```python
import torch

def _softmax(x, axis=-1):
    return torch.softmax(x, dim=axis)
def _gelu(x):
    return torch.nn.functional.gelu(x, approximate="tanh")
def _silu(x):
    return torch.nn.functional.silu(x)
def _sigmoid(x):
    return torch.sigmoid(x)
def _layernorm(x, axis=-1, eps=1e-5):
    m = x.mean(dim=axis, keepdim=True)
    v = x.var(dim=axis, keepdim=True, unbiased=False)
    return (x - m) / torch.sqrt(v + eps)
def _scatter_add(tgt, idx, src, axis=0):
    return tgt.clone().index_add_(axis, idx, src)
def _segment_sum(src, seg, n):
    out = torch.zeros((n,) + src.shape[1:], dtype=src.dtype)
    return out.index_add_(0, seg, src)
def _pad(x, pw):
    flat = tuple(v for pair in reversed(pw) for v in pair)
    return torch.nn.functional.pad(x, flat)

kernel_name = 'concat_heads__sliding_block__spectral_fnet__prompt'

def setup_inputs():

    _w = (lambda a: (lambda t: t.to(torch.bfloat16) if t.is_floating_point() else t)(torch.as_tensor(a)))
    def _A_setup():
        B, S, D = 1, 2048, 640
        return {
            "x": _w((lambda *s: torch.randn(*s, dtype=torch.bfloat16) * 0.2)(B, S, D)),
            "wqkv": _w((lambda *s: torch.randn(*s, dtype=torch.bfloat16) * 0.8)(D, 3 * D)),
            "wo": _w((lambda *s: torch.randn(*s, dtype=torch.bfloat16) * 0.2)(D, D)),
        }
    _A_in = _A_setup()

    def _B_setup():
        B, S, D = 1, 2048, 640
        ns = torch.arange(S)[:, None] * torch.arange(S)[None, :]
        nd = torch.arange(D)[:, None] * torch.arange(D)[None, :]
        Ws_re = torch.cos(-2.0 * torch.pi * ns / S).to(float)
        Ws_im = torch.sin(-2.0 * torch.pi * ns / S).to(float)
        Wd_re = torch.cos(-2.0 * torch.pi * nd / D).to(float)
        Wd_im = torch.sin(-2.0 * torch.pi * nd / D).to(float)
        return {
            "x": _w((lambda *s: torch.randn(*s, dtype=torch.bfloat16) * 0.05)(B, S, D)),
            "dft_seq_re": _w(Ws_re),
            "dft_seq_im": _w(Ws_im),
            "dft_hid_re": _w(Wd_re),
            "dft_hid_im": _w(Wd_im),
        }
    _B_in = _B_setup()

    return {
        "A_x": _A_in["x"],
        "A_wqkv": _A_in["wqkv"],
        "A_wo": _A_in["wo"],
        "B_x": _B_in["x"],
        "B_dft_seq_re": _B_in["dft_seq_re"],
        "B_dft_seq_im": _B_in["dft_seq_im"],
        "B_dft_hid_re": _B_in["dft_hid_re"],
        "B_dft_hid_im": _B_in["dft_hid_im"],
    }

def reference(A_x, A_wqkv, A_wo, B_x, B_dft_seq_re, B_dft_seq_im, B_dft_hid_re, B_dft_hid_im):
    def _A_ref(x, wqkv, wo):
        B, S, D = x.shape
        H = 32; Dh = D // H; W = 256
        qkv = (lambda x, *d: x.permute(*d))((x @ wqkv).reshape(B, S, 3, H, Dh), 2, 0, 3, 1, 4)
        q, k, v = qkv[0], qkv[1], qkv[2]
        scores = torch.einsum("bhqd,bhkd->bhqk", q, k) * (Dh ** -0.5)
        idx = torch.arange(S)
        mask = (idx[:, None] - idx[None, :] >= 0) & (idx[:, None] - idx[None, :] < W)
        scores = torch.where(mask[None, None], scores, -1e9)
        p = _softmax(scores, axis=-1)
        o = torch.einsum("bhqk,bhkd->bhqd", p, v)
        return (lambda x, *d: x.permute(*d))(o, 0, 2, 1, 3).reshape(B, S, D) @ wo

    def _B_ref(x, dft_seq_re, dft_seq_im, dft_hid_re, dft_hid_im):
        a = torch.einsum("bsd,ed->bse", x, dft_hid_re)
        b = torch.einsum("bsd,ed->bse", x, dft_hid_im)
        y = torch.einsum("ts,bse->bte", dft_seq_re, a) - torch.einsum("ts,bse->bte", dft_seq_im, b)
        return y

    a = _A_ref(A_x, A_wqkv, A_wo)
    b = _B_ref(B_x, B_dft_seq_re, B_dft_seq_im, B_dft_hid_re, B_dft_hid_im)
    return torch.concatenate([a, b], axis=-1)
```

```asm
; @launch grid=(256,1,1) block=(512,1,1) lds=163840
.amdgcn_target "amdgcn-amd-amdhsa--gfx950"
.text
.globl concat_heads__sliding_block__spectral_fnet__prompt_kernel
.p2align 8
.type concat_heads__sliding_block__spectral_fnet__prompt_kernel,@function
concat_heads__sliding_block__spectral_fnet__prompt_kernel:
  s_cmp_ge_u32 s2, 256
  s_cbranch_scc1 L_end
  s_load_dwordx4 s[4:7], s[0:1], 0
  s_load_dwordx4 s[8:11], s[0:1], 16
  s_load_dwordx4 s[12:15], s[0:1], 64
  s_load_dwordx2 s[16:17], s[0:1], 80
  v_lshrrev_b32 v4, 6, v0
  v_and_b32 v1, 63, v0
  s_and_b32 s44, s2, 7
  v_readfirstlane_b32 s46, v4
  s_lshr_b32 s45, s2, 3
  v_and_b32 v2, 31, v1
  v_lshrrev_b32 v3, 5, v1
  v_lshlrev_b32 v17, 4, v1
  s_mov_b32 s75, 0
  s_mov_b32 s60, 0
  s_mov_b32 s61, -1
  s_cmp_ge_u32 s46, 4
  s_cselect_b32 s3, 1, 0
  s_cmp_ge_u32 s45, 30
  s_cselect_b32 s57, 1, 0
  s_cbranch_scc1 L_bcu
  s_and_b32 s62, s44, 1
  s_lshr_b32 s63, s44, 1
  s_lshl_b32 s63, s63, 2
  s_and_b32 s18, s45, 3
  s_lshr_b32 s19, s45, 2
  s_lshl_b32 s64, s62, 3
  s_add_u32 s48, s19, s64
  s_cmp_lt_u32 s45, 28
  s_cbranch_scc1 L_m_1
  s_sub_u32 s18, s45, 28
  s_lshl_b32 s64, s62, 1
  s_add_u32 s18, s18, s64
  s_mov_b32 s48, 7
L_m_1:
  s_add_u32 s47, s18, s63
  s_add_u32 s64, s18, s19
  s_and_b32 s64, s64, 3
  s_mul_i32 s64, s64, 5
  s_lshr_b32 s64, s64, 1
  s_lshl_b32 s70, s64, 7
  s_mul_i32 s71, s64, 245760
  s_cmp_eq_u32 s3, 0
  s_cbranch_scc1 L_cmp
  s_and_b32 s65, s46, 3
  v_lshrrev_b32 v4, 3, v1
  v_lshrrev_b32 v5, 4, v1
  v_and_b32 v6, 7, v1
  s_lshl_b32 s66, s47, 7
  s_lshl_b32 s67, s65, 5
  s_add_u32 s66, s66, s67
  v_add_u32 v4, s66, v4
  v_mul_u32_u24 v4, 1280, v4
  v_xor_b32 v6, v5, v6
  v_lshl_add_u32 v100, v6, 4, v4
  v_xor_b32 v6, 4, v6
  v_lshl_add_u32 v101, v6, 4, v4
  v_add_u32 v102, 18432, v100
  v_add_u32 v103, 27648, v101
  v_add_u32 v101, 9216, v101
  v_and_b32 v6, 15, v1
  v_lshlrev_b32 v7, 2, v5
  v_xor_b32 v6, v6, v7
  s_lshl_b32 s66, s65, 4
  v_add_u32 v7, s66, v5
  v_mul_u32_u24 v7, 3840, v7
  s_lshl_b32 s66, s48, 8
  v_lshl_add_u32 v6, v6, 4, s66
  v_add_u32 v104, v6, v7
  s_lshl_b32 s19, s65, 12
  v_add_u32 v105, 14336, v104
  v_add_u32 v106, 28672, v104
  v_add_u32 v107, 43008, v104
  s_cmp_eq_u32 s46, 4
  s_cbranch_scc0 L_cp_2
  s_mov_b32 s66, L_codeend-concat_heads__sliding_block__spectral_fnet__prompt_kernel
  s_getpc_b64 s[62:63]
L_pcref:
  s_sub_u32 s62, s62, L_pcref-concat_heads__sliding_block__spectral_fnet__prompt_kernel
  s_subb_u32 s63, s63, 0
  s_mul_i32 s64, s45, 1280
  v_lshl_add_u32 v6, v1, 7, s64
  v_cmp_gt_u32 s[64:65], s66, v6
  v_mov_b32 v5, s63
  v_add_co_u32 v4, vcc, s62, v6
  s_nop 1
  v_addc_co_u32 v5, vcc, 0, v5, vcc
  s_and_b64 exec, s[64:65], 0x3ff
  s_cbranch_execz L_cp_2x
  global_load_dword v109, v[4:5], off
L_cp_2x:
  s_mov_b64 exec, -1
L_cp_2:
  s_waitcnt lgkmcnt(0)
  s_mov_b32 s20, s4
  s_mov_b32 s21, s5
  s_mov_b32 s22, 2621440
  s_mov_b32 s23, 0x20000
  s_mov_b32 s24, s6
  s_mov_b32 s25, s7
  s_mov_b32 s26, 2457600
  s_mov_b32 s27, 0x20000
  s_setprio 1
  s_add_u32 m0, s19, 0
  s_nop 0
  buffer_load_dwordx4 v100, s[20:23], s70 offen offset:0 lds
  buffer_load_dwordx4 v101, s[20:23], s70 offen offset:1024 lds
  buffer_load_dwordx4 v102, s[20:23], s70 offen offset:2048 lds
  buffer_load_dwordx4 v103, s[20:23], s70 offen offset:3072 lds
  s_add_u32 m0, s19, 16384
  s_add_u32 s70, s70, 128
  buffer_load_dwordx4 v104, s[24:27], s71 offen offset:0 lds
  buffer_load_dwordx4 v105, s[24:27], s71 offen offset:1024 lds
  buffer_load_dwordx4 v106, s[24:27], s71 offen offset:2048 lds
  buffer_load_dwordx4 v107, s[24:27], s71 offen offset:3072 lds
  s_add_u32 s71, s71, 245760
  s_cmp_eq_u32 s70, 1280
  s_cselect_b32 s70, 0, s70
  s_cselect_b32 s71, 0, s71
  s_mov_b32 s28, s8
  s_mov_b32 s29, s9
  s_mov_b32 s30, 819200
  s_mov_b32 s31, 0x20000
  s_mov_b32 s32, s12
  s_mov_b32 s33, s13
  s_mov_b32 s34, 5242880
  s_mov_b32 s35, 0x20000
  s_mov_b32 s40, s14
  s_mov_b32 s41, s15
  s_mov_b32 s42, 256
  s_mov_b32 s43, 0x20000
  s_mov_b32 s36, s16
  s_mov_b32 s37, s17
  s_mov_b32 s38, 14680064
  s_mov_b32 s39, 0x20000
  s_bitcmp1_b32 0x0f000000, s45
  s_cselect_b32 s54, 1, 0
  s_cmp_ge_u32 s45, 28
  s_cselect_b32 s5, 4, 0
  s_sub_u32 s5, s45, s5
  s_mul_i32 s56, s5, 37
  s_lshr_b32 s56, s56, 8
  s_mul_i32 s4, s56, 7
  s_sub_u32 s100, s5, s4
  s_lshr_b32 s4, s44, 1
  s_mul_i32 s55, s4, 7
  s_add_u32 s55, s55, s100
  s_add_u32 s55, s55, 4
  s_and_b32 s5, s45, 3
  s_lshl_b32 s6, s5, 1
  s_add_u32 s6, s6, 1
  s_cmp_eq_u32 s54, 1
  s_cselect_b32 s55, s5, s55
  s_cselect_b32 s56, s4, s56
  s_cselect_b32 s100, s6, s100
  s_and_b32 s4, s44, 1
  s_lshl_b32 s4, s4, 2
  s_add_u32 s56, s56, s4
  s_and_b32 s4, s45, 1
  s_lshl_b32 s50, s44, 1
  s_add_u32 s50, s50, s4
  s_lshr_b32 s49, s45, 1
  s_sub_u32 s49, 15, s49
  s_lshr_b32 s51, s46, 2
  s_mul_i32 s52, s51, 3
  s_xor_b32 s52, s52, s46
  s_and_b32 s52, s52, 3
  s_lshl_b32 s53, s49, 2
  s_add_u32 s53, s53, s52
  s_mul_i32 s4, s50, 163840
  s_lshl_b32 s5, s49, 11
  s_add_u32 s4, s4, s5
  s_add_u32 s4, s4, 2617344
  s_lshl_b32 s6, s49, 1
  s_add_u32 s7, s46, 0
  s_mul_i32 s8, s7, 43
  s_lshr_b32 s8, s8, 8
  s_mul_i32 s9, s8, 6
  s_sub_u32 s9, s7, s9
  s_mul_i32 s10, s8, 6208
  s_lshl_b32 s11, s9, 10
  s_add_u32 s62, s10, s11
  s_lshl_b32 s10, s8, 15
  s_add_u32 s10, s10, s11
  s_add_u32 s66, s10, s4
  s_add_u32 s9, s9, s6
  s_cmp_lt_u32 s9, 4
  s_cselect_b32 s9, 30, s7
  s_cmp_ge_u32 s9, 30
  s_cselect_b32 s62, 31040, s62
  s_cselect_b32 s66, 2621440, s66
  s_add_u32 s7, s46, 8
  s_mul_i32 s8, s7, 43
  s_lshr_b32 s8, s8, 8
  s_mul_i32 s9, s8, 6
  s_sub_u32 s9, s7, s9
  s_mul_i32 s10, s8, 6208
  s_lshl_b32 s11, s9, 10
  s_add_u32 s63, s10, s11
  s_lshl_b32 s10, s8, 15
  s_add_u32 s10, s10, s11
  s_add_u32 s67, s10, s4
  s_add_u32 s9, s9, s6
  s_cmp_lt_u32 s9, 4
  s_cselect_b32 s9, 30, s7
  s_cmp_ge_u32 s9, 30
  s_cselect_b32 s63, 31040, s63
  s_cselect_b32 s67, 2621440, s67
  s_add_u32 s7, s46, 16
  s_mul_i32 s8, s7, 43
  s_lshr_b32 s8, s8, 8
  s_mul_i32 s9, s8, 6
  s_sub_u32 s9, s7, s9
  s_mul_i32 s10, s8, 6208
  s_lshl_b32 s11, s9, 10
  s_add_u32 s64, s10, s11
  s_lshl_b32 s10, s8, 15
  s_add_u32 s10, s10, s11
  s_add_u32 s68, s10, s4
  s_add_u32 s9, s9, s6
  s_cmp_lt_u32 s9, 4
  s_cselect_b32 s9, 30, s7
  s_cmp_ge_u32 s9, 30
  s_cselect_b32 s64, 31040, s64
  s_cselect_b32 s68, 2621440, s68
  s_add_u32 s7, s46, 24
  s_mul_i32 s8, s7, 43
  s_lshr_b32 s8, s8, 8
  s_mul_i32 s9, s8, 6
  s_sub_u32 s9, s7, s9
  s_mul_i32 s10, s8, 6208
  s_lshl_b32 s11, s9, 10
  s_add_u32 s65, s10, s11
  s_lshl_b32 s10, s8, 15
  s_add_u32 s10, s10, s11
  s_add_u32 s69, s10, s4
  s_add_u32 s9, s9, s6
  s_cmp_lt_u32 s9, 4
  s_cselect_b32 s9, 30, s7
  s_cmp_ge_u32 s9, 30
  s_cselect_b32 s65, 31040, s65
  s_cselect_b32 s69, 2621440, s69
  s_lshl_b32 s4, s52, 5
  v_add_u32 v4, s4, v2
  s_add_u32 m0, s19, 32768
  s_nop 0
  buffer_load_dwordx4 v100, s[20:23], s70 offen offset:0 lds
  v_lshlrev_b32 v4, 4, v4
  s_mul_i32 s5, s51, 3
  v_add_u32 v5, s5, v3
  v_mul_u32_u24 v6, 6208, v5
  v_add_u32 v6, 2048, v6
  v_add_u32 v10, v6, v4
  v_add_u32 v6, 14464, v4
  v_mov_b32 v7, 65536
  v_cndmask_b32 v11, v6, v7, s[60:61]
  s_lshl_b32 s6, s53, 5
  v_add_u32 v6, s6, v2
  s_mul_i32 s7, s50, 5
  v_add_u32 v5, s7, v5
  v_lshlrev_b32 v5, 15, v5
  v_lshl_add_u32 v13, v6, 4, v5
  s_add_u32 s7, s7, 2
  s_lshl_b32 s7, s7, 15
  v_lshl_add_u32 v14, v6, 4, s7
  s_lshl_b32 s7, s50, 1
  s_add_u32 s7, s7, s51
  s_lshl_b32 s8, s7, 16
  s_add_u32 s8, s8, 8388608
  v_lshlrev_b32 v5, 15, v3
  buffer_load_dwordx4 v101, s[20:23], s70 offen offset:1024 lds
  v_lshl_add_u32 v5, v6, 4, v5
  v_add_u32 v15, s8, v5
  s_lshl_b32 s8, s7, 14
  s_add_u32 s8, s8, 10485760
  v_lshl_add_u32 v16, v6, 3, s8
  v_bfe_u32 v4, v1, 2, 2
  v_lshl_add_u32 v4, v3, 2, v4
  v_add_u32 v4, s4, v4
  v_bfe_u32 v5, v1, 4, 1
  v_and_b32 v6, 3, v1
  v_lshl_add_u32 v5, v5, 2, v6
  s_mul_i32 s5, s51, 5
  v_add_u32 v6, s5, v5
  v_lshrrev_b32 v7, 1, v6
  v_mul_u32_u24 v7, 6208, v7
  v_and_b32 v6, 1, v6
  v_lshl_add_u32 v7, v6, 3, v7
  v_lshl_add_u32 v7, v4, 4, v7
  v_add_u32 v7, 33088, v7
  s_lshl_b32 s5, s51, 1
  v_add_u32 v6, s5, v3
  v_and_b32 v6, 3, v6
  v_cmp_gt_u32 vcc, 5, v5
  v_lshlrev_b32 v6, 6, v6
  v_add_u32 v6, 65536, v6
  v_cndmask_b32 v12, v6, v7, vcc
  v_mov_b32 v8, 0xff800000
  v_lshlrev_b32 v4, 2, v3
  buffer_load_dwordx4 v102, s[20:23], s70 offen offset:2048 lds
  v_sub_u32 v4, v2, v4
  v_mov_b32 v9, 0xffff
  v_cmp_le_i32 s[4:5], 0, v4
  v_cmp_le_i32 s[6:7], 1, v4
  v_cmp_le_i32 s[8:9], 2, v4
  v_cmp_le_i32 s[10:11], 3, v4
  v_cndmask_b32 v24, v8, 0, s[4:5]
  v_xor_b32 v40, v8, v24
  v_cndmask_b32 v25, v8, 0, s[6:7]
  v_xor_b32 v41, v8, v25
  v_cndmask_b32 v26, v8, 0, s[8:9]
  v_xor_b32 v42, v8, v26
  v_cndmask_b32 v27, v8, 0, s[10:11]
  v_xor_b32 v43, v8, v27
  v_cndmask_b32 v5, 0, v9, s[4:5]
  v_cndmask_b32 v6, 0, v9, s[6:7]
  v_lshl_or_b32 v244, v6, 16, v5
  v_cndmask_b32 v5, 0, v9, s[8:9]
  v_cndmask_b32 v6, 0, v9, s[10:11]
  v_lshl_or_b32 v245, v6, 16, v5
  v_cmp_le_i32 s[4:5], 8, v4
  v_cmp_le_i32 s[6:7], 9, v4
  v_cmp_le_i32 s[8:9], 10, v4
  v_cmp_le_i32 s[10:11], 11, v4
  v_cndmask_b32 v28, v8, 0, s[4:5]
  v_xor_b32 v44, v8, v28
  v_cndmask_b32 v29, v8, 0, s[6:7]
  buffer_load_dwordx4 v103, s[20:23], s70 offen offset:3072 lds
  v_xor_b32 v45, v8, v29
  v_cndmask_b32 v30, v8, 0, s[8:9]
  v_xor_b32 v46, v8, v30
  v_cndmask_b32 v31, v8, 0, s[10:11]
  v_xor_b32 v47, v8, v31
  v_cndmask_b32 v5, 0, v9, s[4:5]
  v_cndmask_b32 v6, 0, v9, s[6:7]
  v_lshl_or_b32 v246, v6, 16, v5
  v_cndmask_b32 v5, 0, v9, s[8:9]
  v_cndmask_b32 v6, 0, v9, s[10:11]
  v_lshl_or_b32 v247, v6, 16, v5
  v_cmp_le_i32 s[4:5], 16, v4
  v_cmp_le_i32 s[6:7], 17, v4
  v_cmp_le_i32 s[8:9], 18, v4
  v_cmp_le_i32 s[10:11], 19, v4
  v_cndmask_b32 v32, v8, 0, s[4:5]
  v_xor_b32 v48, v8, v32
  v_cndmask_b32 v33, v8, 0, s[6:7]
  v_xor_b32 v49, v8, v33
  v_cndmask_b32 v34, v8, 0, s[8:9]
  v_xor_b32 v50, v8, v34
  v_cndmask_b32 v35, v8, 0, s[10:11]
  v_xor_b32 v51, v8, v35
  v_cndmask_b32 v5, 0, v9, s[4:5]
  v_cndmask_b32 v6, 0, v9, s[6:7]
  v_lshl_or_b32 v248, v6, 16, v5
  v_cndmask_b32 v5, 0, v9, s[8:9]
  v_cndmask_b32 v6, 0, v9, s[10:11]
  s_add_u32 m0, s19, 49152
  s_add_u32 s70, s70, 128
  buffer_load_dwordx4 v104, s[24:27], s71 offen offset:0 lds
  v_lshl_or_b32 v249, v6, 16, v5
  v_cmp_le_i32 s[4:5], 24, v4
  v_cmp_le_i32 s[6:7], 25, v4
  v_cmp_le_i32 s[8:9], 26, v4
  v_cmp_le_i32 s[10:11], 27, v4
  v_cndmask_b32 v36, v8, 0, s[4:5]
  v_xor_b32 v52, v8, v36
  v_cndmask_b32 v37, v8, 0, s[6:7]
  v_xor_b32 v53, v8, v37
  v_cndmask_b32 v38, v8, 0, s[8:9]
  v_xor_b32 v54, v8, v38
  v_cndmask_b32 v39, v8, 0, s[10:11]
  v_xor_b32 v55, v8, v39
  v_cndmask_b32 v5, 0, v9, s[4:5]
  v_cndmask_b32 v6, 0, v9, s[6:7]
  v_lshl_or_b32 v250, v6, 16, v5
  v_cndmask_b32 v5, 0, v9, s[8:9]
  v_cndmask_b32 v6, 0, v9, s[10:11]
  v_lshl_or_b32 v251, v6, 16, v5
  v_mul_u32_u24 v4, 43, v1
  v_lshrrev_b32 v4, 8, v4
  v_min_u32 v4, 2, v4
  v_mul_u32_u24 v5, 6, v4
  v_sub_u32 v5, v1, v5
  v_min_u32 v5, 5, v5
  s_cmp_eq_u32 s49, 1
  s_cselect_b32 s5, 9, 0
  v_lshrrev_b32 v6, 1, v5
  buffer_load_dwordx4 v105, s[24:27], s71 offen offset:1024 lds
  v_cmp_eq_u32 vcc, s5, v4
  v_and_b32 v5, 1, v5
  s_mul_i32 s4, s50, 5
  v_cndmask_b32 v6, v6, 0, vcc
  v_sub_u32 v6, s49, v6
  v_max_i32 v6, 0, v6
  v_lshl_add_u32 v5, v5, 2, s4
  v_lshrrev_b32 v5, 4, v5
  v_mad_u32_u24 v5, v4, 5, v5
  v_mad_u32_u24 v5, v6, 15, v5
  v_lshlrev_b32 v5, 7, v5
  v_add_u32 v115, 13631488, v5
  s_cmp_lt_u32 s2, 170
  s_cselect_b32 s73, 1, 0
  s_lshr_b32 s5, s2, 1
  s_mul_i32 s16, s5, 205
  s_lshr_b32 s16, s16, 10
  s_mul_i32 s4, s16, 5
  s_sub_u32 s17, s5, s4
  s_bfe_u32 s4, s46, 0x10001
  s_lshl_b32 s4, s4, 5
  s_and_b32 s5, s46, 1
  s_lshl_b32 s5, s5, 4
  s_add_u32 s4, s4, s5
  s_mul_i32 s5, s16, 98304
  s_lshl_b32 s6, s17, 6
  s_add_u32 s5, s5, s6
  s_cmp_eq_u32 s16, 16
  s_cselect_b32 s6, 31, 63
  s_cselect_b32 s7, 1, 0
  s_cselect_b32 s8, 32, 63
  s_cselect_b32 s9, 1, 0
  s_cmp_eq_u32 s16, 0
  s_cselect_b32 s6, 32, s6
  s_cselect_b32 s7, 33, s7
  v_bfe_u32 v4, v1, 5, 1
  buffer_load_dwordx4 v106, s[24:27], s71 offen offset:2048 lds
  v_bfe_u32 v5, v1, 2, 3
  v_lshl_add_u32 v5, v5, 1, s4
  v_mov_b32 v6, s7
  v_mul_u32_u24 v6, v6, v4
  v_max_u32 v6, s9, v6
  v_mov_b32 v7, s6
  v_mov_b32 v8, s8
  v_cmp_eq_u32 vcc, 0, v4
  v_lshl_add_u32 v4, v4, 6, v5
  v_mul_u32_u24 v4, 768, v4
  v_cndmask_b32 v7, v8, v7, vcc
  v_and_b32 v8, 3, v1
  v_lshl_add_u32 v4, v8, 4, v4
  v_add_u32 v4, s5, v4
  v_cmp_ge_u32 vcc, v5, v6
  v_cmp_ge_u32 s[10:11], v7, v5
  v_add_u32 v4, 0, v4
  v_mov_b32 v8, 2147483632
  v_cndmask_b32 v58, v8, v4, vcc
  v_cndmask_b32 v58, v8, v58, s[10:11]
  buffer_load_dwordx4 v107, s[24:27], s71 offen offset:3072 lds
  s_add_u32 s71, s71, 245760
  s_cmp_eq_u32 s70, 1280
  s_cselect_b32 s70, 0, s70
  s_cselect_b32 s71, 0, s71
  v_add_u32 v5, 1, v5
  v_add_u32 v4, 768, v4
  v_cmp_ge_u32 vcc, v5, v6
  v_cmp_ge_u32 s[10:11], v7, v5
  v_nop
  v_cndmask_b32 v57, v8, v4, vcc
  v_cndmask_b32 v57, v8, v57, s[10:11]
  v_bfe_u32 v4, v1, 3, 1
  v_bfe_u32 v5, v1, 0, 3
  v_lshl_add_u32 v5, v5, 1, s4
  v_mov_b32 v6, s7
  v_mul_u32_u24 v6, v6, v4
  v_max_u32 v6, s9, v6
  v_mov_b32 v7, s6
  v_mov_b32 v8, s8
  v_cmp_eq_u32 vcc, 0, v4
  v_lshl_add_u32 v4, v4, 6, v5
  v_mul_u32_u24 v4, 768, v4
  v_cndmask_b32 v7, v8, v7, vcc
  v_and_b32 v8, 0, v1
  v_lshl_add_u32 v4, v8, 4, v4
  v_add_u32 v4, s5, v4
  v_cmp_ge_u32 vcc, v5, v6
  v_cmp_ge_u32 s[10:11], v7, v5
  v_add_u32 v4, 64, v4
  v_mov_b32 v8, 2147483632
  v_cndmask_b32 v62, v8, v4, vcc
  v_cndmask_b32 v62, v8, v62, s[10:11]
  v_add_u32 v5, 1, v5
  v_add_u32 v4, 768, v4
  v_cmp_ge_u32 vcc, v5, v6
  v_cmp_ge_u32 s[10:11], v7, v5
  v_nop
  v_cndmask_b32 v61, v8, v4, vcc
  v_cndmask_b32 v61, v8, v61, s[10:11]
  v_lshlrev_b32 v4, 7, v1
  v_add_u32 v59, 13664256, v4
  v_bfe_u32 v4, v1, 2, 2
  v_lshlrev_b32 v4, 6, v4
  v_lshl_add_u32 v4, v3, 10, v4
  v_bfe_u32 v5, v1, 4, 1
  v_lshl_add_u32 v4, v5, 5, v4
  v_and_b32 v5, 3, v1
  v_lshl_add_u32 v60, v5, 3, v4
  s_mov_b32 s101, 0
  s_mul_i32 s74, s47, 15
  s_add_u32 s74, s74, s48
  s_lshl_b32 s74, s74, 7
  s_add_u32 s74, s74, 13631488
  s_waitcnt vmcnt(8)
  s_barrier
  s_add_u32 m0, s19, 65536
  s_nop 0
  buffer_load_dwordx4 v100, s[20:23], s70 offen offset:0 lds
  buffer_load_dwordx4 v101, s[20:23], s70 offen offset:1024 lds
  buffer_load_dwordx4 v102, s[20:23], s70 offen offset:2048 lds
  buffer_load_dwordx4 v103, s[20:23], s70 offen offset:3072 lds
  s_add_u32 m0, s19, 81920
  s_add_u32 s70, s70, 128
  buffer_load_dwordx4 v104, s[24:27], s71 offen offset:0 lds
  buffer_load_dwordx4 v105, s[24:27], s71 offen offset:1024 lds
  buffer_load_dwordx4 v106, s[24:27], s71 offen offset:2048 lds
  buffer_load_dwordx4 v107, s[24:27], s71 offen offset:3072 lds
  s_add_u32 s71, s71, 245760
  s_cmp_eq_u32 s70, 1280
  s_cselect_b32 s70, 0, s70
  s_cselect_b32 s71, 0, s71
  s_waitcnt vmcnt(8)
  s_barrier
  s_mov_b64 exec, 1
  v_mov_b32 v109, 0
  buffer_load_dwordx2 v[110:111], v109, s[40:43], 0 offen sc1
  s_mov_b64 exec, -1
  s_add_u32 m0, s19, 98304
  s_nop 0
  buffer_load_dwordx4 v100, s[20:23], s70 offen offset:0 lds
  buffer_load_dwordx4 v101, s[20:23], s70 offen offset:1024 lds
  buffer_load_dwordx4 v102, s[20:23], s70 offen offset:2048 lds
  buffer_load_dwordx4 v103, s[20:23], s70 offen offset:3072 lds
  s_add_u32 m0, s19, 114688
  s_add_u32 s70, s70, 128
  buffer_load_dwordx4 v104, s[24:27], s71 offen offset:0 lds
  buffer_load_dwordx4 v105, s[24:27], s71 offen offset:1024 lds
  buffer_load_dwordx4 v106, s[24:27], s71 offen offset:2048 lds
  buffer_load_dwordx4 v107, s[24:27], s71 offen offset:3072 lds
  s_add_u32 s71, s71, 245760
  s_cmp_eq_u32 s70, 1280
  s_cselect_b32 s70, 0, s70
  s_cselect_b32 s71, 0, s71
  s_waitcnt vmcnt(8)
  s_barrier
  s_add_u32 m0, s19, 0
  s_nop 0
  buffer_load_dwordx4 v100, s[20:23], s70 offen offset:0 lds
  buffer_load_dwordx4 v101, s[20:23], s70 offen offset:1024 lds
  buffer_load_dwordx4 v102, s[20:23], s70 offen offset:2048 lds
  buffer_load_dwordx4 v103, s[20:23], s70 offen offset:3072 lds
  s_add_u32 m0, s19, 16384
  s_add_u32 s70, s70, 128
  buffer_load_dwordx4 v104, s[24:27], s71 offen offset:0 lds
  buffer_load_dwordx4 v105, s[24:27], s71 offen offset:1024 lds
  buffer_load_dwordx4 v106, s[24:27], s71 offen offset:2048 lds
  buffer_load_dwordx4 v107, s[24:27], s71 offen offset:3072 lds
  s_add_u32 s71, s71, 245760
  s_cmp_eq_u32 s70, 1280
  s_cselect_b32 s70, 0, s70
  s_cselect_b32 s71, 0, s71
  s_waitcnt vmcnt(8)
  s_barrier
  s_add_u32 m0, s19, 32768
  s_nop 0
  buffer_load_dwordx4 v100, s[20:23], s70 offen offset:0 lds
  buffer_load_dwordx4 v101, s[20:23], s70 offen offset:1024 lds
  buffer_load_dwordx4 v102, s[20:23], s70 offen offset:2048 lds
  buffer_load_dwordx4 v103, s[20:23], s70 offen offset:3072 lds
  s_add_u32 m0, s19, 49152
  s_add_u32 s70, s70, 128
  buffer_load_dwordx4 v104, s[24:27], s71 offen offset:0 lds
  buffer_load_dwordx4 v105, s[24:27], s71 offen offset:1024 lds
  buffer_load_dwordx4 v106, s[24:27], s71 offen offset:2048 lds
  buffer_load_dwordx4 v107, s[24:27], s71 offen offset:3072 lds
  s_add_u32 s71, s71, 245760
  s_cmp_eq_u32 s70, 1280
  s_cselect_b32 s70, 0, s70
  s_cselect_b32 s71, 0, s71
  s_waitcnt vmcnt(8)
  s_barrier
  s_add_u32 m0, s19, 65536
  s_nop 0
  buffer_load_dwordx4 v100, s[20:23], s70 offen offset:0 lds
  buffer_load_dwordx4 v101, s[20:23], s70 offen offset:1024 lds
  buffer_load_dwordx4 v102, s[20:23], s70 offen offset:2048 lds
  buffer_load_dwordx4 v103, s[20:23], s70 offen offset:3072 lds
  s_add_u32 m0, s19, 81920
  s_add_u32 s70, s70, 128
  buffer_load_dwordx4 v104, s[24:27], s71 offen offset:0 lds
  buffer_load_dwordx4 v105, s[24:27], s71 offen offset:1024 lds
  buffer_load_dwordx4 v106, s[24:27], s71 offen offset:2048 lds
  buffer_load_dwordx4 v107, s[24:27], s71 offen offset:3072 lds
  s_add_u32 s71, s71, 245760
  s_cmp_eq_u32 s70, 1280
  s_cselect_b32 s70, 0, s70
  s_cselect_b32 s71, 0, s71
  s_waitcnt vmcnt(8)
  s_barrier
  s_add_u32 m0, s19, 98304
  s_nop 0
  buffer_load_dwordx4 v100, s[20:23], s70 offen offset:0 lds
  buffer_load_dwordx4 v101, s[20:23], s70 offen offset:1024 lds
  buffer_load_dwordx4 v102, s[20:23], s70 offen offset:2048 lds
  buffer_load_dwordx4 v103, s[20:23], s70 offen offset:3072 lds
  s_add_u32 m0, s19, 114688
  s_add_u32 s70, s70, 128
  buffer_load_dwordx4 v104, s[24:27], s71 offen offset:0 lds
  buffer_load_dwordx4 v105, s[24:27], s71 offen offset:1024 lds
  buffer_load_dwordx4 v106, s[24:27], s71 offen offset:2048 lds
  buffer_load_dwordx4 v107, s[24:27], s71 offen offset:3072 lds
  s_add_u32 s71, s71, 245760
  s_cmp_eq_u32 s70, 1280
  s_cselect_b32 s70, 0, s70
  s_cselect_b32 s71, 0, s71
  s_waitcnt vmcnt(8)
  s_barrier
  s_add_u32 m0, s19, 0
  s_nop 0
  buffer_load_dwordx4 v100, s[20:23], s70 offen offset:0 lds
  buffer_load_dwordx4 v101, s[20:23], s70 offen offset:1024 lds
  buffer_load_dwordx4 v102, s[20:23], s70 offen offset:2048 lds
  buffer_load_dwordx4 v103, s[20:23], s70 offen offset:3072 lds
  s_add_u32 m0, s19, 16384
  s_add_u32 s70, s70, 128
  buffer_load_dwordx4 v104, s[24:27], s71 offen offset:0 lds
  buffer_load_dwordx4 v105, s[24:27], s71 offen offset:1024 lds
  buffer_load_dwordx4 v106, s[24:27], s71 offen offset:2048 lds
  buffer_load_dwordx4 v107, s[24:27], s71 offen offset:3072 lds
  s_add_u32 s71, s71, 245760
  s_cmp_eq_u32 s70, 1280
  s_cselect_b32 s70, 0, s70
  s_cselect_b32 s71, 0, s71
  s_waitcnt vmcnt(8)
  s_barrier
  s_add_u32 m0, s19, 32768
  s_nop 0
  buffer_load_dwordx4 v100, s[20:23], s70 offen offset:0 lds
  buffer_load_dwordx4 v101, s[20:23], s70 offen offset:1024 lds
  buffer_load_dwordx4 v102, s[20:23], s70 offen offset:2048 lds
  buffer_load_dwordx4 v103, s[20:23], s70 offen offset:3072 lds
  s_add_u32 m0, s19, 49152
  s_add_u32 s70, s70, 128
  buffer_load_dwordx4 v104, s[24:27], s71 offen offset:0 lds
  buffer_load_dwordx4 v105, s[24:27], s71 offen offset:1024 lds
  buffer_load_dwordx4 v106, s[24:27], s71 offen offset:2048 lds
  buffer_load_dwordx4 v107, s[24:27], s71 offen offset:3072 lds
  s_add_u32 s71, s71, 245760
  s_cmp_eq_u32 s70, 1280
  s_cselect_b32 s70, 0, s70
  s_cselect_b32 s71, 0, s71
  s_waitcnt vmcnt(8)
  s_barrier
  v_mov_b32 v4, -1
  v_mov_b32 v5, -1
  v_mov_b32 v6, -1
  v_mov_b32 v7, -1
  s_and_b32 s7, s46, 3
  s_lshl_b32 s4, s50, 2
  s_add_u32 s4, s4, s7
  s_lshl_b32 s4, s4, 15
  s_lshl_b32 s6, s49, 11
  s_add_u32 s4, s4, s6
  s_add_u32 s4, s4, 8388608
  s_and_b32 s7, s7, 1
  s_lshl_b32 s5, s50, 1
  s_add_u32 s5, s5, s7
  s_lshl_b32 s5, s5, 14
  s_lshl_b32 s6, s49, 10
  s_add_u32 s5, s5, s6
  s_add_u32 s5, s5, 10485760
  s_mov_b32 s7, s49
L_pz_3:
  buffer_store_dwordx4 v[4:7], v17, s[36:39], s4 offen sc1
  buffer_store_dwordx4 v[4:7], v17, s[36:39], s4 offen offset:1024 sc1
  buffer_store_dwordx4 v[4:7], v17, s[36:39], s5 offen sc1
  s_sub_u32 s4, s4, 2048
  s_sub_u32 s5, s5, 1024
  s_sub_u32 s7, s7, 1
  s_cmp_eq_u32 s7, 0
  s_cbranch_scc1 L_pz_3
  s_cmp_eq_u32 s49, 1
  s_cbranch_scc1 L_pz6
  s_waitcnt vmcnt(3)
  s_branch L_pz7
L_pz6:
  s_waitcnt vmcnt(6)
L_pz7:
  s_barrier
  s_setprio 0
  v_mov_b32 v4, 1065369472
  v_mov_b32 v5, v4
  v_mov_b32 v6, v4
  v_mov_b32 v7, v4
  s_and_b32 s4, s46, 3
  s_lshl_b32 s4, s4, 10
  s_add_u32 s4, s4, 65536
  v_add_u32 v8, s4, v17
  ds_write_b128 v8, v[4:7]
  v_add_u32 v8, 69376, v17
  ds_write_b128 v8, v[4:7]
  v_readfirstlane_b32 s58, v110
  v_readfirstlane_b32 s59, v111
  s_nop 1
  s_cmp_lg_u32 s58, 0
  s_cbranch_scc1 L_nl_4
  s_mov_b64 exec, 1
  v_mov_b32 v4, 0
L_nf_5:
  buffer_load_dwordx2 v[6:7], v4, s[40:43], 0 offen sc1
  s_waitcnt vmcnt(0)
  v_cmp_eq_u32 vcc, 0, v6
  s_cbranch_vccnz L_nf_5
L_nff_6:
  v_readfirstlane_b32 s58, v6
  v_readfirstlane_b32 s59, v7
  s_mov_b64 exec, -1
L_nl_4:
  s_waitcnt vmcnt(0) lgkmcnt(0)
  s_barrier
  s_cmp_eq_u32 s46, 4
  s_cbranch_scc0 L_hg
  s_lshl_b32 s4, s2, 7
  s_add_u32 s4, s4, 13729792
  v_mov_b32 v4, s58
  v_mov_b32 v5, s59
  v_mov_b32 v6, s58
  v_mov_b32 v7, s59
  s_mov_b64 exec, 0xff
  buffer_store_dwordx4 v[4:7], v17, s[36:39], s74 offen sc1
  buffer_store_dwordx4 v[4:7], v17, s[36:39], s4 offen sc1
  s_mov_b64 exec, -1
L_hg:
  s_cmp_eq_u32 s73, 0
  s_cbranch_scc1 L_nh_7
  s_and_b32 s4, s2, 1
  s_lshl_b32 s4, s4, 5
  v_add_u32 v4, s4, v2
  v_cvt_f32_u32 v4, v4
  s_cmp_eq_u32 s16, 16
  s_cselect_b32 s5, 0x3c000000, 0
  s_cselect_b32 s6, 1, 0
  v_mov_b32 v5, s5
  v_fmamk_f32 v4, v4, 0x3c800000, v5
  v_cvt_f32_u32 v5, v3
  v_mul_f32 v5, 0x41800000, v5
  v_mul_f32 v5, v4, v5
  s_cbranch_scc0 L_hg_8
  v_subrev_f32 v5, 0x3e800000, v5
L_hg_8:
  v_add_f32 v6, 0x3e800000, v5
  v_fmamk_f32 v7, v4, 0x42000000, v5
  v_fmamk_f32 v116, v4, 0x3f800000, v5
  v_fmamk_f32 v117, v4, 0x40400000, v5
  v_fmamk_f32 v118, v4, 0x40a00000, v5
  v_fmamk_f32 v119, v4, 0x40e00000, v5
  v_fmamk_f32 v120, v4, 0x41100000, v5
  v_fmamk_f32 v121, v4, 0x41300000, v5
  v_fmamk_f32 v122, v4, 0x41500000, v5
  v_fmamk_f32 v123, v4, 0x41700000, v5
  v_cos_f32 v116, v116
  v_cos_f32 v117, v117
  v_cos_f32 v118, v118
  v_cos_f32 v119, v119
  v_cos_f32 v120, v120
  v_cos_f32 v121, v121
  v_cos_f32 v122, v122
  v_cos_f32 v123, v123
  s_nop 0
  v_cvt_pk_bf16_f32 v68, v116, v117
  v_cvt_pk_bf16_f32 v69, v118, v119
  v_cvt_pk_bf16_f32 v70, v120, v121
  v_cvt_pk_bf16_f32 v71, v122, v123
  v_fmamk_f32 v116, v4, 0x3f800000, v6
  v_fmamk_f32 v117, v4, 0x40400000, v6
  v_fmamk_f32 v118, v4, 0x40a00000, v6
  v_fmamk_f32 v119, v4, 0x40e00000, v6
  v_fmamk_f32 v120, v4, 0x41100000, v6
  v_fmamk_f32 v121, v4, 0x41300000, v6
  v_fmamk_f32 v122, v4, 0x41500000, v6
  v_fmamk_f32 v123, v4, 0x41700000, v6
  v_cos_f32 v116, v116
  v_cos_f32 v117, v117
  v_cos_f32 v118, v118
  v_cos_f32 v119, v119
  v_cos_f32 v120, v120
  v_cos_f32 v121, v121
  v_cos_f32 v122, v122
  v_cos_f32 v123, v123
  s_nop 0
  v_cvt_pk_bf16_f32 v72, v116, v117
  v_cvt_pk_bf16_f32 v73, v118, v119
  v_cvt_pk_bf16_f32 v74, v120, v121
  v_cvt_pk_bf16_f32 v75, v122, v123
  v_fmamk_f32 v116, v4, 0x0, v5
  v_fmamk_f32 v117, v4, 0x40000000, v5
  v_fmamk_f32 v118, v4, 0x40800000, v5
  v_fmamk_f32 v119, v4, 0x40c00000, v5
  v_fmamk_f32 v120, v4, 0x41000000, v5
  v_fmamk_f32 v121, v4, 0x41200000, v5
  v_fmamk_f32 v122, v4, 0x41400000, v5
  v_fmamk_f32 v123, v4, 0x41600000, v5
  v_cos_f32 v116, v116
  v_cos_f32 v117, v117
  v_cos_f32 v118, v118
  v_cos_f32 v119, v119
  v_cos_f32 v120, v120
  v_cos_f32 v121, v121
  v_cos_f32 v122, v122
  v_cos_f32 v123, v123
  s_nop 0
  v_cvt_pk_bf16_f32 v76, v116, v117
  v_cvt_pk_bf16_f32 v77, v118, v119
  v_cvt_pk_bf16_f32 v78, v120, v121
  v_cvt_pk_bf16_f32 v79, v122, v123
  v_cndmask_b32 v116, v7, v6, s[60:61]
  v_fmamk_f32 v117, v4, 0x40000000, v6
  v_fmamk_f32 v118, v4, 0x40800000, v6
  v_fmamk_f32 v119, v4, 0x40c00000, v6
  v_fmamk_f32 v120, v4, 0x41000000, v6
  v_fmamk_f32 v121, v4, 0x41200000, v6
  v_fmamk_f32 v122, v4, 0x41400000, v6
  v_fmamk_f32 v123, v4, 0x41600000, v6
  v_cos_f32 v116, v116
  v_cos_f32 v117, v117
  v_cos_f32 v118, v118
  v_cos_f32 v119, v119
  v_cos_f32 v120, v120
  v_cos_f32 v121, v121
  v_cos_f32 v122, v122
  v_cos_f32 v123, v123
  s_nop 0
  v_cvt_pk_bf16_f32 v80, v116, v117
  v_cvt_pk_bf16_f32 v81, v118, v119
  v_cvt_pk_bf16_f32 v82, v120, v121
  v_cvt_pk_bf16_f32 v83, v122, v123
  s_cmp_eq_u32 s6, 2
  s_cbranch_scc1 L_nh_7
  v_mov_b32 v84, v68
  v_mov_b32 v85, v69
  v_mov_b32 v86, v70
  v_mov_b32 v87, v71
  v_mov_b32 v88, v72
  v_mov_b32 v89, v73
  v_mov_b32 v90, v74
  v_mov_b32 v91, v75
  v_mov_b32 v92, v76
  v_mov_b32 v93, v77
  v_mov_b32 v94, v78
  v_mov_b32 v95, v79
  v_mov_b32 v96, v80
  v_mov_b32 v97, v81
  v_mov_b32 v98, v82
  v_mov_b32 v99, v83
  s_cmp_eq_u32 s6, 0
  s_cbranch_scc1 L_nh_7
  s_mov_b32 s6, 2
  v_add_f32 v5, 0x3e800000, v5
  s_branch L_hg_8
L_nh_7:
  s_cmp_eq_u32 s46, 4
  s_cbranch_scc0 L_barB
  s_mov_b64 exec, 0x3ffff
L_pl_9:
  buffer_load_dwordx2 v[8:9], v115, s[36:39], 0 offen sc1
  s_waitcnt vmcnt(0)
  v_cmp_ne_u64 vcc, s[58:59], v[8:9]
  s_cbranch_vccnz L_pl_9
L_plf_10:
  s_mov_b64 exec, -1
  s_branch L_barB
L_cmp:
  s_mov_b32 s73, 0
  s_lshr_b32 s62, s46, 1
  s_and_b32 s63, s46, 1
  v_bfe_u32 v5, v1, 1, 3
  v_xor_b32 v5, v5, v3
  s_lshl_b32 s64, s62, 6
  v_add_u32 v6, s64, v2
  v_lshlrev_b32 v6, 7, v6
  v_lshl_add_u32 v100, v5, 4, v6
  v_xor_b32 v101, 32, v100
  v_xor_b32 v102, 64, v100
  v_xor_b32 v103, 96, v100
  v_bfe_u32 v5, v1, 2, 2
  v_bfe_u32 v6, v1, 4, 1
  v_bfe_u32 v7, v1, 1, 1
  v_lshl_add_u32 v6, v6, 1, v7
  s_lshl_b32 s64, s63, 3
  v_add_u32 v6, s64, v6
  v_lshlrev_b32 v7, 2, v5
  v_xor_b32 v6, v6, v7
  v_lshl_add_u32 v5, v3, 3, v5
  v_lshlrev_b32 v5, 8, v5
  v_lshl_add_u32 v5, v6, 4, v5
  v_and_b32 v7, 1, v1
  v_lshl_add_u32 v104, v7, 3, v5
  v_xor_b32 v105, 64, v104
  v_lshlrev_b32 v5, 15, v3
  v_lshl_add_u32 v112, v2, 4, v5
  s_lshl_b32 s18, s48, 19
  s_lshl_b32 s64, s63, 18
  s_add_u32 s18, s18, s64
  s_lshl_b32 s64, s47, 11
  s_add_u32 s18, s18, s64
  s_lshl_b32 s64, s62, 10
  s_add_u32 s18, s18, s64
  v_add_u32 v106, 0x10000, v100
  v_add_u32 v107, 0x10000, v101
  v_add_u32 v108, 0x10000, v102
  v_add_u32 v109, 0x10000, v103
  v_add_u32 v110, 0x10000, v104
  v_add_u32 v111, 0x10000, v105
  s_waitcnt lgkmcnt(0)
  s_mov_b32 s28, s8
  s_mov_b32 s29, s9
  s_mov_b32 s30, 819200
  s_mov_b32 s31, 0x20000
  s_mov_b32 s32, s12
  s_mov_b32 s33, s13
  s_mov_b32 s34, 5242880
  s_mov_b32 s35, 0x20000
  s_mov_b32 s40, s14
  s_mov_b32 s41, s15
  s_mov_b32 s42, 256
  s_mov_b32 s43, 0x20000
  s_mov_b32 s36, s16
  s_mov_b32 s37, s17
  s_mov_b32 s38, 14680064
  s_mov_b32 s39, 0x20000
  s_or_b32 s4, s2, s46
  s_cmp_eq_u32 s4, 0
  s_cbranch_scc0 L_np_11
  s_mov_b64 exec, 1
  v_mov_b32 v114, 0
  s_mov_b32 s4, 13762560
  buffer_load_dwordx2 v[116:117], v114, s[36:39], s4 offen sc1
  s_mov_b64 exec, -1
L_np_11:
  s_bitcmp1_b32 0x0f000000, s45
  s_cselect_b32 s54, 1, 0
  s_cmp_ge_u32 s45, 28
  s_cselect_b32 s5, 4, 0
  s_sub_u32 s5, s45, s5
  s_mul_i32 s56, s5, 37
  s_lshr_b32 s56, s56, 8
  s_mul_i32 s4, s56, 7
  s_sub_u32 s100, s5, s4
  s_lshr_b32 s4, s44, 1
  s_mul_i32 s55, s4, 7
  s_add_u32 s55, s55, s100
  s_add_u32 s55, s55, 4
  s_and_b32 s5, s45, 3
  s_lshl_b32 s6, s5, 1
  s_add_u32 s6, s6, 1
  s_cmp_eq_u32 s54, 1
  s_cselect_b32 s55, s5, s55
  s_cselect_b32 s56, s4, s56
  s_cselect_b32 s100, s6, s100
  s_and_b32 s4, s44, 1
  s_lshl_b32 s4, s4, 2
  s_add_u32 s56, s56, s4
  s_and_b32 s4, s45, 1
  s_lshl_b32 s50, s44, 1
  s_add_u32 s50, s50, s4
  s_lshr_b32 s49, s45, 1
  s_sub_u32 s49, 15, s49
  s_lshr_b32 s51, s46, 2
  s_mul_i32 s52, s51, 3
  s_xor_b32 s52, s52, s46
  s_and_b32 s52, s52, 3
  s_lshl_b32 s53, s49, 2
  s_add_u32 s53, s53, s52
  s_mul_i32 s4, s50, 163840
  s_lshl_b32 s5, s49, 11
  s_add_u32 s4, s4, s5
  s_add_u32 s4, s4, 2617344
  s_lshl_b32 s6, s49, 1
  s_add_u32 s7, s46, 0
  s_mul_i32 s8, s7, 43
  s_lshr_b32 s8, s8, 8
  s_mul_i32 s9, s8, 6
  s_sub_u32 s9, s7, s9
  s_mul_i32 s10, s8, 6208
  s_lshl_b32 s11, s9, 10
  s_add_u32 s62, s10, s11
  s_lshl_b32 s10, s8, 15
  s_add_u32 s10, s10, s11
  s_add_u32 s66, s10, s4
  s_add_u32 s9, s9, s6
  s_cmp_lt_u32 s9, 4
  s_cselect_b32 s9, 30, s7
  s_cmp_ge_u32 s9, 30
  s_cselect_b32 s62, 31040, s62
  s_cselect_b32 s66, 2621440, s66
  s_add_u32 s7, s46, 8
  s_mul_i32 s8, s7, 43
  s_lshr_b32 s8, s8, 8
  s_mul_i32 s9, s8, 6
  s_sub_u32 s9, s7, s9
  s_mul_i32 s10, s8, 6208
  s_lshl_b32 s11, s9, 10
  s_add_u32 s63, s10, s11
  s_lshl_b32 s10, s8, 15
  s_add_u32 s10, s10, s11
  s_add_u32 s67, s10, s4
  s_add_u32 s9, s9, s6
  s_cmp_lt_u32 s9, 4
  s_cselect_b32 s9, 30, s7
  s_cmp_ge_u32 s9, 30
  s_cselect_b32 s63, 31040, s63
  s_cselect_b32 s67, 2621440, s67
  s_add_u32 s7, s46, 16
  s_mul_i32 s8, s7, 43
  s_lshr_b32 s8, s8, 8
  s_mul_i32 s9, s8, 6
  s_sub_u32 s9, s7, s9
  s_mul_i32 s10, s8, 6208
  s_lshl_b32 s11, s9, 10
  s_add_u32 s64, s10, s11
  s_lshl_b32 s10, s8, 15
  s_add_u32 s10, s10, s11
  s_add_u32 s68, s10, s4
  s_add_u32 s9, s9, s6
  s_cmp_lt_u32 s9, 4
  s_cselect_b32 s9, 30, s7
  s_cmp_ge_u32 s9, 30
  s_cselect_b32 s64, 31040, s64
  s_cselect_b32 s68, 2621440, s68
  s_add_u32 s7, s46, 24
  s_mul_i32 s8, s7, 43
  s_lshr_b32 s8, s8, 8
  s_mul_i32 s9, s8, 6
  s_sub_u32 s9, s7, s9
  s_mul_i32 s10, s8, 6208
  s_lshl_b32 s11, s9, 10
  s_add_u32 s65, s10, s11
  s_lshl_b32 s10, s8, 15
  s_add_u32 s10, s10, s11
  s_add_u32 s69, s10, s4
  s_add_u32 s9, s9, s6
  s_cmp_lt_u32 s9, 4
  s_cselect_b32 s9, 30, s7
  s_cmp_ge_u32 s9, 30
  s_cselect_b32 s65, 31040, s65
  s_cselect_b32 s69, 2621440, s69
  s_lshl_b32 s4, s52, 5
  v_add_u32 v4, s4, v2
  v_lshlrev_b32 v4, 4, v4
  s_mul_i32 s5, s51, 3
  v_add_u32 v5, s5, v3
  v_mul_u32_u24 v6, 6208, v5
  v_add_u32 v6, 2048, v6
  v_add_u32 v10, v6, v4
  v_add_u32 v6, 14464, v4
  v_mov_b32 v7, 65536
  v_cndmask_b32 v11, v6, v7, s[60:61]
  s_lshl_b32 s6, s53, 5
  v_add_u32 v6, s6, v2
  s_mul_i32 s7, s50, 5
  v_add_u32 v5, s7, v5
  v_lshlrev_b32 v5, 15, v5
  v_lshl_add_u32 v13, v6, 4, v5
  s_add_u32 s7, s7, 2
  s_lshl_b32 s7, s7, 15
  v_lshl_add_u32 v14, v6, 4, s7
  s_lshl_b32 s7, s50, 1
  s_add_u32 s7, s7, s51
  s_lshl_b32 s8, s7, 16
  s_add_u32 s8, s8, 8388608
  v_lshlrev_b32 v5, 15, v3
  v_lshl_add_u32 v5, v6, 4, v5
  v_add_u32 v15, s8, v5
  s_lshl_b32 s8, s7, 14
  s_add_u32 s8, s8, 10485760
  v_lshl_add_u32 v16, v6, 3, s8
  v_bfe_u32 v4, v1, 2, 2
  v_lshl_add_u32 v4, v3, 2, v4
  v_add_u32 v4, s4, v4
  v_bfe_u32 v5, v1, 4, 1
  v_and_b32 v6, 3, v1
  v_lshl_add_u32 v5, v5, 2, v6
  s_mul_i32 s5, s51, 5
  v_add_u32 v6, s5, v5
  v_lshrrev_b32 v7, 1, v6
  v_mul_u32_u24 v7, 6208, v7
  v_and_b32 v6, 1, v6
  v_lshl_add_u32 v7, v6, 3, v7
  v_lshl_add_u32 v7, v4, 4, v7
  v_add_u32 v7, 33088, v7
  s_lshl_b32 s5, s51, 1
  v_add_u32 v6, s5, v3
  v_and_b32 v6, 3, v6
  v_cmp_gt_u32 vcc, 5, v5
  v_lshlrev_b32 v6, 6, v6
  v_add_u32 v6, 65536, v6
  v_cndmask_b32 v12, v6, v7, vcc
  v_mov_b32 v8, 0xff800000
  v_lshlrev_b32 v4, 2, v3
  v_sub_u32 v4, v2, v4
  v_mov_b32 v9, 0xffff
  v_cmp_le_i32 s[4:5], 0, v4
  v_cmp_le_i32 s[6:7], 1, v4
  v_cmp_le_i32 s[8:9], 2, v4
  v_cmp_le_i32 s[10:11], 3, v4
  v_cndmask_b32 v24, v8, 0, s[4:5]
  v_xor_b32 v40, v8, v24
  v_cndmask_b32 v25, v8, 0, s[6:7]
  v_xor_b32 v41, v8, v25
  v_cndmask_b32 v26, v8, 0, s[8:9]
  v_xor_b32 v42, v8, v26
  v_cndmask_b32 v27, v8, 0, s[10:11]
  v_xor_b32 v43, v8, v27
  v_cndmask_b32 v5, 0, v9, s[4:5]
  v_cndmask_b32 v6, 0, v9, s[6:7]
  v_lshl_or_b32 v244, v6, 16, v5
  v_cndmask_b32 v5, 0, v9, s[8:9]
  v_cndmask_b32 v6, 0, v9, s[10:11]
  v_lshl_or_b32 v245, v6, 16, v5
  v_cmp_le_i32 s[4:5], 8, v4
  v_cmp_le_i32 s[6:7], 9, v4
  v_cmp_le_i32 s[8:9], 10, v4
  v_cmp_le_i32 s[10:11], 11, v4
  v_cndmask_b32 v28, v8, 0, s[4:5]
  v_xor_b32 v44, v8, v28
  v_cndmask_b32 v29, v8, 0, s[6:7]
  v_xor_b32 v45, v8, v29
  v_cndmask_b32 v30, v8, 0, s[8:9]
  v_xor_b32 v46, v8, v30
  v_cndmask_b32 v31, v8, 0, s[10:11]
  v_xor_b32 v47, v8, v31
  v_cndmask_b32 v5, 0, v9, s[4:5]
  v_cndmask_b32 v6, 0, v9, s[6:7]
  v_lshl_or_b32 v246, v6, 16, v5
  v_cndmask_b32 v5, 0, v9, s[8:9]
  v_cndmask_b32 v6, 0, v9, s[10:11]
  v_lshl_or_b32 v247, v6, 16, v5
  v_cmp_le_i32 s[4:5], 16, v4
  v_cmp_le_i32 s[6:7], 17, v4
  v_cmp_le_i32 s[8:9], 18, v4
  v_cmp_le_i32 s[10:11], 19, v4
  v_cndmask_b32 v32, v8, 0, s[4:5]
  v_xor_b32 v48, v8, v32
  v_cndmask_b32 v33, v8, 0, s[6:7]
  v_xor_b32 v49, v8, v33
  v_cndmask_b32 v34, v8, 0, s[8:9]
  v_xor_b32 v50, v8, v34
  v_cndmask_b32 v35, v8, 0, s[10:11]
  v_xor_b32 v51, v8, v35
  v_cndmask_b32 v5, 0, v9, s[4:5]
  v_cndmask_b32 v6, 0, v9, s[6:7]
  v_lshl_or_b32 v248, v6, 16, v5
  v_cndmask_b32 v5, 0, v9, s[8:9]
  v_cndmask_b32 v6, 0, v9, s[10:11]
  v_lshl_or_b32 v249, v6, 16, v5
  v_cmp_le_i32 s[4:5], 24, v4
  v_cmp_le_i32 s[6:7], 25, v4
  v_cmp_le_i32 s[8:9], 26, v4
  v_cmp_le_i32 s[10:11], 27, v4
  v_cndmask_b32 v36, v8, 0, s[4:5]
  v_xor_b32 v52, v8, v36
  v_cndmask_b32 v37, v8, 0, s[6:7]
  v_xor_b32 v53, v8, v37
  v_cndmask_b32 v38, v8, 0, s[8:9]
  v_xor_b32 v54, v8, v38
  v_cndmask_b32 v39, v8, 0, s[10:11]
  v_xor_b32 v55, v8, v39
  v_cndmask_b32 v5, 0, v9, s[4:5]
  v_cndmask_b32 v6, 0, v9, s[6:7]
  v_lshl_or_b32 v250, v6, 16, v5
  v_cndmask_b32 v5, 0, v9, s[8:9]
  v_cndmask_b32 v6, 0, v9, s[10:11]
  v_lshl_or_b32 v251, v6, 16, v5
  s_or_b32 s4, s2, s46
  s_cmp_eq_u32 s4, 0
  s_cbranch_scc0 L_np2_12
  s_mov_b64 exec, 1
  v_mov_b32 v114, 0
  s_mov_b32 s4, 13762560
  s_waitcnt vmcnt(0)
  v_add_u32 v116, 1, v116
  v_max_u32 v116, 1, v116
  buffer_store_dwordx2 v[116:117], v114, s[40:43], 0 offen sc1
  buffer_store_dwordx2 v[116:117], v114, s[36:39], s4 offen sc1
  s_mov_b64 exec, -1
L_np2_12:
  s_and_b32 s4, s46, 3
  s_lshl_b32 s4, s4, 6
  v_add_u32 v4, s4, v1
  v_mul_u32_u24 v5, 205, v4
  v_lshrrev_b32 v5, 11, v5
  v_mul_u32_u24 v6, 10, v5
  v_sub_u32 v4, v4, v6
  v_bfe_u32 v6, v5, 2, 1
  v_bfe_u32 v7, v5, 3, 1
  v_xor_b32 v7, v6, v7
  v_mul_u32_u24 v7, 12, v7
  v_xor_b32 v5, v5, v7
  s_mul_i32 s4, s56, 160
  v_lshl_add_u32 v4, v4, 4, s4
  v_lshrrev_b32 v6, 4, v5
  v_lshl_add_u32 v6, v6, 2, v5
  v_mul_u32_u24 v6, 1280, v6
  v_add_u32 v18, v6, v4
  v_lshrrev_b32 v6, 2, v5
  v_mul_u32_u24 v6, 20, v6
  v_and_b32 v7, 3, v5
  v_add3_u32 v6, v6, v7, 16
  v_mul_u32_u24 v6, 1280, v6
  v_add_u32 v20, v6, v4
  s_and_b32 s4, s46, 3
  s_lshl_b32 s4, s4, 6
  v_add_u32 v4, 256, v1
  v_mul_u32_u24 v5, 205, v4
  v_lshrrev_b32 v5, 11, v5
  v_mul_u32_u24 v6, 10, v5
  v_sub_u32 v4, v4, v6
  v_bfe_u32 v6, v5, 2, 1
  v_bfe_u32 v7, v5, 3, 1
  v_xor_b32 v7, v6, v7
  v_mul_u32_u24 v7, 12, v7
  v_xor_b32 v5, v5, v7
  s_mul_i32 s4, s56, 160
  v_lshl_add_u32 v4, v4, 4, s4
  v_lshrrev_b32 v6, 4, v5
  v_lshl_add_u32 v6, v6, 2, v5
  v_mul_u32_u24 v6, 1280, v6
  v_add_u32 v19, v6, v4
  v_lshrrev_b32 v6, 2, v5
  v_mul_u32_u24 v6, 20, v6
  v_and_b32 v7, 3, v5
  v_add3_u32 v6, v6, v7, 16
  v_mul_u32_u24 v6, 1280, v6
  v_add_u32 v21, v6, v4
  v_and_b32 v4, 15, v1
  v_lshrrev_b32 v5, 4, v1
  s_lshl_b32 s4, s55, 6
  s_and_b32 s5, s46, 3
  s_lshl_b32 s5, s5, 4
  s_add_u32 s4, s4, s5
  v_add_u32 v6, s4, v4
  v_lshlrev_b32 v7, 15, v5
  v_lshl_add_u32 v56, v6, 4, v7
  v_add_u32 v56, 8388608, v56
  v_lshl_add_u32 v57, v6, 3, v7
  v_add_u32 v57, 10485760, v57
  v_lshlrev_b32 v6, 4, v3
  v_bfe_u32 v7, v1, 4, 1
  v_lshl_add_u32 v6, v7, 2, v6
  v_bfe_u32 v8, v1, 2, 2
  v_add_u32 v6, v6, v8
  v_mul_u32_u24 v6, 160, v6
  v_and_b32 v8, 3, v1
  v_lshl_add_u32 v60, v8, 3, v6
  s_cmp_eq_u32 s54, 1
  s_cselect_b64 vcc, -1, 0
  v_cndmask_b32 v7, v60, v17, vcc
  s_and_b32 s5, s56, 3
  s_mul_i32 s6, s5, 20480
  s_add_u32 s6, s6, 70400
  v_add_u32 v58, s6, v7
  s_add_u32 s5, s5, 1
  s_and_b32 s5, s5, 3
  s_mul_i32 s6, s5, 20480
  s_add_u32 s6, s6, 70400
  v_add_u32 v59, s6, v7
  s_add_u32 s5, s5, 1
  s_and_b32 s5, s5, 3
  s_mul_i32 s6, s5, 20480
  s_add_u32 s6, s6, 70400
  v_add_u32 v68, s6, v7
  s_add_u32 s5, s5, 1
  s_and_b32 s5, s5, 3
  s_mul_i32 s6, s5, 20480
  s_add_u32 s6, s6, 70400
  v_add_u32 v69, s6, v7
  s_mul_i32 s5, s46, 2816
  s_add_u32 s5, s5, 45056
  v_mul_u32_u24 v6, 176, v4
  v_lshl_add_u32 v6, v5, 3, v6
  v_add_u32 v61, s5, v6
  s_mul_i32 s6, s56, 160
  s_mul_i32 s7, s4, 2560
  s_add_u32 s6, s6, s7
  s_lshr_b32 s7, s55, 1
  s_lshl_b32 s7, s7, 11
  s_add_u32 s7, s7, 13697024
  v_lshl_add_u32 v71, v4, 7, s7
  s_lshr_b32 s7, s55, 1
  s_max_u32 s7, s7, 1
  s_sub_u32 s7, 15, s7
  s_lshl_b32 s7, s7, 11
  s_add_u32 s7, s7, 13729792
  v_and_b32 v6, 1, v4
  v_lshlrev_b32 v6, 10, v6
  v_lshrrev_b32 v7, 1, v4
  v_lshl_add_u32 v6, v7, 7, v6
  v_add_u32 v70, s7, v6
  s_lshl_b32 s7, s4, 4
  s_add_u32 s7, s7, 8421616
  v_lshl_add_u32 v93, v2, 16, s7
  v_add_u32 v4, 0, v1
  v_mul_u32_u24 v5, 205, v4
  v_lshrrev_b32 v5, 11, v5
  v_mul_u32_u24 v6, 10, v5
  v_sub_u32 v4, v4, v6
  v_lshlrev_b32 v4, 4, v4
  v_mul_u32_u24 v6, 176, v5
  v_add3_u32 v62, v6, v4, s5
  v_mul_u32_u24 v6, 2560, v5
  v_add3_u32 v65, v6, v4, s6
  v_add_u32 v4, 64, v1
  v_mul_u32_u24 v5, 205, v4
  v_lshrrev_b32 v5, 11, v5
  v_mul_u32_u24 v6, 10, v5
  v_sub_u32 v4, v4, v6
  v_lshlrev_b32 v4, 4, v4
  v_mul_u32_u24 v6, 176, v5
  v_add3_u32 v63, v6, v4, s5
  v_mul_u32_u24 v6, 2560, v5
  v_add3_u32 v66, v6, v4, s6
  v_add_u32 v4, 128, v1
  v_mul_u32_u24 v5, 205, v4
  v_lshrrev_b32 v5, 11, v5
  v_mul_u32_u24 v6, 10, v5
  v_sub_u32 v4, v4, v6
  v_lshlrev_b32 v4, 4, v4
  v_mul_u32_u24 v6, 176, v5
  v_add3_u32 v64, v6, v4, s5
  v_mul_u32_u24 v6, 2560, v5
  v_add3_u32 v67, v6, v4, s6
  v_add_u32 v4, 0, v1
  v_mul_u32_u24 v5, 205, v4
  v_lshrrev_b32 v5, 11, v5
  v_mul_u32_u24 v6, 10, v5
  v_sub_u32 v4, v4, v6
  v_bfe_u32 v6, v5, 2, 1
  v_bfe_u32 v7, v5, 3, 1
  v_xor_b32 v7, v6, v7
  v_mul_u32_u24 v7, 12, v7
  v_xor_b32 v5, v5, v7
  s_mul_i32 s4, s56, 160
  s_add_u32 s4, s4, 20480
  v_lshl_add_u32 v4, v4, 4, s4
  v_lshrrev_b32 v6, 2, v5
  v_mul_u32_u24 v6, 20, v6
  v_and_b32 v7, 3, v5
  v_add_u32 v6, v6, v7
  v_mul_u32_u24 v6, 1280, v6
  v_add_u32 v88, v6, v4
  v_add_u32 v4, 64, v1
  v_mul_u32_u24 v5, 205, v4
  v_lshrrev_b32 v5, 11, v5
  v_mul_u32_u24 v6, 10, v5
  v_sub_u32 v4, v4, v6
  v_bfe_u32 v6, v5, 2, 1
  v_bfe_u32 v7, v5, 3, 1
  v_xor_b32 v7, v6, v7
  v_mul_u32_u24 v7, 12, v7
  v_xor_b32 v5, v5, v7
  s_mul_i32 s4, s56, 160
  s_add_u32 s4, s4, 19456
  v_lshl_add_u32 v4, v4, 4, s4
  v_lshrrev_b32 v6, 2, v5
  v_mul_u32_u24 v6, 20, v6
  v_and_b32 v7, 3, v5
  v_add_u32 v6, v6, v7
  v_mul_u32_u24 v6, 1280, v6
  v_add_u32 v89, v6, v4
  v_add_u32 v4, 128, v1
  v_mul_u32_u24 v5, 205, v4
  v_lshrrev_b32 v5, 11, v5
  v_mul_u32_u24 v6, 10, v5
  v_sub_u32 v4, v4, v6
  v_bfe_u32 v6, v5, 2, 1
  v_bfe_u32 v7, v5, 3, 1
  v_xor_b32 v7, v6, v7
  v_mul_u32_u24 v7, 12, v7
  v_xor_b32 v5, v5, v7
  s_mul_i32 s4, s56, 160
  s_add_u32 s4, s4, 18432
  v_lshl_add_u32 v4, v4, 4, s4
  v_lshrrev_b32 v6, 2, v5
  v_mul_u32_u24 v6, 20, v6
  v_and_b32 v7, 3, v5
  v_add_u32 v6, v6, v7
  v_mul_u32_u24 v6, 1280, v6
  v_add_u32 v90, v6, v4
  v_add_u32 v4, 192, v1
  v_mul_u32_u24 v5, 205, v4
  v_lshrrev_b32 v5, 11, v5
  v_mul_u32_u24 v6, 10, v5
  v_sub_u32 v4, v4, v6
  v_bfe_u32 v6, v5, 2, 1
  v_bfe_u32 v7, v5, 3, 1
  v_xor_b32 v7, v6, v7
  v_mul_u32_u24 v7, 12, v7
  v_xor_b32 v5, v5, v7
  s_mul_i32 s4, s56, 160
  s_add_u32 s4, s4, 17408
  v_lshl_add_u32 v4, v4, 4, s4
  v_lshrrev_b32 v6, 2, v5
  v_mul_u32_u24 v6, 20, v6
  v_and_b32 v7, 3, v5
  v_add_u32 v6, v6, v7
  v_mul_u32_u24 v6, 1280, v6
  v_add_u32 v91, v6, v4
  v_add_u32 v4, 256, v1
  v_mul_u32_u24 v5, 205, v4
  v_lshrrev_b32 v5, 11, v5
  v_mul_u32_u24 v6, 10, v5
  v_sub_u32 v4, v4, v6
  v_bfe_u32 v6, v5, 2, 1
  v_bfe_u32 v7, v5, 3, 1
  v_xor_b32 v7, v6, v7
  v_mul_u32_u24 v7, 12, v7
  v_xor_b32 v5, v5, v7
  s_mul_i32 s4, s56, 160
  s_add_u32 s4, s4, 20480
  v_lshl_add_u32 v4, v4, 4, s4
  v_lshrrev_b32 v6, 2, v5
  v_mul_u32_u24 v6, 20, v6
  v_and_b32 v7, 3, v5
  v_add_u32 v6, v6, v7
  v_mul_u32_u24 v6, 1280, v6
  v_add_u32 v92, v6, v4
  v_mov_b32 v6, 2147483632
  v_cndmask_b32 v67, v67, v6, s[60:61]
  v_cndmask_b32 v64, v64, v62, s[60:61]
  s_barrier
  ds_read_b64_tr_b16 v[116:117], v104 offset:16384
  ds_read_b64_tr_b16 v[118:119], v104 offset:17408
  ds_read_b128 v[124:127], v100 offset:0
  ds_read_b128 v[128:131], v100 offset:4096
  ds_read_b64_tr_b16 v[120:121], v105 offset:16384
  ds_read_b64_tr_b16 v[122:123], v105 offset:17408
  s_waitcnt lgkmcnt(0)
  v_mfma_f32_32x32x16_bf16 v[148:163], v[116:119], v[124:127], 0
  ds_read_b64_tr_b16 v[132:133], v104 offset:20480
  ds_read_b64_tr_b16 v[134:135], v104 offset:21504
  v_mfma_f32_32x32x16_bf16 v[164:179], v[116:119], v[128:131], 0
  ds_read_b128 v[140:143], v101 offset:0
  ds_read_b128 v[144:147], v101 offset:4096
  v_mfma_f32_32x32x16_bf16 v[180:195], v[120:123], v[124:127], 0
  ds_read_b64_tr_b16 v[136:137], v105 offset:20480
  ds_read_b64_tr_b16 v[138:139], v105 offset:21504
  v_mfma_f32_32x32x16_bf16 v[196:211], v[120:123], v[128:131], 0
  s_waitcnt lgkmcnt(0)
  v_mfma_f32_32x32x16_bf16 v[148:163], v[132:135], v[140:143], v[148:163]
  ds_read_b64_tr_b16 v[116:117], v104 offset:24576
  ds_read_b64_tr_b16 v[118:119], v104 offset:25600
  v_mfma_f32_32x32x16_bf16 v[164:179], v[132:135], v[144:147], v[164:179]
  ds_read_b128 v[124:127], v102 offset:0
  ds_read_b128 v[128:131], v102 offset:4096
  v_mfma_f32_32x32x16_bf16 v[180:195], v[136:139], v[140:143], v[180:195]
  ds_read_b64_tr_b16 v[120:121], v105 offset:24576
  ds_read_b64_tr_b16 v[122:123], v105 offset:25600
  v_mfma_f32_32x32x16_bf16 v[196:211], v[136:139], v[144:147], v[196:211]
  s_waitcnt lgkmcnt(0)
  v_mfma_f32_32x32x16_bf16 v[148:163], v[116:119], v[124:127], v[148:163]
  ds_read_b64_tr_b16 v[132:133], v104 offset:28672
  ds_read_b64_tr_b16 v[134:135], v104 offset:29696
  v_mfma_f32_32x32x16_bf16 v[164:179], v[116:119], v[128:131], v[164:179]
  ds_read_b128 v[140:143], v103 offset:0
  ds_read_b128 v[144:147], v103 offset:4096
  v_mfma_f32_32x32x16_bf16 v[180:195], v[120:123], v[124:127], v[180:195]
  ds_read_b64_tr_b16 v[136:137], v105 offset:28672
  ds_read_b64_tr_b16 v[138:139], v105 offset:29696
  v_mfma_f32_32x32x16_bf16 v[196:211], v[120:123], v[128:131], v[196:211]
  s_waitcnt lgkmcnt(0)
  v_mfma_f32_32x32x16_bf16 v[148:163], v[132:135], v[140:143], v[148:163]
  v_mfma_f32_32x32x16_bf16 v[164:179], v[132:135], v[144:147], v[164:179]
  s_barrier
  ds_read_b64_tr_b16 v[116:117], v104 offset:49152
  ds_read_b64_tr_b16 v[118:119], v104 offset:50176
  ds_read_b128 v[124:127], v100 offset:32768
  ds_read_b128 v[128:131], v100 offset:36864
  ds_read_b64_tr_b16 v[120:121], v105 offset:49152
  ds_read_b64_tr_b16 v[122:123], v105 offset:50176
  v_mfma_f32_32x32x16_bf16 v[180:195], v[136:139], v[140:143], v[180:195]
  v_mfma_f32_32x32x16_bf16 v[196:211], v[136:139], v[144:147], v[196:211]
  s_waitcnt lgkmcnt(0)
  v_mfma_f32_32x32x16_bf16 v[148:163], v[116:119], v[124:127], v[148:163]
  ds_read_b64_tr_b16 v[132:133], v104 offset:53248
  ds_read_b64_tr_b16 v[134:135], v104 offset:54272
  v_mfma_f32_32x32x16_bf16 v[164:179], v[116:119], v[128:131], v[164:179]
  ds_read_b128 v[140:143], v101 offset:32768
  ds_read_b128 v[144:147], v101 offset:36864
  v_mfma_f32_32x32x16_bf16 v[180:195], v[120:123], v[124:127], v[180:195]
  ds_read_b64_tr_b16 v[136:137], v105 offset:53248
  ds_read_b64_tr_b16 v[138:139], v105 offset:54272
  v_mfma_f32_32x32x16_bf16 v[196:211], v[120:123], v[128:131], v[196:211]
  s_waitcnt lgkmcnt(0)
  v_mfma_f32_32x32x16_bf16 v[148:163], v[132:135], v[140:143], v[148:163]
  ds_read_b64_tr_b16 v[116:117], v104 offset:57344
  ds_read_b64_tr_b16 v[118:119], v104 offset:58368
  v_mfma_f32_32x32x16_bf16 v[164:179], v[132:135], v[144:147], v[164:179]
  ds_read_b128 v[124:127], v102 offset:32768
  ds_read_b128 v[128:131], v102 offset:36864
  v_mfma_f32_32x32x16_bf16 v[180:195], v[136:139], v[140:143], v[180:195]
  ds_read_b64_tr_b16 v[120:121], v105 offset:57344
  ds_read_b64_tr_b16 v[122:123], v105 offset:58368
  v_mfma_f32_32x32x16_bf16 v[196:211], v[136:139], v[144:147], v[196:211]
  s_waitcnt lgkmcnt(0)
  v_mfma_f32_32x32x16_bf16 v[148:163], v[116:119], v[124:127], v[148:163]
  ds_read_b64_tr_b16 v[132:133], v104 offset:61440
  ds_read_b64_tr_b16 v[134:135], v104 offset:62464
  v_mfma_f32_32x32x16_bf16 v[164:179], v[116:119], v[128:131], v[164:179]
  ds_read_b128 v[140:143], v103 offset:32768
  ds_read_b128 v[144:147], v103 offset:36864
  v_mfma_f32_32x32x16_bf16 v[180:195], v[120:123], v[124:127], v[180:195]
  ds_read_b64_tr_b16 v[136:137], v105 offset:61440
  ds_read_b64_tr_b16 v[138:139], v105 offset:62464
  v_mfma_f32_32x32x16_bf16 v[196:211], v[120:123], v[128:131], v[196:211]
  s_waitcnt lgkmcnt(0)
  v_mfma_f32_32x32x16_bf16 v[148:163], v[132:135], v[140:143], v[148:163]
  v_mfma_f32_32x32x16_bf16 v[164:179], v[132:135], v[144:147], v[164:179]
  s_barrier
  ds_read_b64_tr_b16 v[116:117], v110 offset:16384
  ds_read_b64_tr_b16 v[118:119], v110 offset:17408
  ds_read_b128 v[124:127], v106 offset:0
  ds_read_b128 v[128:131], v106 offset:4096
  ds_read_b64_tr_b16 v[120:121], v111 offset:16384
  ds_read_b64_tr_b16 v[122:123], v111 offset:17408
  v_mfma_f32_32x32x16_bf16 v[180:195], v[136:139], v[140:143], v[180:195]
  v_mfma_f32_32x32x16_bf16 v[196:211], v[136:139], v[144:147], v[196:211]
  s_waitcnt lgkmcnt(0)
  v_mfma_f32_32x32x16_bf16 v[148:163], v[116:119], v[124:127], v[148:163]
  ds_read_b64_tr_b16 v[132:133], v110 offset:20480
  ds_read_b64_tr_b16 v[134:135], v110 offset:21504
  v_mfma_f32_32x32x16_bf16 v[164:179], v[116:119], v[128:131], v[164:179]
  ds_read_b128 v[140:143], v107 offset:0
  ds_read_b128 v[144:147], v107 offset:4096
  v_mfma_f32_32x32x16_bf16 v[180:195], v[120:123], v[124:127], v[180:195]
  ds_read_b64_tr_b16 v[136:137], v111 offset:20480
  ds_read_b64_tr_b16 v[138:139], v111 offset:21504
  v_mfma_f32_32x32x16_bf16 v[196:211], v[120:123], v[128:131], v[196:211]
  s_waitcnt lgkmcnt(0)
  v_mfma_f32_32x32x16_bf16 v[148:163], v[132:135], v[140:143], v[148:163]
  ds_read_b64_tr_b16 v[116:117], v110 offset:24576
  ds_read_b64_tr_b16 v[118:119], v110 offset:25600
  v_mfma_f32_32x32x16_bf16 v[164:179], v[132:135], v[144:147], v[164:179]
  ds_read_b128 v[124:127], v108 offset:0
  ds_read_b128 v[128:131], v108 offset:4096
  v_mfma_f32_32x32x16_bf16 v[180:195], v[136:139], v[140:143], v[180:195]
  ds_read_b64_tr_b16 v[120:121], v111 offset:24576
  ds_read_b64_tr_b16 v[122:123], v111 offset:25600
  v_mfma_f32_32x32x16_bf16 v[196:211], v[136:139], v[144:147], v[196:211]
  s_waitcnt lgkmcnt(0)
  v_mfma_f32_32x32x16_bf16 v[148:163], v[116:119], v[124:127], v[148:163]
  ds_read_b64_tr_b16 v[132:133], v110 offset:28672
  ds_read_b64_tr_b16 v[134:135], v110 offset:29696
  v_mfma_f32_32x32x16_bf16 v[164:179], v[116:119], v[128:131], v[164:179]
  ds_read_b128 v[140:143], v109 offset:0
  ds_read_b128 v[144:147], v109 offset:4096
  v_mfma_f32_32x32x16_bf16 v[180:195], v[120:123], v[124:127], v[180:195]
  ds_read_b64_tr_b16 v[136:137], v111 offset:28672
  ds_read_b64_tr_b16 v[138:139], v111 offset:29696
  v_mfma_f32_32x32x16_bf16 v[196:211], v[120:123], v[128:131], v[196:211]
  s_waitcnt lgkmcnt(0)
  v_mfma_f32_32x32x16_bf16 v[148:163], v[132:135], v[140:143], v[148:163]
  v_mfma_f32_32x32x16_bf16 v[164:179], v[132:135], v[144:147], v[164:179]
  s_barrier
  ds_read_b64_tr_b16 v[116:117], v110 offset:49152
  ds_read_b64_tr_b16 v[118:119], v110 offset:50176
  ds_read_b128 v[124:127], v106 offset:32768
  ds_read_b128 v[128:131], v106 offset:36864
  ds_read_b64_tr_b16 v[120:121], v111 offset:49152
  ds_read_b64_tr_b16 v[122:123], v111 offset:50176
  v_mfma_f32_32x32x16_bf16 v[180:195], v[136:139], v[140:143], v[180:195]
  v_mfma_f32_32x32x16_bf16 v[196:211], v[136:139], v[144:147], v[196:211]
  s_waitcnt lgkmcnt(0)
  v_mfma_f32_32x32x16_bf16 v[148:163], v[116:119], v[124:127], v[148:163]
  ds_read_b64_tr_b16 v[132:133], v110 offset:53248
  ds_read_b64_tr_b16 v[134:135], v110 offset:54272
  v_mfma_f32_32x32x16_bf16 v[164:179], v[116:119], v[128:131], v[164:179]
  ds_read_b128 v[140:143], v107 offset:32768
  ds_read_b128 v[144:147], v107 offset:36864
  v_mfma_f32_32x32x16_bf16 v[180:195], v[120:123], v[124:127], v[180:195]
  ds_read_b64_tr_b16 v[136:137], v111 offset:53248
  ds_read_b64_tr_b16 v[138:139], v111 offset:54272
  v_mfma_f32_32x32x16_bf16 v[196:211], v[120:123], v[128:131], v[196:211]
  s_waitcnt lgkmcnt(0)
  v_mfma_f32_32x32x16_bf16 v[148:163], v[132:135], v[140:143], v[148:163]
  ds_read_b64_tr_b16 v[116:117], v110 offset:57344
  ds_read_b64_tr_b16 v[118:119], v110 offset:58368
  v_mfma_f32_32x32x16_bf16 v[164:179], v[132:135], v[144:147], v[164:179]
  ds_read_b128 v[124:127], v108 offset:32768
  ds_read_b128 v[128:131], v108 offset:36864
  v_mfma_f32_32x32x16_bf16 v[180:195], v[136:139], v[140:143], v[180:195]
  ds_read_b64_tr_b16 v[120:121], v111 offset:57344
  ds_read_b64_tr_b16 v[122:123], v111 offset:58368
  v_mfma_f32_32x32x16_bf16 v[196:211], v[136:139], v[144:147], v[196:211]
  s_waitcnt lgkmcnt(0)
  v_mfma_f32_32x32x16_bf16 v[148:163], v[116:119], v[124:127], v[148:163]
  ds_read_b64_tr_b16 v[132:133], v110 offset:61440
  ds_read_b64_tr_b16 v[134:135], v110 offset:62464
  v_mfma_f32_32x32x16_bf16 v[164:179], v[116:119], v[128:131], v[164:179]
  ds_read_b128 v[140:143], v109 offset:32768
  ds_read_b128 v[144:147], v109 offset:36864
  v_mfma_f32_32x32x16_bf16 v[180:195], v[120:123], v[124:127], v[180:195]
  ds_read_b64_tr_b16 v[136:137], v111 offset:61440
  ds_read_b64_tr_b16 v[138:139], v111 offset:62464
  v_mfma_f32_32x32x16_bf16 v[196:211], v[120:123], v[128:131], v[196:211]
  s_waitcnt lgkmcnt(0)
  v_mfma_f32_32x32x16_bf16 v[148:163], v[132:135], v[140:143], v[148:163]
  v_mfma_f32_32x32x16_bf16 v[164:179], v[132:135], v[144:147], v[164:179]
  s_barrier
  ds_read_b64_tr_b16 v[116:117], v104 offset:16384
  ds_read_b64_tr_b16 v[118:119], v104 offset:17408
  ds_read_b128 v[124:127], v100 offset:0
  ds_read_b128 v[128:131], v100 offset:4096
  ds_read_b64_tr_b16 v[120:121], v105 offset:16384
  ds_read_b64_tr_b16 v[122:123], v105 offset:17408
  v_mfma_f32_32x32x16_bf16 v[180:195], v[136:139], v[140:143], v[180:195]
  v_mfma_f32_32x32x16_bf16 v[196:211], v[136:139], v[144:147], v[196:211]
  s_waitcnt lgkmcnt(0)
  v_mfma_f32_32x32x16_bf16 v[148:163], v[116:119], v[124:127], v[148:163]
  ds_read_b64_tr_b16 v[132:133], v104 offset:20480
  ds_read_b64_tr_b16 v[134:135], v104 offset:21504
  v_mfma_f32_32x32x16_bf16 v[164:179], v[116:119], v[128:131], v[164:179]
  ds_read_b128 v[140:143], v101 offset:0
  ds_read_b128 v[144:147], v101 offset:4096
  v_mfma_f32_32x32x16_bf16 v[180:195], v[120:123], v[124:127], v[180:195]
  ds_read_b64_tr_b16 v[136:137], v105 offset:20480
  ds_read_b64_tr_b16 v[138:139], v105 offset:21504
  v_mfma_f32_32x32x16_bf16 v[196:211], v[120:123], v[128:131], v[196:211]
  s_waitcnt lgkmcnt(0)
  v_mfma_f32_32x32x16_bf16 v[148:163], v[132:135], v[140:143], v[148:163]
  ds_read_b64_tr_b16 v[116:117], v104 offset:24576
  ds_read_b64_tr_b16 v[118:119], v104 offset:25600
  v_mfma_f32_32x32x16_bf16 v[164:179], v[132:135], v[144:147], v[164:179]
  ds_read_b128 v[124:127], v102 offset:0
  ds_read_b128 v[128:131], v102 offset:4096
  v_mfma_f32_32x32x16_bf16 v[180:195], v[136:139], v[140:143], v[180:195]
  ds_read_b64_tr_b16 v[120:121], v105 offset:24576
  ds_read_b64_tr_b16 v[122:123], v105 offset:25600
  v_mfma_f32_32x32x16_bf16 v[196:211], v[136:139], v[144:147], v[196:211]
  s_waitcnt lgkmcnt(0)
  v_mfma_f32_32x32x16_bf16 v[148:163], v[116:119], v[124:127], v[148:163]
  ds_read_b64_tr_b16 v[132:133], v104 offset:28672
  ds_read_b64_tr_b16 v[134:135], v104 offset:29696
  v_mfma_f32_32x32x16_bf16 v[164:179], v[116:119], v[128:131], v[164:179]
  ds_read_b128 v[140:143], v103 offset:0
  ds_read_b128 v[144:147], v103 offset:4096
  v_mfma_f32_32x32x16_bf16 v[180:195], v[120:123], v[124:127], v[180:195]
  ds_read_b64_tr_b16 v[136:137], v105 offset:28672
  ds_read_b64_tr_b16 v[138:139], v105 offset:29696
  v_mfma_f32_32x32x16_bf16 v[196:211], v[120:123], v[128:131], v[196:211]
  s_waitcnt lgkmcnt(0)
  v_mfma_f32_32x32x16_bf16 v[148:163], v[132:135], v[140:143], v[148:163]
  v_mfma_f32_32x32x16_bf16 v[164:179], v[132:135], v[144:147], v[164:179]
  s_barrier
  ds_read_b64_tr_b16 v[116:117], v104 offset:49152
  ds_read_b64_tr_b16 v[118:119], v104 offset:50176
  ds_read_b128 v[124:127], v100 offset:32768
  ds_read_b128 v[128:131], v100 offset:36864
  ds_read_b64_tr_b16 v[120:121], v105 offset:49152
  ds_read_b64_tr_b16 v[122:123], v105 offset:50176
  v_mfma_f32_32x32x16_bf16 v[180:195], v[136:139], v[140:143], v[180:195]
  v_mfma_f32_32x32x16_bf16 v[196:211], v[136:139], v[144:147], v[196:211]
  s_waitcnt lgkmcnt(0)
  v_mfma_f32_32x32x16_bf16 v[148:163], v[116:119], v[124:127], v[148:163]
  ds_read_b64_tr_b16 v[132:133], v104 offset:53248
  ds_read_b64_tr_b16 v[134:135], v104 offset:54272
  v_mfma_f32_32x32x16_bf16 v[164:179], v[116:119], v[128:131], v[164:179]
  ds_read_b128 v[140:143], v101 offset:32768
  ds_read_b128 v[144:147], v101 offset:36864
  v_mfma_f32_32x32x16_bf16 v[180:195], v[120:123], v[124:127], v[180:195]
  ds_read_b64_tr_b16 v[136:137], v105 offset:53248
  ds_read_b64_tr_b16 v[138:139], v105 offset:54272
  v_mfma_f32_32x32x16_bf16 v[196:211], v[120:123], v[128:131], v[196:211]
  s_waitcnt lgkmcnt(0)
  v_mfma_f32_32x32x16_bf16 v[148:163], v[132:135], v[140:143], v[148:163]
  ds_read_b64_tr_b16 v[116:117], v104 offset:57344
  ds_read_b64_tr_b16 v[118:119], v104 offset:58368
  v_mfma_f32_32x32x16_bf16 v[164:179], v[132:135], v[144:147], v[164:179]
  ds_read_b128 v[124:127], v102 offset:32768
  ds_read_b128 v[128:131], v102 offset:36864
  v_mfma_f32_32x32x16_bf16 v[180:195], v[136:139], v[140:143], v[180:195]
  ds_read_b64_tr_b16 v[120:121], v105 offset:57344
  ds_read_b64_tr_b16 v[122:123], v105 offset:58368
  v_mfma_f32_32x32x16_bf16 v[196:211], v[136:139], v[144:147], v[196:211]
  s_waitcnt lgkmcnt(0)
  v_mfma_f32_32x32x16_bf16 v[148:163], v[116:119], v[124:127], v[148:163]
  ds_read_b64_tr_b16 v[132:133], v104 offset:61440
  ds_read_b64_tr_b16 v[134:135], v104 offset:62464
  v_mfma_f32_32x32x16_bf16 v[164:179], v[116:119], v[128:131], v[164:179]
  ds_read_b128 v[140:143], v103 offset:32768
  ds_read_b128 v[144:147], v103 offset:36864
  v_mfma_f32_32x32x16_bf16 v[180:195], v[120:123], v[124:127], v[180:195]
  ds_read_b64_tr_b16 v[136:137], v105 offset:61440
  ds_read_b64_tr_b16 v[138:139], v105 offset:62464
  v_mfma_f32_32x32x16_bf16 v[196:211], v[120:123], v[128:131], v[196:211]
  s_waitcnt lgkmcnt(0)
  v_mfma_f32_32x32x16_bf16 v[148:163], v[132:135], v[140:143], v[148:163]
  v_mfma_f32_32x32x16_bf16 v[164:179], v[132:135], v[144:147], v[164:179]
  s_barrier
  ds_read_b64_tr_b16 v[116:117], v110 offset:16384
  ds_read_b64_tr_b16 v[118:119], v110 offset:17408
  ds_read_b128 v[124:127], v106 offset:0
  ds_read_b128 v[128:131], v106 offset:4096
  ds_read_b64_tr_b16 v[120:121], v111 offset:16384
  ds_read_b64_tr_b16 v[122:123], v111 offset:17408
  v_mfma_f32_32x32x16_bf16 v[180:195], v[136:139], v[140:143], v[180:195]
  v_mfma_f32_32x32x16_bf16 v[196:211], v[136:139], v[144:147], v[196:211]
  s_waitcnt lgkmcnt(0)
  v_mfma_f32_32x32x16_bf16 v[148:163], v[116:119], v[124:127], v[148:163]
  ds_read_b64_tr_b16 v[132:133], v110 offset:20480
  ds_read_b64_tr_b16 v[134:135], v110 offset:21504
  v_mfma_f32_32x32x16_bf16 v[164:179], v[116:119], v[128:131], v[164:179]
  ds_read_b128 v[140:143], v107 offset:0
  ds_read_b128 v[144:147], v107 offset:4096
  v_mfma_f32_32x32x16_bf16 v[180:195], v[120:123], v[124:127], v[180:195]
  ds_read_b64_tr_b16 v[136:137], v111 offset:20480
  ds_read_b64_tr_b16 v[138:139], v111 offset:21504
  v_mfma_f32_32x32x16_bf16 v[196:211], v[120:123], v[128:131], v[196:211]
  s_waitcnt lgkmcnt(0)
  v_mfma_f32_32x32x16_bf16 v[148:163], v[132:135], v[140:143], v[148:163]
  ds_read_b64_tr_b16 v[116:117], v110 offset:24576
  ds_read_b64_tr_b16 v[118:119], v110 offset:25600
  v_mfma_f32_32x32x16_bf16 v[164:179], v[132:135], v[144:147], v[164:179]
  ds_read_b128 v[124:127], v108 offset:0
  ds_read_b128 v[128:131], v108 offset:4096
  v_mfma_f32_32x32x16_bf16 v[180:195], v[136:139], v[140:143], v[180:195]
  ds_read_b64_tr_b16 v[120:121], v111 offset:24576
  ds_read_b64_tr_b16 v[122:123], v111 offset:25600
  v_mfma_f32_32x32x16_bf16 v[196:211], v[136:139], v[144:147], v[196:211]
  s_waitcnt lgkmcnt(0)
  v_mfma_f32_32x32x16_bf16 v[148:163], v[116:119], v[124:127], v[148:163]
  ds_read_b64_tr_b16 v[132:133], v110 offset:28672
  ds_read_b64_tr_b16 v[134:135], v110 offset:29696
  v_mfma_f32_32x32x16_bf16 v[164:179], v[116:119], v[128:131], v[164:179]
  ds_read_b128 v[140:143], v109 offset:0
  ds_read_b128 v[144:147], v109 offset:4096
  v_mfma_f32_32x32x16_bf16 v[180:195], v[120:123], v[124:127], v[180:195]
  ds_read_b64_tr_b16 v[136:137], v111 offset:28672
  ds_read_b64_tr_b16 v[138:139], v111 offset:29696
  v_mfma_f32_32x32x16_bf16 v[196:211], v[120:123], v[128:131], v[196:211]
  s_waitcnt lgkmcnt(0)
  v_mfma_f32_32x32x16_bf16 v[148:163], v[132:135], v[140:143], v[148:163]
  v_mfma_f32_32x32x16_bf16 v[164:179], v[132:135], v[144:147], v[164:179]
  s_barrier
  ds_read_b64_tr_b16 v[116:117], v110 offset:49152
  ds_read_b64_tr_b16 v[118:119], v110 offset:50176
  ds_read_b128 v[124:127], v106 offset:32768
  ds_read_b128 v[128:131], v106 offset:36864
  ds_read_b64_tr_b16 v[120:121], v111 offset:49152
  ds_read_b64_tr_b16 v[122:123], v111 offset:50176
  v_mfma_f32_32x32x16_bf16 v[180:195], v[136:139], v[140:143], v[180:195]
  v_mfma_f32_32x32x16_bf16 v[196:211], v[136:139], v[144:147], v[196:211]
  s_waitcnt lgkmcnt(0)
  v_mfma_f32_32x32x16_bf16 v[148:163], v[116:119], v[124:127], v[148:163]
  ds_read_b64_tr_b16 v[132:133], v110 offset:53248
  ds_read_b64_tr_b16 v[134:135], v110 offset:54272
  v_mfma_f32_32x32x16_bf16 v[164:179], v[116:119], v[128:131], v[164:179]
  ds_read_b128 v[140:143], v107 offset:32768
  ds_read_b128 v[144:147], v107 offset:36864
  v_mfma_f32_32x32x16_bf16 v[180:195], v[120:123], v[124:127], v[180:195]
  ds_read_b64_tr_b16 v[136:137], v111 offset:53248
  ds_read_b64_tr_b16 v[138:139], v111 offset:54272
  v_mfma_f32_32x32x16_bf16 v[196:211], v[120:123], v[128:131], v[196:211]
  s_waitcnt lgkmcnt(0)
  v_mfma_f32_32x32x16_bf16 v[148:163], v[132:135], v[140:143], v[148:163]
  ds_read_b64_tr_b16 v[116:117], v110 offset:57344
  ds_read_b64_tr_b16 v[118:119], v110 offset:58368
  v_mfma_f32_32x32x16_bf16 v[164:179], v[132:135], v[144:147], v[164:179]
  ds_read_b128 v[124:127], v108 offset:32768
  ds_read_b128 v[128:131], v108 offset:36864
  v_mfma_f32_32x32x16_bf16 v[180:195], v[136:139], v[140:143], v[180:195]
  ds_read_b64_tr_b16 v[120:121], v111 offset:57344
  ds_read_b64_tr_b16 v[122:123], v111 offset:58368
  v_mfma_f32_32x32x16_bf16 v[196:211], v[136:139], v[144:147], v[196:211]
  s_waitcnt lgkmcnt(0)
  v_mfma_f32_32x32x16_bf16 v[148:163], v[116:119], v[124:127], v[148:163]
  ds_read_b64_tr_b16 v[132:133], v110 offset:61440
  ds_read_b64_tr_b16 v[134:135], v110 offset:62464
  v_mfma_f32_32x32x16_bf16 v[164:179], v[116:119], v[128:131], v[164:179]
  ds_read_b128 v[140:143], v109 offset:32768
  ds_read_b128 v[144:147], v109 offset:36864
  v_mfma_f32_32x32x16_bf16 v[180:195], v[120:123], v[124:127], v[180:195]
  ds_read_b64_tr_b16 v[136:137], v111 offset:61440
  ds_read_b64_tr_b16 v[138:139], v111 offset:62464
  v_mfma_f32_32x32x16_bf16 v[196:211], v[120:123], v[128:131], v[196:211]
  s_waitcnt lgkmcnt(0)
  v_mfma_f32_32x32x16_bf16 v[148:163], v[132:135], v[140:143], v[148:163]
  v_mfma_f32_32x32x16_bf16 v[164:179], v[132:135], v[144:147], v[164:179]
  s_barrier
  ds_read_b64_tr_b16 v[116:117], v104 offset:16384
  ds_read_b64_tr_b16 v[118:119], v104 offset:17408
  ds_read_b128 v[124:127], v100 offset:0
  ds_read_b128 v[128:131], v100 offset:4096
  ds_read_b64_tr_b16 v[120:121], v105 offset:16384
  ds_read_b64_tr_b16 v[122:123], v105 offset:17408
  v_mfma_f32_32x32x16_bf16 v[180:195], v[136:139], v[140:143], v[180:195]
  v_mfma_f32_32x32x16_bf16 v[196:211], v[136:139], v[144:147], v[196:211]
  s_waitcnt lgkmcnt(0)
  v_mfma_f32_32x32x16_bf16 v[148:163], v[116:119], v[124:127], v[148:163]
  ds_read_b64_tr_b16 v[132:133], v104 offset:20480
  ds_read_b64_tr_b16 v[134:135], v104 offset:21504
  v_mfma_f32_32x32x16_bf16 v[164:179], v[116:119], v[128:131], v[164:179]
  ds_read_b128 v[140:143], v101 offset:0
  ds_read_b128 v[144:147], v101 offset:4096
  v_mfma_f32_32x32x16_bf16 v[180:195], v[120:123], v[124:127], v[180:195]
  ds_read_b64_tr_b16 v[136:137], v105 offset:20480
  ds_read_b64_tr_b16 v[138:139], v105 offset:21504
  v_mfma_f32_32x32x16_bf16 v[196:211], v[120:123], v[128:131], v[196:211]
  s_waitcnt lgkmcnt(0)
  v_mfma_f32_32x32x16_bf16 v[148:163], v[132:135], v[140:143], v[148:163]
  ds_read_b64_tr_b16 v[116:117], v104 offset:24576
  ds_read_b64_tr_b16 v[118:119], v104 offset:25600
  v_mfma_f32_32x32x16_bf16 v[164:179], v[132:135], v[144:147], v[164:179]
  ds_read_b128 v[124:127], v102 offset:0
  ds_read_b128 v[128:131], v102 offset:4096
  v_mfma_f32_32x32x16_bf16 v[180:195], v[136:139], v[140:143], v[180:195]
  ds_read_b64_tr_b16 v[120:121], v105 offset:24576
  ds_read_b64_tr_b16 v[122:123], v105 offset:25600
  v_mfma_f32_32x32x16_bf16 v[196:211], v[136:139], v[144:147], v[196:211]
  s_waitcnt lgkmcnt(0)
  v_mfma_f32_32x32x16_bf16 v[148:163], v[116:119], v[124:127], v[148:163]
  ds_read_b64_tr_b16 v[132:133], v104 offset:28672
  ds_read_b64_tr_b16 v[134:135], v104 offset:29696
  v_mfma_f32_32x32x16_bf16 v[164:179], v[116:119], v[128:131], v[164:179]
  ds_read_b128 v[140:143], v103 offset:0
  ds_read_b128 v[144:147], v103 offset:4096
  v_mfma_f32_32x32x16_bf16 v[180:195], v[120:123], v[124:127], v[180:195]
  ds_read_b64_tr_b16 v[136:137], v105 offset:28672
  ds_read_b64_tr_b16 v[138:139], v105 offset:29696
  v_mfma_f32_32x32x16_bf16 v[196:211], v[120:123], v[128:131], v[196:211]
  s_waitcnt lgkmcnt(0)
  v_mfma_f32_32x32x16_bf16 v[148:163], v[132:135], v[140:143], v[148:163]
  v_mfma_f32_32x32x16_bf16 v[164:179], v[132:135], v[144:147], v[164:179]
  s_barrier
  ds_read_b64_tr_b16 v[116:117], v104 offset:49152
  ds_read_b64_tr_b16 v[118:119], v104 offset:50176
  ds_read_b128 v[124:127], v100 offset:32768
  ds_read_b128 v[128:131], v100 offset:36864
  ds_read_b64_tr_b16 v[120:121], v105 offset:49152
  ds_read_b64_tr_b16 v[122:123], v105 offset:50176
  v_mfma_f32_32x32x16_bf16 v[180:195], v[136:139], v[140:143], v[180:195]
  v_mfma_f32_32x32x16_bf16 v[196:211], v[136:139], v[144:147], v[196:211]
  s_waitcnt lgkmcnt(0)
  v_mfma_f32_32x32x16_bf16 v[148:163], v[116:119], v[124:127], v[148:163]
  ds_read_b64_tr_b16 v[132:133], v104 offset:53248
  ds_read_b64_tr_b16 v[134:135], v104 offset:54272
  v_mfma_f32_32x32x16_bf16 v[164:179], v[116:119], v[128:131], v[164:179]
  ds_read_b128 v[140:143], v101 offset:32768
  ds_read_b128 v[144:147], v101 offset:36864
  v_mfma_f32_32x32x16_bf16 v[180:195], v[120:123], v[124:127], v[180:195]
  ds_read_b64_tr_b16 v[136:137], v105 offset:53248
  ds_read_b64_tr_b16 v[138:139], v105 offset:54272
  v_mfma_f32_32x32x16_bf16 v[196:211], v[120:123], v[128:131], v[196:211]
  s_waitcnt lgkmcnt(0)
  v_mfma_f32_32x32x16_bf16 v[148:163], v[132:135], v[140:143], v[148:163]
  ds_read_b64_tr_b16 v[116:117], v104 offset:57344
  ds_read_b64_tr_b16 v[118:119], v104 offset:58368
  v_mfma_f32_32x32x16_bf16 v[164:179], v[132:135], v[144:147], v[164:179]
  ds_read_b128 v[124:127], v102 offset:32768
  ds_read_b128 v[128:131], v102 offset:36864
  v_mfma_f32_32x32x16_bf16 v[180:195], v[136:139], v[140:143], v[180:195]
  ds_read_b64_tr_b16 v[120:121], v105 offset:57344
  ds_read_b64_tr_b16 v[122:123], v105 offset:58368
  v_mfma_f32_32x32x16_bf16 v[196:211], v[136:139], v[144:147], v[196:211]
  s_waitcnt lgkmcnt(0)
  v_mfma_f32_32x32x16_bf16 v[148:163], v[116:119], v[124:127], v[148:163]
  ds_read_b64_tr_b16 v[132:133], v104 offset:61440
  ds_read_b64_tr_b16 v[134:135], v104 offset:62464
  v_mfma_f32_32x32x16_bf16 v[164:179], v[116:119], v[128:131], v[164:179]
  ds_read_b128 v[140:143], v103 offset:32768
  ds_read_b128 v[144:147], v103 offset:36864
  v_mfma_f32_32x32x16_bf16 v[180:195], v[120:123], v[124:127], v[180:195]
  ds_read_b64_tr_b16 v[136:137], v105 offset:61440
  ds_read_b64_tr_b16 v[138:139], v105 offset:62464
  v_mfma_f32_32x32x16_bf16 v[196:211], v[120:123], v[128:131], v[196:211]
  s_waitcnt lgkmcnt(0)
  v_mfma_f32_32x32x16_bf16 v[148:163], v[132:135], v[140:143], v[148:163]
  v_mfma_f32_32x32x16_bf16 v[164:179], v[132:135], v[144:147], v[164:179]
  v_mfma_f32_32x32x16_bf16 v[180:195], v[136:139], v[140:143], v[180:195]
  v_mfma_f32_32x32x16_bf16 v[196:211], v[136:139], v[144:147], v[196:211]
  s_mov_b32 s4, 1051011932
  s_cmp_ge_u32 s48, 5
  s_cselect_b32 s4, 1.0, s4
  s_mov_b32 s5, s4
  s_nop 7
  s_cmp_ge_u32 s48, 5
  s_cbranch_scc1 L_noq_13
  v_pk_mul_f32 v[148:149], v[148:149], s[4:5]
  v_pk_mul_f32 v[150:151], v[150:151], s[4:5]
  v_pk_mul_f32 v[152:153], v[152:153], s[4:5]
  v_pk_mul_f32 v[154:155], v[154:155], s[4:5]
  v_pk_mul_f32 v[156:157], v[156:157], s[4:5]
  v_pk_mul_f32 v[158:159], v[158:159], s[4:5]
  v_pk_mul_f32 v[160:161], v[160:161], s[4:5]
  v_pk_mul_f32 v[162:163], v[162:163], s[4:5]
  v_pk_mul_f32 v[164:165], v[164:165], s[4:5]
  v_pk_mul_f32 v[166:167], v[166:167], s[4:5]
  v_pk_mul_f32 v[168:169], v[168:169], s[4:5]
  v_pk_mul_f32 v[170:171], v[170:171], s[4:5]
  v_pk_mul_f32 v[172:173], v[172:173], s[4:5]
  v_pk_mul_f32 v[174:175], v[174:175], s[4:5]
  v_pk_mul_f32 v[176:177], v[176:177], s[4:5]
  v_pk_mul_f32 v[178:179], v[178:179], s[4:5]
  v_pk_mul_f32 v[180:181], v[180:181], s[4:5]
  v_pk_mul_f32 v[182:183], v[182:183], s[4:5]
  v_pk_mul_f32 v[184:185], v[184:185], s[4:5]
  v_pk_mul_f32 v[186:187], v[186:187], s[4:5]
  v_pk_mul_f32 v[188:189], v[188:189], s[4:5]
  v_pk_mul_f32 v[190:191], v[190:191], s[4:5]
  v_pk_mul_f32 v[192:193], v[192:193], s[4:5]
  v_pk_mul_f32 v[194:195], v[194:195], s[4:5]
  v_pk_mul_f32 v[196:197], v[196:197], s[4:5]
  v_pk_mul_f32 v[198:199], v[198:199], s[4:5]
  v_pk_mul_f32 v[200:201], v[200:201], s[4:5]
  v_pk_mul_f32 v[202:203], v[202:203], s[4:5]
  v_pk_mul_f32 v[204:205], v[204:205], s[4:5]
  v_pk_mul_f32 v[206:207], v[206:207], s[4:5]
  v_pk_mul_f32 v[208:209], v[208:209], s[4:5]
  v_pk_mul_f32 v[210:211], v[210:211], s[4:5]
L_noq_13:
  v_cvt_pk_bf16_f32 v116, v148, v149
  v_cvt_pk_bf16_f32 v117, v150, v151
  v_cvt_pk_bf16_f32 v118, v152, v153
  v_cvt_pk_bf16_f32 v119, v154, v155
  s_add_u32 s6, s18, 0
  s_nop 0
  v_permlane32_swap_b32 v116, v118
  v_permlane32_swap_b32 v117, v119
  buffer_store_dwordx4 v[116:119], v112, s[36:39], s6 offen offset:0 sc1
  v_cvt_pk_bf16_f32 v120, v156, v157
  v_cvt_pk_bf16_f32 v121, v158, v159
  v_cvt_pk_bf16_f32 v122, v160, v161
  v_cvt_pk_bf16_f32 v123, v162, v163
  s_add_u32 s6, s18, 65536
  s_nop 0
  v_permlane32_swap_b32 v120, v122
  v_permlane32_swap_b32 v121, v123
  buffer_store_dwordx4 v[120:123], v112, s[36:39], s6 offen offset:0 sc1
  v_cvt_pk_bf16_f32 v124, v164, v165
  v_cvt_pk_bf16_f32 v125, v166, v167
  v_cvt_pk_bf16_f32 v126, v168, v169
  v_cvt_pk_bf16_f32 v127, v170, v171
  s_add_u32 s6, s18, 0
  s_nop 0
  v_permlane32_swap_b32 v124, v126
  v_permlane32_swap_b32 v125, v127
  buffer_store_dwordx4 v[124:127], v112, s[36:39], s6 offen offset:512 sc1
  v_cvt_pk_bf16_f32 v128, v172, v173
  v_cvt_pk_bf16_f32 v129, v174, v175
  v_cvt_pk_bf16_f32 v130, v176, v177
  v_cvt_pk_bf16_f32 v131, v178, v179
  s_add_u32 s6, s18, 65536
  s_nop 0
  v_permlane32_swap_b32 v128, v130
  v_permlane32_swap_b32 v129, v131
  buffer_store_dwordx4 v[128:131], v112, s[36:39], s6 offen offset:512 sc1
  v_cvt_pk_bf16_f32 v132, v180, v181
  v_cvt_pk_bf16_f32 v133, v182, v183
  v_cvt_pk_bf16_f32 v134, v184, v185
  v_cvt_pk_bf16_f32 v135, v186, v187
  s_add_u32 s6, s18, 131072
  s_nop 0
  v_permlane32_swap_b32 v132, v134
  v_permlane32_swap_b32 v133, v135
  buffer_store_dwordx4 v[132:135], v112, s[36:39], s6 offen offset:0 sc1
  v_cvt_pk_bf16_f32 v136, v188, v189
  v_cvt_pk_bf16_f32 v137, v190, v191
  v_cvt_pk_bf16_f32 v138, v192, v193
  v_cvt_pk_bf16_f32 v139, v194, v195
  s_add_u32 s6, s18, 196608
  s_nop 0
  v_permlane32_swap_b32 v136, v138
  v_permlane32_swap_b32 v137, v139
  buffer_store_dwordx4 v[136:139], v112, s[36:39], s6 offen offset:0 sc1
  v_cvt_pk_bf16_f32 v140, v196, v197
  v_cvt_pk_bf16_f32 v141, v198, v199
  v_cvt_pk_bf16_f32 v142, v200, v201
  v_cvt_pk_bf16_f32 v143, v202, v203
  s_add_u32 s6, s18, 131072
  s_nop 0
  v_permlane32_swap_b32 v140, v142
  v_permlane32_swap_b32 v141, v143
  buffer_store_dwordx4 v[140:143], v112, s[36:39], s6 offen offset:512 sc1
  v_cvt_pk_bf16_f32 v144, v204, v205
  v_cvt_pk_bf16_f32 v145, v206, v207
  v_cvt_pk_bf16_f32 v146, v208, v209
  v_cvt_pk_bf16_f32 v147, v210, v211
  s_add_u32 s6, s18, 196608
  s_nop 0
  v_permlane32_swap_b32 v144, v146
  v_permlane32_swap_b32 v145, v147
  buffer_store_dwordx4 v[144:147], v112, s[36:39], s6 offen offset:512 sc1
  s_waitcnt vmcnt(0)
  s_barrier
  s_mov_b64 exec, 1
  v_mov_b32 v4, 0
L_nf_14:
  buffer_load_dwordx2 v[6:7], v4, s[40:43], 0 offen sc1
  s_waitcnt vmcnt(0)
  v_cmp_eq_u32 vcc, 0, v6
  s_cbranch_vccnz L_nf_14
L_nff_15:
  v_readfirstlane_b32 s58, v6
  v_readfirstlane_b32 s59, v7
  s_mov_b64 exec, -1
L_barB:
  s_barrier
  buffer_load_dwordx4 v[100:103], v13, s[36:39], 0 offen sc1
  buffer_load_dwordx4 v[104:107], v14, s[36:39], 0 offen sc1
  s_cmp_eq_u32 s49, 1
  s_cselect_b32 s47, 1, 0
  s_cbranch_scc0 L_nj_16
  s_lshl_b32 s48, s52, 10
  s_add_u32 s48, s48, 512
  v_subrev_u32 v4, s48, v13
  v_subrev_u32 v5, s48, v14
  buffer_load_dwordx4 v[204:207], v4, s[36:39], 0 offen sc1
  buffer_load_dwordx4 v[208:211], v5, s[36:39], 0 offen sc1
L_nj_16:
  s_add_u32 s4, s62, 2048
  s_cmp_eq_u32 s62, 31040
  s_cselect_b32 m0, 64128, s4
  s_nop 0
  buffer_load_dwordx4 v17, s[36:39], s66 offen sc1 lds
  s_add_u32 s4, s63, 2048
  s_cmp_eq_u32 s63, 31040
  s_cselect_b32 m0, 64128, s4
  s_nop 0
  buffer_load_dwordx4 v17, s[36:39], s67 offen sc1 lds
  s_add_u32 s4, s64, 2048
  s_cmp_eq_u32 s64, 31040
  s_cselect_b32 m0, 64128, s4
  s_nop 0
  buffer_load_dwordx4 v17, s[36:39], s68 offen sc1 lds
  s_add_u32 s4, s65, 2048
  s_cmp_eq_u32 s65, 31040
  s_cselect_b32 m0, 64128, s4
  s_nop 0
  buffer_load_dwordx4 v17, s[36:39], s69 offen sc1 lds
  s_mov_b32 s10, s100
  s_and_b32 s12, s46, 3
  s_lshl_b32 s12, s12, 10
  s_cmp_eq_u32 s3, 0
  s_cselect_b32 s13, 8, 0
  v_mov_b32 v116, 0
  v_mov_b32 v117, 0
  v_mov_b32 v118, 0
  v_mov_b32 v119, 0
  v_mov_b32 v120, 0
  v_mov_b32 v121, 0
  v_mov_b32 v122, 0
  v_mov_b32 v123, 0
  v_mov_b32 v124, 0
  v_mov_b32 v125, 0
  v_mov_b32 v126, 0
  v_mov_b32 v127, 0
  v_mov_b32 v128, 0
  v_mov_b32 v129, 0
  v_mov_b32 v130, 0
  v_mov_b32 v131, 0
  s_mov_b32 s8, 0
  s_mov_b32 s9, 0
  s_waitcnt vmcnt(4)
  s_cmp_eq_u32 s51, 0
  s_cselect_b32 s4, -1, 0
  s_cselect_b32 s5, 0, -1
  v_and_b32 v104, s4, v104
  v_and_b32 v105, s4, v105
  v_and_b32 v106, s5, v106
  v_and_b32 v107, s5, v107
  v_cndmask_b32 v108, v104, 0, s[60:61]
  v_cndmask_b32 v109, v105, 0, s[60:61]
  v_cndmask_b32 v106, v106, 0, s[60:61]
  v_cndmask_b32 v107, v107, 0, s[60:61]
  v_mov_b32 v104, v108
  v_mov_b32 v105, v109
  s_cmp_eq_u32 s47, 0
  s_cbranch_scc1 L_mt_17
  v_mov_b32 v40, 0xff800000
  v_mov_b32 v41, 0xff800000
  v_mov_b32 v42, 0xff800000
  v_mov_b32 v43, 0xff800000
  v_mov_b32 v44, 0xff800000
  v_mov_b32 v45, 0xff800000
  v_mov_b32 v46, 0xff800000
  v_mov_b32 v47, 0xff800000
  v_mov_b32 v48, 0xff800000
  v_mov_b32 v49, 0xff800000
  v_mov_b32 v50, 0xff800000
  v_mov_b32 v51, 0xff800000
  v_mov_b32 v52, 0xff800000
  v_mov_b32 v53, 0xff800000
  v_mov_b32 v54, 0xff800000
  v_mov_b32 v55, 0xff800000
  s_cmp_eq_u32 s51, 0
  s_cselect_b32 s4, -1, 0
  s_cselect_b32 s5, 0, -1
  v_and_b32 v208, s4, v208
  v_and_b32 v209, s4, v209
  v_and_b32 v210, s5, v210
  v_and_b32 v211, s5, v211
  v_cndmask_b32 v98, v208, 0, s[60:61]
  v_cndmask_b32 v99, v209, 0, s[60:61]
  v_cndmask_b32 v210, v210, 0, s[60:61]
  v_cndmask_b32 v211, v211, 0, s[60:61]
  v_mov_b32 v208, v98
  v_mov_b32 v209, v99
  s_cmp_eq_u32 s52, 3
  s_cselect_b32 s4, 512, 0
  s_cselect_b32 s6, -1, 0
  s_sub_u32 s4, s48, s4
  v_mov_b32 v4, s4
  v_cmp_gt_u32 vcc, 65536, v12
  v_subrev_u32 v94, s4, v10
  v_cndmask_b32 v5, v4, 0, s[60:61]
  v_sub_u32 v95, v11, v5
  v_cndmask_b32 v5, 0, v4, vcc
  v_sub_u32 v96, v12, v5
  v_and_b32 v72, s6, v24
  v_and_b32 v73, s6, v25
  v_and_b32 v74, s6, v26
  v_and_b32 v75, s6, v27
  v_and_b32 v76, s6, v28
  v_and_b32 v77, s6, v29
  v_and_b32 v78, s6, v30
  v_and_b32 v79, s6, v31
  v_and_b32 v80, s6, v32
  v_and_b32 v81, s6, v33
  v_and_b32 v82, s6, v34
  v_and_b32 v83, s6, v35
  v_and_b32 v84, s6, v36
  v_and_b32 v85, s6, v37
  v_and_b32 v86, s6, v38
  v_and_b32 v87, s6, v39
L_mt_17:
  s_waitcnt vmcnt(0)
  s_add_u32 m0, s62, 33088
  s_add_u32 s4, s66, 2621440
  buffer_load_dwordx4 v17, s[36:39], s4 offen sc1 lds
  s_add_u32 m0, s63, 33088
  s_add_u32 s4, s67, 2621440
  buffer_load_dwordx4 v17, s[36:39], s4 offen sc1 lds
  s_add_u32 m0, s64, 33088
  s_add_u32 s4, s68, 2621440
  buffer_load_dwordx4 v17, s[36:39], s4 offen sc1 lds
  s_add_u32 m0, s65, 33088
  s_add_u32 s4, s69, 2621440
  buffer_load_dwordx4 v17, s[36:39], s4 offen sc1 lds
  s_barrier
L_job:
  ds_read_b128 v[172:175], v10 offset:3584
  ds_read_b128 v[176:179], v11 offset:3584
  s_waitcnt lgkmcnt(0)
  v_mfma_f32_32x32x16_bf16 v[116:131], v[172:175], v[100:103], v[116:131]
  v_mfma_f32_32x32x16_bf16 v[116:131], v[176:179], v[104:107], v[116:131]
  ds_read_b128 v[180:183], v10 offset:4096
  ds_read_b128 v[184:187], v11 offset:4096
  ds_read_b128 v[236:239], v10 offset:0
  ds_read_b128 v[240:243], v11 offset:0
  s_nop 7
  v_max3_f32 v110, v116, v117, v118
  v_max_f32 v110, v110, v119
  v_max3_f32 v110, v110, v120, v121
  v_max3_f32 v110, v110, v122, v123
  v_max3_f32 v110, v110, v124, v125
  v_max3_f32 v110, v110, v126, v127
  v_max3_f32 v110, v110, v128, v129
  v_max3_f32 v110, v110, v130, v131
L_set:
  ds_read_b128 v[172:175], v10 offset:3072
  ds_read_b128 v[176:179], v11 offset:3072
  v_mov_b32 v111, v110
  s_nop 1
  v_permlane32_swap_b32 v110, v111
  s_nop 0
  v_max_f32 v110, v110, v111
  v_cvt_pk_bf16_f32 v111, 0, -v110
  v_sub_f32 v112, -v110, v111
  v_cvt_pk_bf16_f32 v113, 0, v112
  v_sub_f32 v112, v112, v113
  v_cvt_pk_bf16_f32 v111, v111, v113
  v_cvt_pk_bf16_f32 v112, v112, 0
  v_cndmask_b32 v104, v108, v111, s[60:61]
  v_cndmask_b32 v105, v109, v112, s[60:61]
  v_sub_f32 v116, v116, v110
  v_sub_f32 v117, v117, v110
  s_waitcnt lgkmcnt(4)
  v_mfma_f32_32x32x16_bf16 v[132:147], v[180:183], v[100:103], v[24:39]
  v_sub_f32 v118, v118, v110
  v_sub_f32 v119, v119, v110
  v_sub_f32 v120, v120, v110
  v_sub_f32 v121, v121, v110
  v_sub_f32 v122, v122, v110
  v_sub_f32 v123, v123, v110
  v_sub_f32 v124, v124, v110
  v_sub_f32 v125, v125, v110
  v_sub_f32 v126, v126, v110
  v_sub_f32 v127, v127, v110
  v_sub_f32 v128, v128, v110
  v_sub_f32 v129, v129, v110
  v_sub_f32 v130, v130, v110
  v_sub_f32 v131, v131, v110
  v_mfma_f32_32x32x16_bf16 v[132:147], v[184:187], v[104:107], v[132:147]
  v_exp_f32 v116, v116
  v_exp_f32 v117, v117
  v_exp_f32 v118, v118
  v_exp_f32 v119, v119
  s_waitcnt lgkmcnt(2)
  v_mfma_f32_32x32x16_bf16 v[220:235], v[236:239], v[100:103], v[40:55]
  v_exp_f32 v120, v120
  v_exp_f32 v121, v121
  v_exp_f32 v122, v122
  v_exp_f32 v123, v123
  s_cmp_eq_u32 s9, 1
  s_cbranch_scc1 L_c2_18
  s_cmp_eq_u32 s47, 1
  s_cbranch_scc0 L_c2_18w
  ds_read_b128 v[188:191], v94 offset:3584
  ds_read_b128 v[192:195], v95 offset:3584
  s_waitcnt lgkmcnt(0)
  v_mfma_f32_32x32x16_bf16 v[72:87], v[188:191], v[204:207], v[72:87]
  v_mfma_f32_32x32x16_bf16 v[72:87], v[192:195], v[208:211], v[72:87]
  s_nop 7
  s_nop 3
  v_max3_f32 v97, v72, v73, v74
  v_max_f32 v97, v97, v75
  v_max3_f32 v97, v97, v76, v77
  v_max3_f32 v97, v97, v78, v79
  v_max3_f32 v97, v97, v80, v81
  v_max3_f32 v97, v97, v82, v83
  v_max3_f32 v97, v97, v84, v85
  v_max3_f32 v97, v97, v86, v87
  v_mov_b32 v111, v97
  s_nop 1
  v_permlane32_swap_b32 v97, v111
  s_nop 0
  v_max_f32 v97, v97, v111
  v_cvt_pk_bf16_f32 v111, 0, -v97
  v_sub_f32 v112, -v97, v111
  v_cvt_pk_bf16_f32 v113, 0, v112
  v_sub_f32 v112, v112, v113
  v_cvt_pk_bf16_f32 v111, v111, v113
  v_cvt_pk_bf16_f32 v112, v112, 0
  v_cndmask_b32 v208, v98, v111, s[60:61]
  v_cndmask_b32 v209, v99, v112, s[60:61]
L_c2_18w:
  s_waitcnt vmcnt(0)
  s_barrier
L_c2_18:
  ds_read_b64_tr_b16 v[188:189], v12 offset:3584
  ds_read_b64_tr_b16 v[190:191], v12 offset:3712
  ds_read_b64_tr_b16 v[192:193], v12 offset:3840
  ds_read_b64_tr_b16 v[194:195], v12 offset:3968
  v_mfma_f32_32x32x16_bf16 v[220:235], v[240:243], v[104:107], v[220:235]
  v_cvt_pk_bf16_f32 v164, v116, v117
  v_cvt_pk_bf16_f32 v165, v118, v119
  v_cvt_pk_bf16_f32 v166, v120, v121
  v_cvt_pk_bf16_f32 v167, v122, v123
  v_exp_f32 v124, v124
  v_exp_f32 v125, v125
  v_exp_f32 v126, v126
  v_exp_f32 v127, v127
  ds_read_b64_tr_b16 v[196:197], v12 offset:4096
  ds_read_b64_tr_b16 v[198:199], v12 offset:4224
  ds_read_b64_tr_b16 v[200:201], v12 offset:4352
  ds_read_b64_tr_b16 v[202:203], v12 offset:4480
  s_waitcnt lgkmcnt(4)
  v_mfma_f32_32x32x16_bf16 v[148:163], v[188:191], v[164:167], 0
  v_exp_f32 v128, v128
  v_exp_f32 v129, v129
  v_exp_f32 v130, v130
  v_exp_f32 v131, v131
  v_cvt_pk_bf16_f32 v168, v124, v125
  v_cvt_pk_bf16_f32 v169, v126, v127
  v_cvt_pk_bf16_f32 v170, v128, v129
  v_cvt_pk_bf16_f32 v171, v130, v131
  s_cmp_eq_u32 s13, 0
  s_cbranch_scc1 L_ww_21
  s_and_b32 s5, s100, 3
  s_mul_i32 s5, s5, 204800
  s_mov_b32 m0, 64128
  s_bitcmp1_b32 s100, 2
  s_cbranch_scc1 L_ww_21
  buffer_load_dwordx4 v20, s[28:31], s5 offen lds
  buffer_load_dwordx4 v21, s[28:31], s5 offen lds
L_ww_21:
  s_cmp_eq_u32 s13, 0
  s_cbranch_scc1 L_ws_20
  s_mul_i32 s4, s10, 10240
  s_mul_i32 s5, s10, 102400
  s_add_u32 s4, s4, 70400
  s_add_u32 m0, s4, s12
  s_sub_u32 s13, s13, 1
  buffer_load_dwordx4 v18, s[28:31], s5 offen lds
  s_add_u32 m0, m0, 5120
  s_add_u32 s6, s5, 51200
  buffer_load_dwordx4 v18, s[28:31], s6 offen lds
  s_lshr_b32 s7, s12, 11
  s_xor_b32 s7, s7, s10
  s_add_u32 s10, s10, 1
  s_and_b32 s10, s10, 7
  s_bitcmp1_b32 s7, 0
  s_cbranch_scc1 L_wp_22
  s_bitcmp1_b32 s46, 0
  s_cselect_b32 s5, s6, s5
  s_cselect_b32 s6, 5120, 0
  s_add_u32 s4, s4, 4096
  s_add_u32 m0, s4, s6
  s_nop 0
  buffer_load_dwordx4 v19, s[28:31], s5 offen lds
L_wp_22:
L_ws_20:
  s_nop 1
  v_mfma_f32_32x32x16_bf16 v[148:163], v[192:195], v[168:171], v[148:163]
  v_mfma_f32_32x32x16_bf16 v[116:131], v[172:175], v[100:103], 0
  ds_read_b64_tr_b16 v[180:181], v12 offset:0
  ds_read_b64_tr_b16 v[182:183], v12 offset:128
  ds_read_b64_tr_b16 v[184:185], v12 offset:256
  ds_read_b64_tr_b16 v[186:187], v12 offset:384
  v_max_f32 v132, v132, v220
  v_max_f32 v133, v133, v221
  v_max_f32 v134, v134, v222
  v_max_f32 v135, v135, v223
  v_max_f32 v136, v136, v224
  v_max_f32 v137, v137, v225
  v_max_f32 v138, v138, v226
  v_max_f32 v139, v139, v227
  v_exp_f32 v132, v132
  v_exp_f32 v133, v133
  v_exp_f32 v134, v134
  v_exp_f32 v135, v135
  v_mfma_f32_32x32x16_bf16 v[116:131], v[176:179], v[104:107], v[116:131]
  v_max_f32 v140, v140, v228
  v_max_f32 v141, v141, v229
  v_max_f32 v142, v142, v230
  v_max_f32 v143, v143, v231
  v_max_f32 v144, v144, v232
  v_max_f32 v145, v145, v233
  v_max_f32 v146, v146, v234
  v_max_f32 v147, v147, v235
  v_exp_f32 v136, v136
  v_exp_f32 v137, v137
  v_exp_f32 v138, v138
  v_exp_f32 v139, v139
  ds_read_b128 v[236:239], v10 offset:2560
  ds_read_b128 v[240:243], v11 offset:2560
  v_cvt_pk_bf16_f32 v164, v132, v133
  v_cvt_pk_bf16_f32 v165, v134, v135
  v_cvt_pk_bf16_f32 v166, v136, v137
  v_cvt_pk_bf16_f32 v167, v138, v139
  v_and_b32 v220, v244, v164
  v_xor_b32 v164, v220, v164
  v_and_b32 v221, v245, v165
  v_xor_b32 v165, v221, v165
  v_and_b32 v222, v246, v166
  v_xor_b32 v166, v222, v166
  v_and_b32 v223, v247, v167
  v_xor_b32 v167, v223, v167
  v_exp_f32 v140, v140
  v_exp_f32 v141, v141
  v_exp_f32 v142, v142
  v_exp_f32 v143, v143
  s_waitcnt lgkmcnt(2)
  v_mfma_f32_32x32x16_bf16 v[148:163], v[196:199], v[220:223], v[148:163]
  v_exp_f32 v144, v144
  v_exp_f32 v145, v145
  v_mfma_f32_32x32x16_bf16 v[148:163], v[180:183], v[164:167], v[148:163]
  v_exp_f32 v146, v146
  v_exp_f32 v147, v147
  ds_read_b64_tr_b16 v[188:189], v12 offset:3072
  ds_read_b64_tr_b16 v[190:191], v12 offset:3200
  ds_read_b64_tr_b16 v[192:193], v12 offset:3328
  ds_read_b64_tr_b16 v[194:195], v12 offset:3456
  v_cvt_pk_bf16_f32 v168, v140, v141
  v_cvt_pk_bf16_f32 v169, v142, v143
  v_cvt_pk_bf16_f32 v170, v144, v145
  v_cvt_pk_bf16_f32 v171, v146, v147
  v_and_b32 v224, v248, v168
  v_xor_b32 v168, v224, v168
  v_and_b32 v225, v249, v169
  v_xor_b32 v169, v225, v169
  v_and_b32 v226, v250, v170
  v_xor_b32 v170, v226, v170
  v_and_b32 v227, v251, v171
  v_xor_b32 v171, v227, v171
  s_cmp_eq_u32 s53, 1
  s_nop 0
  v_mfma_f32_32x32x16_bf16 v[148:163], v[200:203], v[224:227], v[148:163]
  v_mfma_f32_32x32x16_bf16 v[148:163], v[184:187], v[168:171], v[148:163]
  s_cbranch_scc1 L_tail
  s_waitcnt lgkmcnt(4)
  v_mfma_f32_32x32x16_bf16 v[132:147], v[236:239], v[100:103], 0
  v_exp_f32 v116, v116
  v_exp_f32 v117, v117
  v_exp_f32 v118, v118
  v_exp_f32 v119, v119
  v_mfma_f32_32x32x16_bf16 v[132:147], v[240:243], v[104:107], v[132:147]
  v_exp_f32 v120, v120
  v_exp_f32 v121, v121
  v_exp_f32 v122, v122
  v_exp_f32 v123, v123
  ds_read_b128 v[172:175], v10 offset:2048
  ds_read_b128 v[176:179], v11 offset:2048
  v_cvt_pk_bf16_f32 v164, v116, v117
  v_cvt_pk_bf16_f32 v165, v118, v119
  v_cvt_pk_bf16_f32 v166, v120, v121
  v_cvt_pk_bf16_f32 v167, v122, v123
  v_exp_f32 v124, v124
  v_exp_f32 v125, v125
  v_exp_f32 v126, v126
  v_exp_f32 v127, v127
  s_waitcnt lgkmcnt(2)
  v_mfma_f32_32x32x16_bf16 v[148:163], v[188:191], v[164:167], v[148:163]
  v_exp_f32 v128, v128
  v_exp_f32 v129, v129
  v_exp_f32 v130, v130
  v_exp_f32 v131, v131
  ds_read_b64_tr_b16 v[196:197], v12 offset:2560
  ds_read_b64_tr_b16 v[198:199], v12 offset:2688
  ds_read_b64_tr_b16 v[200:201], v12 offset:2816
  ds_read_b64_tr_b16 v[202:203], v12 offset:2944
  v_cvt_pk_bf16_f32 v168, v124, v125
  v_cvt_pk_bf16_f32 v169, v126, v127
  v_cvt_pk_bf16_f32 v170, v128, v129
  v_cvt_pk_bf16_f32 v171, v130, v131
  s_cmp_eq_u32 s73, 0
  s_cbranch_scc1 L_zs_24
  s_mov_b64 exec, 0xffff
  s_mov_b32 s4, 4096
  buffer_load_dwordx2 v[8:9], v59, s[36:39], s4 offen sc1
  s_mov_b64 exec, -1
L_zs_24:
  s_cmp_eq_u32 s13, 0
  s_cbranch_scc1 L_ws_25
  s_mul_i32 s4, s10, 10240
  s_mul_i32 s5, s10, 102400
  s_add_u32 s4, s4, 70400
  s_add_u32 m0, s4, s12
  s_sub_u32 s13, s13, 1
  buffer_load_dwordx4 v18, s[28:31], s5 offen lds
  s_add_u32 m0, m0, 5120
  s_add_u32 s6, s5, 51200
  buffer_load_dwordx4 v18, s[28:31], s6 offen lds
  s_lshr_b32 s7, s12, 11
  s_xor_b32 s7, s7, s10
  s_add_u32 s10, s10, 1
  s_and_b32 s10, s10, 7
  s_bitcmp1_b32 s7, 0
  s_cbranch_scc1 L_wp_26
  s_bitcmp1_b32 s46, 0
  s_cselect_b32 s5, s6, s5
  s_cselect_b32 s6, 5120, 0
  s_add_u32 s4, s4, 4096
  s_add_u32 m0, s4, s6
  s_nop 0
  buffer_load_dwordx4 v19, s[28:31], s5 offen lds
L_wp_26:
L_ws_25:
  s_cmp_eq_u32 s53, 2
  s_nop 0
  v_mfma_f32_32x32x16_bf16 v[148:163], v[192:195], v[168:171], v[148:163]
  s_cbranch_scc1 L_tail
  s_waitcnt lgkmcnt(4)
  v_mfma_f32_32x32x16_bf16 v[116:131], v[172:175], v[100:103], 0
  v_exp_f32 v132, v132
  v_exp_f32 v133, v133
  v_exp_f32 v134, v134
  v_exp_f32 v135, v135
  v_mfma_f32_32x32x16_bf16 v[116:131], v[176:179], v[104:107], v[116:131]
  v_exp_f32 v136, v136
  v_exp_f32 v137, v137
  v_exp_f32 v138, v138
  v_exp_f32 v139, v139
  ds_read_b128 v[236:239], v10 offset:1536
  ds_read_b128 v[240:243], v11 offset:1536
  v_cvt_pk_bf16_f32 v164, v132, v133
  v_cvt_pk_bf16_f32 v165, v134, v135
  v_cvt_pk_bf16_f32 v166, v136, v137
  v_cvt_pk_bf16_f32 v167, v138, v139
  v_exp_f32 v140, v140
  v_exp_f32 v141, v141
  v_exp_f32 v142, v142
  v_exp_f32 v143, v143
  s_waitcnt lgkmcnt(2)
  v_mfma_f32_32x32x16_bf16 v[148:163], v[196:199], v[164:167], v[148:163]
  v_exp_f32 v144, v144
  v_exp_f32 v145, v145
  v_exp_f32 v146, v146
  v_exp_f32 v147, v147
  ds_read_b64_tr_b16 v[188:189], v12 offset:2048
  ds_read_b64_tr_b16 v[190:191], v12 offset:2176
  ds_read_b64_tr_b16 v[192:193], v12 offset:2304
  ds_read_b64_tr_b16 v[194:195], v12 offset:2432
  v_cvt_pk_bf16_f32 v168, v140, v141
  v_cvt_pk_bf16_f32 v169, v142, v143
  v_cvt_pk_bf16_f32 v170, v144, v145
  v_cvt_pk_bf16_f32 v171, v146, v147
  s_cmp_eq_u32 s73, 0
  s_cbranch_scc1 L_zs_27
  s_mov_b64 exec, 0xffff
  s_waitcnt vmcnt(0)
  v_cmp_ne_u64 vcc, s[58:59], v[8:9]
  s_mov_b64 exec, -1
  s_cbranch_vccnz L_zs_27
  s_mov_b32 s101, 1
  s_and_b32 s5, s46, 3
  s_lshl_b32 s6, s5, 10
  s_add_u32 m0, s6, 152320
  s_mov_b32 s4, 11534336
  buffer_load_dwordx4 v57, s[36:39], s4 offen sc1 lds
  s_add_u32 m0, s6, 156416
  s_mov_b32 s4, 11534720
  buffer_load_dwordx4 v57, s[36:39], s4 offen sc1 lds
  s_lshl_b32 s6, s5, 8
  s_add_u32 m0, s6, 160512
  s_mov_b32 s4, 11534336
  s_mov_b64 exec, 0xffff
  buffer_load_dwordx4 v61, s[36:39], s4 offen sc1 lds
  s_mov_b64 exec, -1
L_zs_27:
  s_cmp_eq_u32 s3, 1
  s_cbranch_scc1 L_f0_28
  s_mov_b64 exec, 0xffff
  buffer_load_dwordx2 v[8:9], v70, s[36:39], 0 offen sc1
  s_mov_b64 exec, -1
L_f0_28:
  s_cmp_eq_u32 s13, 0
  s_cbranch_scc1 L_ws_29
  s_mul_i32 s4, s10, 10240
  s_mul_i32 s5, s10, 102400
  s_add_u32 s4, s4, 70400
  s_add_u32 m0, s4, s12
  s_sub_u32 s13, s13, 1
  buffer_load_dwordx4 v18, s[28:31], s5 offen lds
  s_add_u32 m0, m0, 5120
  s_add_u32 s6, s5, 51200
  buffer_load_dwordx4 v18, s[28:31], s6 offen lds
  s_lshr_b32 s7, s12, 11
  s_xor_b32 s7, s7, s10
  s_add_u32 s10, s10, 1
  s_and_b32 s10, s10, 7
  s_bitcmp1_b32 s7, 0
  s_cbranch_scc1 L_wp_30
  s_bitcmp1_b32 s46, 0
  s_cselect_b32 s5, s6, s5
  s_cselect_b32 s6, 5120, 0
  s_add_u32 s4, s4, 4096
  s_add_u32 m0, s4, s6
  s_nop 0
  buffer_load_dwordx4 v19, s[28:31], s5 offen lds
L_wp_30:
L_ws_29:
  s_cmp_eq_u32 s53, 3
  s_nop 0
  v_mfma_f32_32x32x16_bf16 v[148:163], v[200:203], v[168:171], v[148:163]
  s_cbranch_scc1 L_tail
  s_waitcnt lgkmcnt(4)
  v_mfma_f32_32x32x16_bf16 v[132:147], v[236:239], v[100:103], 0
  v_exp_f32 v116, v116
  v_exp_f32 v117, v117
  v_exp_f32 v118, v118
  v_exp_f32 v119, v119
  v_mfma_f32_32x32x16_bf16 v[132:147], v[240:243], v[104:107], v[132:147]
  v_exp_f32 v120, v120
  v_exp_f32 v121, v121
  v_exp_f32 v122, v122
  v_exp_f32 v123, v123
  ds_read_b128 v[172:175], v10 offset:1024
  ds_read_b128 v[176:179], v11 offset:1024
  v_cvt_pk_bf16_f32 v164, v116, v117
  v_cvt_pk_bf16_f32 v165, v118, v119
  v_cvt_pk_bf16_f32 v166, v120, v121
  v_cvt_pk_bf16_f32 v167, v122, v123
  v_exp_f32 v124, v124
  v_exp_f32 v125, v125
  v_exp_f32 v126, v126
  v_exp_f32 v127, v127
  s_waitcnt lgkmcnt(2)
  v_mfma_f32_32x32x16_bf16 v[148:163], v[188:191], v[164:167], v[148:163]
  v_exp_f32 v128, v128
  v_exp_f32 v129, v129
  v_exp_f32 v130, v130
  v_exp_f32 v131, v131
  ds_read_b64_tr_b16 v[196:197], v12 offset:1536
  ds_read_b64_tr_b16 v[198:199], v12 offset:1664
  ds_read_b64_tr_b16 v[200:201], v12 offset:1792
  ds_read_b64_tr_b16 v[202:203], v12 offset:1920
  v_cvt_pk_bf16_f32 v168, v124, v125
  v_cvt_pk_bf16_f32 v169, v126, v127
  v_cvt_pk_bf16_f32 v170, v128, v129
  v_cvt_pk_bf16_f32 v171, v130, v131
  s_cmp_eq_u32 s13, 0
  s_cbranch_scc1 L_ws_32
  s_mul_i32 s4, s10, 10240
  s_mul_i32 s5, s10, 102400
  s_add_u32 s4, s4, 70400
  s_add_u32 m0, s4, s12
  s_sub_u32 s13, s13, 1
  buffer_load_dwordx4 v18, s[28:31], s5 offen lds
  s_add_u32 m0, m0, 5120
  s_add_u32 s6, s5, 51200
  buffer_load_dwordx4 v18, s[28:31], s6 offen lds
  s_lshr_b32 s7, s12, 11
  s_xor_b32 s7, s7, s10
  s_add_u32 s10, s10, 1
  s_and_b32 s10, s10, 7
  s_bitcmp1_b32 s7, 0
  s_cbranch_scc1 L_wp_33
  s_bitcmp1_b32 s46, 0
  s_cselect_b32 s5, s6, s5
  s_cselect_b32 s6, 5120, 0
  s_add_u32 s4, s4, 4096
  s_add_u32 m0, s4, s6
  s_nop 0
  buffer_load_dwordx4 v19, s[28:31], s5 offen lds
L_wp_33:
  s_cmp_eq_u32 s13, 0
  s_cbranch_scc1 L_ws_32
  s_mul_i32 s4, s10, 10240
  s_mul_i32 s5, s10, 102400
  s_add_u32 s4, s4, 70400
  s_add_u32 m0, s4, s12
  s_sub_u32 s13, s13, 1
  buffer_load_dwordx4 v18, s[28:31], s5 offen lds
  s_add_u32 m0, m0, 5120
  s_add_u32 s6, s5, 51200
  buffer_load_dwordx4 v18, s[28:31], s6 offen lds
  s_lshr_b32 s7, s12, 11
  s_xor_b32 s7, s7, s10
  s_add_u32 s10, s10, 1
  s_and_b32 s10, s10, 7
  s_bitcmp1_b32 s7, 0
  s_cbranch_scc1 L_wp_34
  s_bitcmp1_b32 s46, 0
  s_cselect_b32 s5, s6, s5
  s_cselect_b32 s6, 5120, 0
  s_add_u32 s4, s4, 4096
  s_add_u32 m0, s4, s6
  s_nop 0
  buffer_load_dwordx4 v19, s[28:31], s5 offen lds
L_wp_34:
L_ws_32:
  s_cmp_eq_u32 s53, 4
  s_nop 0
  v_mfma_f32_32x32x16_bf16 v[148:163], v[192:195], v[168:171], v[148:163]
  s_cbranch_scc1 L_tail
  s_waitcnt lgkmcnt(4)
  v_mfma_f32_32x32x16_bf16 v[116:131], v[172:175], v[100:103], 0
  v_exp_f32 v132, v132
  v_exp_f32 v133, v133
  v_exp_f32 v134, v134
  v_exp_f32 v135, v135
  v_mfma_f32_32x32x16_bf16 v[116:131], v[176:179], v[104:107], v[116:131]
  v_exp_f32 v136, v136
  v_exp_f32 v137, v137
  v_exp_f32 v138, v138
  v_exp_f32 v139, v139
  ds_read_b128 v[236:239], v10 offset:512
  ds_read_b128 v[240:243], v11 offset:512
  v_cvt_pk_bf16_f32 v164, v132, v133
  v_cvt_pk_bf16_f32 v165, v134, v135
  v_cvt_pk_bf16_f32 v166, v136, v137
  v_cvt_pk_bf16_f32 v167, v138, v139
  v_exp_f32 v140, v140
  v_exp_f32 v141, v141
  v_exp_f32 v142, v142
  v_exp_f32 v143, v143
  s_waitcnt lgkmcnt(2)
  v_mfma_f32_32x32x16_bf16 v[148:163], v[196:199], v[164:167], v[148:163]
  v_exp_f32 v144, v144
  v_exp_f32 v145, v145
  v_exp_f32 v146, v146
  v_exp_f32 v147, v147
  ds_read_b64_tr_b16 v[188:189], v12 offset:1024
  ds_read_b64_tr_b16 v[190:191], v12 offset:1152
  ds_read_b64_tr_b16 v[192:193], v12 offset:1280
  ds_read_b64_tr_b16 v[194:195], v12 offset:1408
  v_cvt_pk_bf16_f32 v168, v140, v141
  v_cvt_pk_bf16_f32 v169, v142, v143
  v_cvt_pk_bf16_f32 v170, v144, v145
  v_cvt_pk_bf16_f32 v171, v146, v147
  s_cmp_eq_u32 s13, 0
  s_cbranch_scc1 L_ws_36
  s_mul_i32 s4, s10, 10240
  s_mul_i32 s5, s10, 102400
  s_add_u32 s4, s4, 70400
  s_add_u32 m0, s4, s12
  s_sub_u32 s13, s13, 1
  buffer_load_dwordx4 v18, s[28:31], s5 offen lds
  s_add_u32 m0, m0, 5120
  s_add_u32 s6, s5, 51200
  buffer_load_dwordx4 v18, s[28:31], s6 offen lds
  s_lshr_b32 s7, s12, 11
  s_xor_b32 s7, s7, s10
  s_add_u32 s10, s10, 1
  s_and_b32 s10, s10, 7
  s_bitcmp1_b32 s7, 0
  s_cbranch_scc1 L_wp_37
  s_bitcmp1_b32 s46, 0
  s_cselect_b32 s5, s6, s5
  s_cselect_b32 s6, 5120, 0
  s_add_u32 s4, s4, 4096
  s_add_u32 m0, s4, s6
  s_nop 0
  buffer_load_dwordx4 v19, s[28:31], s5 offen lds
L_wp_37:
  s_cmp_eq_u32 s13, 0
  s_cbranch_scc1 L_ws_36
  s_mul_i32 s4, s10, 10240
  s_mul_i32 s5, s10, 102400
  s_add_u32 s4, s4, 70400
  s_add_u32 m0, s4, s12
  s_sub_u32 s13, s13, 1
  buffer_load_dwordx4 v18, s[28:31], s5 offen lds
  s_add_u32 m0, m0, 5120
  s_add_u32 s6, s5, 51200
  buffer_load_dwordx4 v18, s[28:31], s6 offen lds
  s_lshr_b32 s7, s12, 11
  s_xor_b32 s7, s7, s10
  s_add_u32 s10, s10, 1
  s_and_b32 s10, s10, 7
  s_bitcmp1_b32 s7, 0
  s_cbranch_scc1 L_wp_38
  s_bitcmp1_b32 s46, 0
  s_cselect_b32 s5, s6, s5
  s_cselect_b32 s6, 5120, 0
  s_add_u32 s4, s4, 4096
  s_add_u32 m0, s4, s6
  s_nop 0
  buffer_load_dwordx4 v19, s[28:31], s5 offen lds
L_wp_38:
L_ws_36:
  s_cmp_eq_u32 s53, 5
  s_nop 0
  v_mfma_f32_32x32x16_bf16 v[148:163], v[200:203], v[168:171], v[148:163]
  s_cbranch_scc1 L_tail
  s_waitcnt lgkmcnt(4)
  v_mfma_f32_32x32x16_bf16 v[132:147], v[236:239], v[100:103], 0
  v_exp_f32 v116, v116
  v_exp_f32 v117, v117
  v_exp_f32 v118, v118
  v_exp_f32 v119, v119
  v_mfma_f32_32x32x16_bf16 v[132:147], v[240:243], v[104:107], v[132:147]
  v_exp_f32 v120, v120
  v_exp_f32 v121, v121
  v_exp_f32 v122, v122
  v_exp_f32 v123, v123
  v_cvt_pk_bf16_f32 v164, v116, v117
  v_cvt_pk_bf16_f32 v165, v118, v119
  v_cvt_pk_bf16_f32 v166, v120, v121
  v_cvt_pk_bf16_f32 v167, v122, v123
  v_exp_f32 v124, v124
  v_exp_f32 v125, v125
  v_exp_f32 v126, v126
  v_exp_f32 v127, v127
  s_waitcnt lgkmcnt(0)
  v_mfma_f32_32x32x16_bf16 v[148:163], v[188:191], v[164:167], v[148:163]
  v_exp_f32 v128, v128
  v_exp_f32 v129, v129
  v_exp_f32 v130, v130
  v_exp_f32 v131, v131
  ds_read_b64_tr_b16 v[196:197], v12 offset:512
  ds_read_b64_tr_b16 v[198:199], v12 offset:640
  ds_read_b64_tr_b16 v[200:201], v12 offset:768
  ds_read_b64_tr_b16 v[202:203], v12 offset:896
  v_cvt_pk_bf16_f32 v168, v124, v125
  v_cvt_pk_bf16_f32 v169, v126, v127
  v_cvt_pk_bf16_f32 v170, v128, v129
  v_cvt_pk_bf16_f32 v171, v130, v131
  s_cmp_eq_u32 s13, 0
  s_cbranch_scc1 L_ws_40
  s_mul_i32 s4, s10, 10240
  s_mul_i32 s5, s10, 102400
  s_add_u32 s4, s4, 70400
  s_add_u32 m0, s4, s12
  s_sub_u32 s13, s13, 1
  buffer_load_dwordx4 v18, s[28:31], s5 offen lds
  s_add_u32 m0, m0, 5120
  s_add_u32 s6, s5, 51200
  buffer_load_dwordx4 v18, s[28:31], s6 offen lds
  s_lshr_b32 s7, s12, 11
  s_xor_b32 s7, s7, s10
  s_add_u32 s10, s10, 1
  s_and_b32 s10, s10, 7
  s_bitcmp1_b32 s7, 0
  s_cbranch_scc1 L_wp_41
  s_bitcmp1_b32 s46, 0
  s_cselect_b32 s5, s6, s5
  s_cselect_b32 s6, 5120, 0
  s_add_u32 s4, s4, 4096
  s_add_u32 m0, s4, s6
  s_nop 0
  buffer_load_dwordx4 v19, s[28:31], s5 offen lds
L_wp_41:
L_ws_40:
  s_cmp_eq_u32 s53, 6
  s_nop 0
  v_mfma_f32_32x32x16_bf16 v[148:163], v[192:195], v[168:171], v[148:163]
  s_cbranch_scc1 L_tail
  v_exp_f32 v132, v132
  v_exp_f32 v133, v133
  v_exp_f32 v134, v134
  v_exp_f32 v135, v135
  v_exp_f32 v136, v136
  v_exp_f32 v137, v137
  v_exp_f32 v138, v138
  v_exp_f32 v139, v139
  v_cvt_pk_bf16_f32 v164, v132, v133
  v_cvt_pk_bf16_f32 v165, v134, v135
  v_cvt_pk_bf16_f32 v166, v136, v137
  v_cvt_pk_bf16_f32 v167, v138, v139
  v_exp_f32 v140, v140
  v_exp_f32 v141, v141
  v_exp_f32 v142, v142
  v_exp_f32 v143, v143
  s_waitcnt lgkmcnt(0)
  v_mfma_f32_32x32x16_bf16 v[148:163], v[196:199], v[164:167], v[148:163]
  v_exp_f32 v144, v144
  v_exp_f32 v145, v145
  v_exp_f32 v146, v146
  v_exp_f32 v147, v147
  v_cvt_pk_bf16_f32 v168, v140, v141
  v_cvt_pk_bf16_f32 v169, v142, v143
  v_cvt_pk_bf16_f32 v170, v144, v145
  v_cvt_pk_bf16_f32 v171, v146, v147
  s_nop 0
  s_nop 0
  v_mfma_f32_32x32x16_bf16 v[148:163], v[200:203], v[168:171], v[148:163]
L_tail:
  s_mov_b32 s9, 1
  s_cmp_eq_u32 s47, 1
  s_cbranch_scc1 L_wdone
L_wflush:
  s_cmp_eq_u32 s13, 0
  s_cbranch_scc1 L_wdone
  s_mul_i32 s4, s10, 10240
  s_mul_i32 s5, s10, 102400
  s_add_u32 s4, s4, 70400
  s_add_u32 m0, s4, s12
  s_sub_u32 s13, s13, 1
  buffer_load_dwordx4 v18, s[28:31], s5 offen lds
  s_add_u32 m0, m0, 5120
  s_add_u32 s6, s5, 51200
  buffer_load_dwordx4 v18, s[28:31], s6 offen lds
  s_lshr_b32 s7, s12, 11
  s_xor_b32 s7, s7, s10
  s_add_u32 s10, s10, 1
  s_and_b32 s10, s10, 7
  s_bitcmp1_b32 s7, 0
  s_cbranch_scc1 L_wp_43
  s_bitcmp1_b32 s46, 0
  s_cselect_b32 s5, s6, s5
  s_cselect_b32 s6, 5120, 0
  s_add_u32 s4, s4, 4096
  s_add_u32 m0, s4, s6
  s_nop 0
  buffer_load_dwordx4 v19, s[28:31], s5 offen lds
L_wp_43:
  s_branch L_wflush
L_wdone:
  s_waitcnt lgkmcnt(0)
  s_cmp_eq_u32 s47, 1
  s_cbranch_scc0 L_j2r_44
  ds_read_b128 v[180:183], v94 offset:4096
  ds_read_b128 v[184:187], v95 offset:4096
  ds_read_b128 v[172:175], v94 offset:3072
  ds_read_b128 v[176:179], v95 offset:3072
  ds_read_b64_tr_b16 v[188:189], v96 offset:3584
  ds_read_b64_tr_b16 v[190:191], v96 offset:3712
  ds_read_b64_tr_b16 v[192:193], v96 offset:3840
  ds_read_b64_tr_b16 v[194:195], v96 offset:3968
L_j2r_44:
  s_nop 5
  v_mov_b32 v111, v156
  v_mov_b32 v112, v156
  s_nop 1
  v_permlane32_swap_b32 v111, v112
  s_mov_b32 s4, 2071986176
  v_rcp_f32 v111, v112
  v_cmp_nlt_f32 vcc, v112, s4
  v_mov_b32 v114, 0x207
  v_mul_f32 v116, v111, v148
  v_mul_f32 v117, v111, v149
  v_mul_f32 v118, v111, v150
  v_mul_f32 v119, v111, v151
  v_mul_f32 v120, v111, v152
  v_mul_f32 v121, v111, v153
  v_mul_f32 v122, v111, v154
  v_mul_f32 v123, v111, v155
  v_mul_f32 v124, v111, v156
  v_mul_f32 v125, v111, v157
  v_mul_f32 v126, v111, v158
  v_mul_f32 v127, v111, v159
  v_add_f32 v113, v116, v117
  v_add_f32 v113, v113, v118
  v_add_f32 v113, v113, v119
  v_add_f32 v113, v113, v120
  v_add_f32 v113, v113, v121
  v_add_f32 v113, v113, v122
  v_add_f32 v113, v113, v123
  v_add_f32 v113, v113, v124
  v_add_f32 v113, v113, v125
  v_add_f32 v113, v113, v126
  v_add_f32 v113, v113, v127
  v_cmp_class_f32 s[4:5], v113, v114
  v_cvt_pk_bf16_f32 v164, v116, v117
  v_cvt_pk_bf16_f32 v165, v118, v119
  v_cvt_pk_bf16_f32 v166, v120, v121
  v_cvt_pk_bf16_f32 v167, v122, v123
  v_cvt_pk_bf16_f32 v168, v124, v125
  v_cvt_pk_bf16_f32 v169, v126, v127
  s_or_b64 vcc, vcc, s[4:5]
  s_cmp_eq_u32 s8, 1
  s_cbranch_scc1 L_out_45
  s_cbranch_vccnz L_slow
L_out_45:
  v_permlane32_swap_b32 v164, v166
  v_permlane32_swap_b32 v165, v167
  s_cmp_eq_u32 s47, 1
  s_cbranch_scc0 L_last
  s_mov_b32 s47, 2
  s_sub_u32 s53, 3, s52
  s_cmp_eq_u32 s53, 0
  s_cselect_b32 s8, 1, 0
  v_subrev_u32 v15, s48, v15
  s_lshr_b32 s4, s48, 1
  v_subrev_u32 v16, s4, v16
  v_mov_b32 v212, v164
  v_mov_b32 v213, v165
  v_mov_b32 v214, v166
  v_mov_b32 v215, v167
  v_mov_b32 v216, v168
  v_mov_b32 v217, v169
  s_waitcnt lgkmcnt(6)
  v_mfma_f32_32x32x16_bf16 v[132:147], v[180:183], v[204:207], v[24:39]
  v_sub_f32 v72, v72, v97
  v_sub_f32 v73, v73, v97
  v_sub_f32 v74, v74, v97
  v_sub_f32 v75, v75, v97
  v_sub_f32 v76, v76, v97
  v_sub_f32 v77, v77, v97
  v_sub_f32 v78, v78, v97
  v_sub_f32 v79, v79, v97
  v_sub_f32 v80, v80, v97
  v_sub_f32 v81, v81, v97
  v_sub_f32 v82, v82, v97
  v_sub_f32 v83, v83, v97
  v_sub_f32 v84, v84, v97
  v_sub_f32 v85, v85, v97
  v_sub_f32 v86, v86, v97
  v_sub_f32 v87, v87, v97
  v_mfma_f32_32x32x16_bf16 v[132:147], v[184:187], v[208:211], v[132:147]
  v_exp_f32 v72, v72
  v_exp_f32 v73, v73
  v_exp_f32 v74, v74
  v_exp_f32 v75, v75
  v_exp_f32 v76, v76
  v_exp_f32 v77, v77
  v_exp_f32 v78, v78
  v_exp_f32 v79, v79
  v_cvt_pk_bf16_f32 v164, v72, v73
  v_cvt_pk_bf16_f32 v165, v74, v75
  v_cvt_pk_bf16_f32 v166, v76, v77
  v_cvt_pk_bf16_f32 v167, v78, v79
  v_exp_f32 v80, v80
  v_exp_f32 v81, v81
  v_exp_f32 v82, v82
  v_exp_f32 v83, v83
  ds_read_b64_tr_b16 v[196:197], v96 offset:4096
  ds_read_b64_tr_b16 v[198:199], v96 offset:4224
  ds_read_b64_tr_b16 v[200:201], v96 offset:4352
  ds_read_b64_tr_b16 v[202:203], v96 offset:4480
  s_waitcnt lgkmcnt(4)
  v_mfma_f32_32x32x16_bf16 v[148:163], v[188:191], v[164:167], 0
  v_exp_f32 v84, v84
  v_exp_f32 v85, v85
  v_exp_f32 v86, v86
  v_exp_f32 v87, v87
  v_cvt_pk_bf16_f32 v168, v80, v81
  v_cvt_pk_bf16_f32 v169, v82, v83
  v_cvt_pk_bf16_f32 v170, v84, v85
  v_cvt_pk_bf16_f32 v171, v86, v87
  s_cmp_eq_u32 s3, 1
  s_cbranch_scc1 L_f0_46
  s_mov_b64 exec, 0xffff
  buffer_load_dwordx2 v[8:9], v70, s[36:39], 0 offen sc1
  s_mov_b64 exec, -1
L_f0_46:
  s_cmp_eq_u32 s13, 0
  s_cbranch_scc1 L_ws_47
  s_mul_i32 s4, s10, 10240
  s_mul_i32 s5, s10, 102400
  s_add_u32 s4, s4, 70400
  s_add_u32 m0, s4, s12
  s_sub_u32 s13, s13, 1
  buffer_load_dwordx4 v18, s[28:31], s5 offen lds
  s_add_u32 m0, m0, 5120
  s_add_u32 s6, s5, 51200
  buffer_load_dwordx4 v18, s[28:31], s6 offen lds
  s_lshr_b32 s7, s12, 11
  s_xor_b32 s7, s7, s10
  s_add_u32 s10, s10, 1
  s_and_b32 s10, s10, 7
  s_bitcmp1_b32 s7, 0
  s_cbranch_scc1 L_wp_48
  s_bitcmp1_b32 s46, 0
  s_cselect_b32 s5, s6, s5
  s_cselect_b32 s6, 5120, 0
  s_add_u32 s4, s4, 4096
  s_add_u32 m0, s4, s6
  s_nop 0
  buffer_load_dwordx4 v19, s[28:31], s5 offen lds
L_wp_48:
L_ws_47:
  s_cmp_eq_u32 s53, 0
  s_nop 0
  v_mfma_f32_32x32x16_bf16 v[148:163], v[192:195], v[168:171], v[148:163]
  s_cbranch_scc1 L_tail
  v_mfma_f32_32x32x16_bf16 v[116:131], v[172:175], v[204:207], 0
  v_exp_f32 v132, v132
  v_exp_f32 v133, v133
  v_exp_f32 v134, v134
  v_exp_f32 v135, v135
  v_mfma_f32_32x32x16_bf16 v[116:131], v[176:179], v[208:211], v[116:131]
  v_exp_f32 v136, v136
  v_exp_f32 v137, v137
  v_exp_f32 v138, v138
  v_exp_f32 v139, v139
  ds_read_b128 v[236:239], v94 offset:2560
  ds_read_b128 v[240:243], v95 offset:2560
  v_cvt_pk_bf16_f32 v164, v132, v133
  v_cvt_pk_bf16_f32 v165, v134, v135
  v_cvt_pk_bf16_f32 v166, v136, v137
  v_cvt_pk_bf16_f32 v167, v138, v139
  v_exp_f32 v140, v140
  v_exp_f32 v141, v141
  v_exp_f32 v142, v142
  v_exp_f32 v143, v143
  s_waitcnt lgkmcnt(2)
  v_mfma_f32_32x32x16_bf16 v[148:163], v[196:199], v[164:167], v[148:163]
  v_exp_f32 v144, v144
  v_exp_f32 v145, v145
  v_exp_f32 v146, v146
  v_exp_f32 v147, v147
  ds_read_b64_tr_b16 v[188:189], v96 offset:3072
  ds_read_b64_tr_b16 v[190:191], v96 offset:3200
  ds_read_b64_tr_b16 v[192:193], v96 offset:3328
  ds_read_b64_tr_b16 v[194:195], v96 offset:3456
  v_cvt_pk_bf16_f32 v168, v140, v141
  v_cvt_pk_bf16_f32 v169, v142, v143
  v_cvt_pk_bf16_f32 v170, v144, v145
  v_cvt_pk_bf16_f32 v171, v146, v147
  s_cmp_eq_u32 s13, 0
  s_cbranch_scc1 L_ws_49
  s_mul_i32 s4, s10, 10240
  s_mul_i32 s5, s10, 102400
  s_add_u32 s4, s4, 70400
  s_add_u32 m0, s4, s12
  s_sub_u32 s13, s13, 1
  buffer_load_dwordx4 v18, s[28:31], s5 offen lds
  s_add_u32 m0, m0, 5120
  s_add_u32 s6, s5, 51200
  buffer_load_dwordx4 v18, s[28:31], s6 offen lds
  s_lshr_b32 s7, s12, 11
  s_xor_b32 s7, s7, s10
  s_add_u32 s10, s10, 1
  s_and_b32 s10, s10, 7
  s_bitcmp1_b32 s7, 0
  s_cbranch_scc1 L_wp_50
  s_bitcmp1_b32 s46, 0
  s_cselect_b32 s5, s6, s5
  s_cselect_b32 s6, 5120, 0
  s_add_u32 s4, s4, 4096
  s_add_u32 m0, s4, s6
  s_nop 0
  buffer_load_dwordx4 v19, s[28:31], s5 offen lds
L_wp_50:
L_ws_49:
  s_cmp_eq_u32 s53, 1
  s_nop 0
  v_mfma_f32_32x32x16_bf16 v[148:163], v[200:203], v[168:171], v[148:163]
  s_cbranch_scc1 L_tail
  s_waitcnt lgkmcnt(4)
  v_mfma_f32_32x32x16_bf16 v[132:147], v[236:239], v[204:207], 0
  v_exp_f32 v116, v116
  v_exp_f32 v117, v117
  v_exp_f32 v118, v118
  v_exp_f32 v119, v119
  v_mfma_f32_32x32x16_bf16 v[132:147], v[240:243], v[208:211], v[132:147]
  v_exp_f32 v120, v120
  v_exp_f32 v121, v121
  v_exp_f32 v122, v122
  v_exp_f32 v123, v123
  ds_read_b128 v[172:175], v94 offset:2048
  ds_read_b128 v[176:179], v95 offset:2048
  v_cvt_pk_bf16_f32 v164, v116, v117
  v_cvt_pk_bf16_f32 v165, v118, v119
  v_cvt_pk_bf16_f32 v166, v120, v121
  v_cvt_pk_bf16_f32 v167, v122, v123
  v_exp_f32 v124, v124
  v_exp_f32 v125, v125
  v_exp_f32 v126, v126
  v_exp_f32 v127, v127
  s_waitcnt lgkmcnt(2)
  v_mfma_f32_32x32x16_bf16 v[148:163], v[188:191], v[164:167], v[148:163]
  v_exp_f32 v128, v128
  v_exp_f32 v129, v129
  v_exp_f32 v130, v130
  v_exp_f32 v131, v131
  ds_read_b64_tr_b16 v[196:197], v96 offset:2560
  ds_read_b64_tr_b16 v[198:199], v96 offset:2688
  ds_read_b64_tr_b16 v[200:201], v96 offset:2816
  ds_read_b64_tr_b16 v[202:203], v96 offset:2944
  v_cvt_pk_bf16_f32 v168, v124, v125
  v_cvt_pk_bf16_f32 v169, v126, v127
  v_cvt_pk_bf16_f32 v170, v128, v129
  v_cvt_pk_bf16_f32 v171, v130, v131
  s_cmp_eq_u32 s13, 0
  s_cbranch_scc1 L_ws_51
  s_mul_i32 s4, s10, 10240
  s_mul_i32 s5, s10, 102400
  s_add_u32 s4, s4, 70400
  s_add_u32 m0, s4, s12
  s_sub_u32 s13, s13, 1
  buffer_load_dwordx4 v18, s[28:31], s5 offen lds
  s_add_u32 m0, m0, 5120
  s_add_u32 s6, s5, 51200
  buffer_load_dwordx4 v18, s[28:31], s6 offen lds
  s_lshr_b32 s7, s12, 11
  s_xor_b32 s7, s7, s10
  s_add_u32 s10, s10, 1
  s_and_b32 s10, s10, 7
  s_bitcmp1_b32 s7, 0
  s_cbranch_scc1 L_wp_52
  s_bitcmp1_b32 s46, 0
  s_cselect_b32 s5, s6, s5
  s_cselect_b32 s6, 5120, 0
  s_add_u32 s4, s4, 4096
  s_add_u32 m0, s4, s6
  s_nop 0
  buffer_load_dwordx4 v19, s[28:31], s5 offen lds
L_wp_52:
L_ws_51:
  s_cmp_eq_u32 s53, 2
  s_nop 0
  v_mfma_f32_32x32x16_bf16 v[148:163], v[192:195], v[168:171], v[148:163]
  s_cbranch_scc1 L_tail
  v_exp_f32 v132, v132
  v_exp_f32 v133, v133
  v_exp_f32 v134, v134
  v_exp_f32 v135, v135
  v_exp_f32 v136, v136
  v_exp_f32 v137, v137
  v_exp_f32 v138, v138
  v_exp_f32 v139, v139
  v_cvt_pk_bf16_f32 v164, v132, v133
  v_cvt_pk_bf16_f32 v165, v134, v135
  v_cvt_pk_bf16_f32 v166, v136, v137
  v_cvt_pk_bf16_f32 v167, v138, v139
  v_exp_f32 v140, v140
  v_exp_f32 v141, v141
  v_exp_f32 v142, v142
  v_exp_f32 v143, v143
  s_waitcnt lgkmcnt(0)
  v_mfma_f32_32x32x16_bf16 v[148:163], v[196:199], v[164:167], v[148:163]
  v_exp_f32 v144, v144
  v_exp_f32 v145, v145
  v_exp_f32 v146, v146
  v_exp_f32 v147, v147
  v_cvt_pk_bf16_f32 v168, v140, v141
  v_cvt_pk_bf16_f32 v169, v142, v143
  v_cvt_pk_bf16_f32 v170, v144, v145
  v_cvt_pk_bf16_f32 v171, v146, v147
  s_cmp_eq_u32 s13, 0
  s_cbranch_scc1 L_ws_53
  s_mul_i32 s4, s10, 10240
  s_mul_i32 s5, s10, 102400
  s_add_u32 s4, s4, 70400
  s_add_u32 m0, s4, s12
  s_sub_u32 s13, s13, 1
  buffer_load_dwordx4 v18, s[28:31], s5 offen lds
  s_add_u32 m0, m0, 5120
  s_add_u32 s6, s5, 51200
  buffer_load_dwordx4 v18, s[28:31], s6 offen lds
  s_lshr_b32 s7, s12, 11
  s_xor_b32 s7, s7, s10
  s_add_u32 s10, s10, 1
  s_and_b32 s10, s10, 7
  s_bitcmp1_b32 s7, 0
  s_cbranch_scc1 L_wp_54
  s_bitcmp1_b32 s46, 0
  s_cselect_b32 s5, s6, s5
  s_cselect_b32 s6, 5120, 0
  s_add_u32 s4, s4, 4096
  s_add_u32 m0, s4, s6
  s_nop 0
  buffer_load_dwordx4 v19, s[28:31], s5 offen lds
L_wp_54:
L_ws_53:
  s_nop 0
  s_nop 0
  v_mfma_f32_32x32x16_bf16 v[148:163], v[200:203], v[168:171], v[148:163]
  s_branch L_tail
L_last:
  s_mov_b32 exec_hi, 0
  buffer_store_dwordx2 v[168:169], v16, s[36:39], 0 offen sc1
  s_mov_b32 exec_hi, -1
  buffer_store_dwordx4 v[164:167], v15, s[36:39], 0 offen sc1
  s_cmp_eq_u32 s47, 2
  s_cbranch_scc0 L_ost
  s_lshr_b32 s4, s48, 1
  s_mov_b32 exec_hi, 0
  buffer_store_dwordx2 v[216:217], v16, s[36:39], s4 offen sc1
  s_mov_b32 exec_hi, -1
  buffer_store_dwordx4 v[212:215], v15, s[36:39], s48 offen sc1
L_ost:
  v_mov_b32 v114, -1
  s_cmp_eq_u32 s3, 1
  s_cbranch_scc1 L_ep_55
  s_cmp_eq_u32 s47, 2
  s_cbranch_scc0 L_ep_55
  s_mov_b32 exec_hi, 0
  buffer_load_dword v114, v93, s[36:39], 0 offen sc1
  s_mov_b32 exec_hi, -1
L_ep_55:
  s_cmp_eq_u32 s47, 2
  s_cbranch_scc1 L_d_56
  s_waitcnt vmcnt(2)
  s_branch L_d_57
L_d_56:
  s_waitcnt vmcnt(5)
L_d_57:
  s_barrier
L_late:
  s_cmp_eq_u32 s3, 1
  s_cbranch_scc1 L_lb_58
  s_mul_i32 s4, s46, 5120
  s_mul_i32 s5, s46, 204800
  s_mov_b32 m0, s4
  s_nop 0
  buffer_load_dwordx4 v88, s[28:31], s5 offen offset:0 lds
  buffer_load_dwordx4 v89, s[28:31], s5 offen offset:1024 lds
  buffer_load_dwordx4 v90, s[28:31], s5 offen offset:2048 lds
  buffer_load_dwordx4 v91, s[28:31], s5 offen offset:3072 lds
  s_add_u32 m0, s4, 4096
  s_nop 0
  buffer_load_dwordx4 v92, s[28:31], s5 offen lds
  s_cmp_eq_u32 s54, 1
  s_cbranch_scc0 L_rl_59
  s_mul_i32 s6, s46, 20480
  s_add_u32 s6, s6, 70400
  v_add_u32 v6, s6, v60
  v_add_u32 v7, s6, v17
  v_add_u32 v8, s4, v60
  v_add_u32 v9, s4, v17
  ds_read_b64_tr_b16 v[128:129], v6 offset:0
  ds_read_b64_tr_b16 v[130:131], v6 offset:1280
  ds_read_b64_tr_b16 v[132:133], v6 offset:32
  ds_read_b64_tr_b16 v[134:135], v6 offset:1312
  ds_read_b64_tr_b16 v[136:137], v6 offset:64
  ds_read_b64_tr_b16 v[138:139], v6 offset:1344
  ds_read_b64_tr_b16 v[140:141], v6 offset:96
  ds_read_b64_tr_b16 v[142:143], v6 offset:1376
  ds_read_b64_tr_b16 v[144:145], v6 offset:128
  ds_read_b64_tr_b16 v[146:147], v6 offset:1408
  ds_read_b64_tr_b16 v[148:149], v6 offset:5120
  ds_read_b64_tr_b16 v[150:151], v6 offset:6400
  ds_read_b64_tr_b16 v[152:153], v6 offset:5152
  ds_read_b64_tr_b16 v[154:155], v6 offset:6432
  ds_read_b64_tr_b16 v[156:157], v6 offset:5184
  s_waitcnt lgkmcnt(5)
  ds_read_b64_tr_b16 v[158:159], v6 offset:6464
  ds_read_b64_tr_b16 v[160:161], v6 offset:5216
  ds_read_b64_tr_b16 v[162:163], v6 offset:6496
  ds_read_b64_tr_b16 v[164:165], v6 offset:5248
  ds_read_b64_tr_b16 v[166:167], v6 offset:6528
  ds_write_b128 v7, v[128:131] offset:0
  ds_write_b128 v7, v[132:135] offset:1024
  ds_write_b128 v7, v[136:139] offset:2048
  ds_write_b128 v7, v[140:143] offset:3072
  ds_write_b128 v7, v[144:147] offset:4096
  ds_read_b64_tr_b16 v[128:129], v6 offset:10240
  ds_read_b64_tr_b16 v[130:131], v6 offset:11520
  ds_read_b64_tr_b16 v[132:133], v6 offset:10272
  ds_read_b64_tr_b16 v[134:135], v6 offset:11552
  ds_read_b64_tr_b16 v[136:137], v6 offset:10304
  s_waitcnt lgkmcnt(5)
  ds_read_b64_tr_b16 v[138:139], v6 offset:11584
  ds_read_b64_tr_b16 v[140:141], v6 offset:10336
  ds_read_b64_tr_b16 v[142:143], v6 offset:11616
  ds_read_b64_tr_b16 v[144:145], v6 offset:10368
  ds_read_b64_tr_b16 v[146:147], v6 offset:11648
  ds_write_b128 v7, v[148:151] offset:5120
  ds_write_b128 v7, v[152:155] offset:6144
  ds_write_b128 v7, v[156:159] offset:7168
  ds_write_b128 v7, v[160:163] offset:8192
  ds_write_b128 v7, v[164:167] offset:9216
  ds_read_b64_tr_b16 v[148:149], v6 offset:15360
  ds_read_b64_tr_b16 v[150:151], v6 offset:16640
  ds_read_b64_tr_b16 v[152:153], v6 offset:15392
  ds_read_b64_tr_b16 v[154:155], v6 offset:16672
  ds_read_b64_tr_b16 v[156:157], v6 offset:15424
  s_waitcnt lgkmcnt(5)
  ds_read_b64_tr_b16 v[158:159], v6 offset:16704
  ds_read_b64_tr_b16 v[160:161], v6 offset:15456
  ds_read_b64_tr_b16 v[162:163], v6 offset:16736
  ds_read_b64_tr_b16 v[164:165], v6 offset:15488
  ds_read_b64_tr_b16 v[166:167], v6 offset:16768
  ds_write_b128 v7, v[128:131] offset:10240
  ds_write_b128 v7, v[132:135] offset:11264
  ds_write_b128 v7, v[136:139] offset:12288
  ds_write_b128 v7, v[140:143] offset:13312
  ds_write_b128 v7, v[144:147] offset:14336
  s_waitcnt vmcnt(0)
  ds_read_b64_tr_b16 v[128:129], v8 offset:0
  ds_read_b64_tr_b16 v[130:131], v8 offset:1280
  ds_read_b64_tr_b16 v[132:133], v8 offset:32
  ds_read_b64_tr_b16 v[134:135], v8 offset:1312
  ds_read_b64_tr_b16 v[136:137], v8 offset:64
  s_waitcnt lgkmcnt(5)
  ds_read_b64_tr_b16 v[138:139], v8 offset:1344
  ds_read_b64_tr_b16 v[140:141], v8 offset:96
  ds_read_b64_tr_b16 v[142:143], v8 offset:1376
  ds_read_b64_tr_b16 v[144:145], v8 offset:128
  ds_read_b64_tr_b16 v[146:147], v8 offset:1408
  ds_write_b128 v7, v[148:151] offset:15360
  ds_write_b128 v7, v[152:155] offset:16384
  ds_write_b128 v7, v[156:159] offset:17408
  ds_write_b128 v7, v[160:163] offset:18432
  ds_write_b128 v7, v[164:167] offset:19456
  s_waitcnt lgkmcnt(0)
  ds_write_b128 v9, v[128:131] offset:0
  ds_write_b128 v9, v[132:135] offset:1024
  ds_write_b128 v9, v[136:139] offset:2048
  ds_write_b128 v9, v[140:143] offset:3072
  ds_write_b128 v9, v[144:147] offset:4096
  s_waitcnt lgkmcnt(0)
L_rl_59:
  s_waitcnt vmcnt(0)
  v_mov_b32 v4, 70376
  v_mov_b32 v5, 1
  s_mov_b64 exec, 1
  ds_add_u32 v4, v5
  s_mov_b64 exec, -1
  v_mov_b32 v4, 70376
L_lw_60:
  ds_read_b32 v5, v4
  s_waitcnt lgkmcnt(0)
  v_cmp_gt_u32 vcc, 1065369480, v5
  s_cbranch_vccz L_lwf_61
  s_sleep 1
  s_branch L_lw_60
L_lwf_61:
  s_add_u32 s62, s56, 0
  s_and_b32 s62, s62, 3
  s_lshl_b32 s62, s62, 19
  s_add_u32 s63, s56, 1
  s_and_b32 s63, s63, 3
  s_lshl_b32 s63, s63, 19
  s_add_u32 s64, s56, 2
  s_and_b32 s64, s64, 3
  s_lshl_b32 s64, s64, 19
  s_add_u32 s65, s56, 3
  s_and_b32 s65, s65, 3
  s_lshl_b32 s65, s65, 19
  s_mov_b32 s8, 0
  s_mov_b32 s9, 0
  s_mov_b64 exec, 0xffff
  v_cmp_ne_u64 vcc, s[58:59], v[8:9]
  s_mov_b64 exec, -1
  s_cbranch_vccz L_k0_62
  s_mov_b64 exec, 0xffff
L_pl_64:
  buffer_load_dwordx2 v[8:9], v70, s[36:39], 0 offen sc1
  s_waitcnt vmcnt(0)
  v_cmp_ne_u64 vcc, s[58:59], v[8:9]
  s_cbranch_vccz L_plf_65
  s_sleep 2
  s_branch L_pl_64
L_plf_65:
  s_mov_b64 exec, -1
  v_mov_b32 v114, -1
L_k0_62:
  s_mov_b32 exec_hi, 0
  s_mov_b32 exec_lo, 0xaaaaaaaa
  v_cmp_eq_u32 vcc, -1, v114
  s_cbranch_vccz L_pb_63x
L_pb_63:
  buffer_load_dword v8, v93, s[36:39], 0 offen sc1
  s_add_u32 s9, s9, 1
  s_waitcnt vmcnt(0)
  v_cmp_eq_u32 vcc, -1, v8
  s_cbranch_vccz L_pb_63x
  s_cmp_ge_u32 s9, 200
  s_cbranch_scc1 L_fallback
  s_sleep 4
  s_branch L_pb_63
L_pb_63x:
  s_mov_b64 exec, -1
  v_mov_b32 v4, 70380
  v_mov_b32 v5, 1
  s_mov_b64 exec, 1
  ds_add_u32 v4, v5
  s_mov_b64 exec, -1
L_gemm:
  s_cmp_eq_u32 s54, 1
  s_cbranch_scc1 L_gemmR
  s_add_u32 s4, s62, 0
  buffer_load_dwordx4 v[116:119], v56, s[36:39], s4 offen sc1
  s_add_u32 s4, s62, 131072
  buffer_load_dwordx4 v[120:123], v56, s[36:39], s4 offen sc1
  s_add_u32 s4, s62, 262144
  buffer_load_dwordx4 v[124:127], v56, s[36:39], s4 offen sc1
  s_add_u32 s4, s62, 393216
  buffer_load_dwordx4 v[128:131], v56, s[36:39], s4 offen sc1
  s_add_u32 s4, s63, 0
  buffer_load_dwordx4 v[132:135], v56, s[36:39], s4 offen sc1
  s_add_u32 s4, s63, 131072
  buffer_load_dwordx4 v[136:139], v56, s[36:39], s4 offen sc1
  s_add_u32 s4, s63, 262144
  buffer_load_dwordx4 v[140:143], v56, s[36:39], s4 offen sc1
  s_add_u32 s4, s63, 393216
  buffer_load_dwordx4 v[144:147], v56, s[36:39], s4 offen sc1
  v_mov_b32 v4, 70372
  v_mov_b32 v5, 1
  ds_read_b64_tr_b16 v[196:197], v58 offset:0
  ds_read_b64_tr_b16 v[198:199], v58 offset:1280
  ds_read_b64_tr_b16 v[200:201], v58 offset:32
  ds_read_b64_tr_b16 v[202:203], v58 offset:1312
  ds_read_b64_tr_b16 v[204:205], v58 offset:64
  ds_read_b64_tr_b16 v[206:207], v58 offset:1344
  ds_read_b64_tr_b16 v[208:209], v58 offset:96
  ds_read_b64_tr_b16 v[210:211], v58 offset:1376
  ds_read_b64_tr_b16 v[212:213], v58 offset:128
  ds_read_b64_tr_b16 v[214:215], v58 offset:1408
  ds_read_b64_tr_b16 v[216:217], v58 offset:5120
  ds_read_b64_tr_b16 v[218:219], v58 offset:6400
  ds_read_b64_tr_b16 v[220:221], v58 offset:5152
  ds_read_b64_tr_b16 v[222:223], v58 offset:6432
  ds_read_b64_tr_b16 v[224:225], v58 offset:5184
  ds_read_b64_tr_b16 v[226:227], v58 offset:6464
  ds_read_b64_tr_b16 v[228:229], v58 offset:5216
  ds_read_b64_tr_b16 v[230:231], v58 offset:6496
  ds_read_b64_tr_b16 v[232:233], v58 offset:5248
  ds_read_b64_tr_b16 v[234:235], v58 offset:6528
  s_waitcnt vmcnt(7) lgkmcnt(10)
  v_mfma_f32_16x16x32_bf16 v[24:27], v[196:199], v[116:119], 0
  s_add_u32 s4, s64, 0
  buffer_load_dwordx4 v[148:151], v56, s[36:39], s4 offen sc1
  ds_read_b64_tr_b16 v[236:237], v58 offset:10240
  ds_read_b64_tr_b16 v[238:239], v58 offset:11520
  v_mfma_f32_16x16x32_bf16 v[28:31], v[200:203], v[116:119], 0
  ds_read_b64_tr_b16 v[240:241], v58 offset:10272
  ds_read_b64_tr_b16 v[242:243], v58 offset:11552
  v_mfma_f32_16x16x32_bf16 v[32:35], v[204:207], v[116:119], 0
  ds_read_b64_tr_b16 v[244:245], v58 offset:10304
  ds_read_b64_tr_b16 v[246:247], v58 offset:11584
  v_mfma_f32_16x16x32_bf16 v[36:39], v[208:211], v[116:119], 0
  ds_read_b64_tr_b16 v[248:249], v58 offset:10336
  ds_read_b64_tr_b16 v[250:251], v58 offset:11616
  v_mfma_f32_16x16x32_bf16 v[40:43], v[212:215], v[116:119], 0
  ds_read_b64_tr_b16 v[252:253], v58 offset:10368
  ds_read_b64_tr_b16 v[254:255], v58 offset:11648
  s_waitcnt vmcnt(7) lgkmcnt(10)
  v_mfma_f32_16x16x32_bf16 v[24:27], v[216:219], v[120:123], v[24:27]
  s_add_u32 s4, s64, 131072
  buffer_load_dwordx4 v[152:155], v56, s[36:39], s4 offen sc1
  ds_read_b64_tr_b16 v[196:197], v58 offset:15360
  ds_read_b64_tr_b16 v[198:199], v58 offset:16640
  v_mfma_f32_16x16x32_bf16 v[28:31], v[220:223], v[120:123], v[28:31]
  ds_read_b64_tr_b16 v[200:201], v58 offset:15392
  ds_read_b64_tr_b16 v[202:203], v58 offset:16672
  v_mfma_f32_16x16x32_bf16 v[32:35], v[224:227], v[120:123], v[32:35]
  ds_read_b64_tr_b16 v[204:205], v58 offset:15424
  ds_read_b64_tr_b16 v[206:207], v58 offset:16704
  v_mfma_f32_16x16x32_bf16 v[36:39], v[228:231], v[120:123], v[36:39]
  ds_read_b64_tr_b16 v[208:209], v58 offset:15456
  ds_read_b64_tr_b16 v[210:211], v58 offset:16736
  v_mfma_f32_16x16x32_bf16 v[40:43], v[232:235], v[120:123], v[40:43]
  ds_read_b64_tr_b16 v[212:213], v58 offset:15488
  ds_read_b64_tr_b16 v[214:215], v58 offset:16768
  s_waitcnt vmcnt(7) lgkmcnt(10)
  v_mfma_f32_16x16x32_bf16 v[24:27], v[236:239], v[124:127], v[24:27]
  s_add_u32 s4, s64, 262144
  buffer_load_dwordx4 v[156:159], v56, s[36:39], s4 offen sc1
  ds_read_b64_tr_b16 v[216:217], v59 offset:0
  ds_read_b64_tr_b16 v[218:219], v59 offset:1280
  v_mfma_f32_16x16x32_bf16 v[28:31], v[240:243], v[124:127], v[28:31]
  ds_read_b64_tr_b16 v[220:221], v59 offset:32
  ds_read_b64_tr_b16 v[222:223], v59 offset:1312
  v_mfma_f32_16x16x32_bf16 v[32:35], v[244:247], v[124:127], v[32:35]
  ds_read_b64_tr_b16 v[224:225], v59 offset:64
  ds_read_b64_tr_b16 v[226:227], v59 offset:1344
  v_mfma_f32_16x16x32_bf16 v[36:39], v[248:251], v[124:127], v[36:39]
  ds_read_b64_tr_b16 v[228:229], v59 offset:96
  ds_read_b64_tr_b16 v[230:231], v59 offset:1376
  v_mfma_f32_16x16x32_bf16 v[40:43], v[252:255], v[124:127], v[40:43]
  ds_read_b64_tr_b16 v[232:233], v59 offset:128
  ds_read_b64_tr_b16 v[234:235], v59 offset:1408
  s_waitcnt vmcnt(7) lgkmcnt(10)
  v_mfma_f32_16x16x32_bf16 v[24:27], v[196:199], v[128:131], v[24:27]
  s_add_u32 s4, s64, 393216
  buffer_load_dwordx4 v[160:163], v56, s[36:39], s4 offen sc1
  ds_read_b64_tr_b16 v[236:237], v59 offset:5120
  ds_read_b64_tr_b16 v[238:239], v59 offset:6400
  v_mfma_f32_16x16x32_bf16 v[28:31], v[200:203], v[128:131], v[28:31]
  ds_read_b64_tr_b16 v[240:241], v59 offset:5152
  ds_read_b64_tr_b16 v[242:243], v59 offset:6432
  v_mfma_f32_16x16x32_bf16 v[32:35], v[204:207], v[128:131], v[32:35]
  ds_read_b64_tr_b16 v[244:245], v59 offset:5184
  ds_read_b64_tr_b16 v[246:247], v59 offset:6464
  v_mfma_f32_16x16x32_bf16 v[36:39], v[208:211], v[128:131], v[36:39]
  ds_read_b64_tr_b16 v[248:249], v59 offset:5216
  ds_read_b64_tr_b16 v[250:251], v59 offset:6496
  v_mfma_f32_16x16x32_bf16 v[40:43], v[212:215], v[128:131], v[40:43]
  ds_read_b64_tr_b16 v[252:253], v59 offset:5248
  ds_read_b64_tr_b16 v[254:255], v59 offset:6528
  s_waitcnt vmcnt(7) lgkmcnt(10)
  v_mfma_f32_16x16x32_bf16 v[24:27], v[216:219], v[132:135], v[24:27]
  s_add_u32 s4, s65, 0
  buffer_load_dwordx4 v[164:167], v56, s[36:39], s4 offen sc1
  ds_read_b64_tr_b16 v[196:197], v59 offset:10240
  ds_read_b64_tr_b16 v[198:199], v59 offset:11520
  v_mfma_f32_16x16x32_bf16 v[28:31], v[220:223], v[132:135], v[28:31]
  ds_read_b64_tr_b16 v[200:201], v59 offset:10272
  ds_read_b64_tr_b16 v[202:203], v59 offset:11552
  v_mfma_f32_16x16x32_bf16 v[32:35], v[224:227], v[132:135], v[32:35]
  ds_read_b64_tr_b16 v[204:205], v59 offset:10304
  ds_read_b64_tr_b16 v[206:207], v59 offset:11584
  v_mfma_f32_16x16x32_bf16 v[36:39], v[228:231], v[132:135], v[36:39]
  ds_read_b64_tr_b16 v[208:209], v59 offset:10336
  ds_read_b64_tr_b16 v[210:211], v59 offset:11616
  v_mfma_f32_16x16x32_bf16 v[40:43], v[232:235], v[132:135], v[40:43]
  ds_read_b64_tr_b16 v[212:213], v59 offset:10368
  ds_read_b64_tr_b16 v[214:215], v59 offset:11648
  s_waitcnt vmcnt(7) lgkmcnt(10)
  v_mfma_f32_16x16x32_bf16 v[24:27], v[236:239], v[136:139], v[24:27]
  s_add_u32 s4, s65, 131072
  buffer_load_dwordx4 v[168:171], v56, s[36:39], s4 offen sc1
  ds_read_b64_tr_b16 v[216:217], v59 offset:15360
  ds_read_b64_tr_b16 v[218:219], v59 offset:16640
  v_mfma_f32_16x16x32_bf16 v[28:31], v[240:243], v[136:139], v[28:31]
  ds_read_b64_tr_b16 v[220:221], v59 offset:15392
  ds_read_b64_tr_b16 v[222:223], v59 offset:16672
  v_mfma_f32_16x16x32_bf16 v[32:35], v[244:247], v[136:139], v[32:35]
  ds_read_b64_tr_b16 v[224:225], v59 offset:15424
  ds_read_b64_tr_b16 v[226:227], v59 offset:16704
  v_mfma_f32_16x16x32_bf16 v[36:39], v[248:251], v[136:139], v[36:39]
  ds_read_b64_tr_b16 v[228:229], v59 offset:15456
  ds_read_b64_tr_b16 v[230:231], v59 offset:16736
  v_mfma_f32_16x16x32_bf16 v[40:43], v[252:255], v[136:139], v[40:43]
  ds_read_b64_tr_b16 v[232:233], v59 offset:15488
  ds_read_b64_tr_b16 v[234:235], v59 offset:16768
  s_waitcnt vmcnt(7) lgkmcnt(10)
  v_mfma_f32_16x16x32_bf16 v[24:27], v[196:199], v[140:143], v[24:27]
  s_add_u32 s4, s65, 262144
  buffer_load_dwordx4 v[172:175], v56, s[36:39], s4 offen sc1
  ds_read_b64_tr_b16 v[236:237], v68 offset:0
  ds_read_b64_tr_b16 v[238:239], v68 offset:1280
  v_mfma_f32_16x16x32_bf16 v[28:31], v[200:203], v[140:143], v[28:31]
  ds_read_b64_tr_b16 v[240:241], v68 offset:32
  ds_read_b64_tr_b16 v[242:243], v68 offset:1312
  v_mfma_f32_16x16x32_bf16 v[32:35], v[204:207], v[140:143], v[32:35]
  ds_read_b64_tr_b16 v[244:245], v68 offset:64
  ds_read_b64_tr_b16 v[246:247], v68 offset:1344
  v_mfma_f32_16x16x32_bf16 v[36:39], v[208:211], v[140:143], v[36:39]
  ds_read_b64_tr_b16 v[248:249], v68 offset:96
  ds_read_b64_tr_b16 v[250:251], v68 offset:1376
  v_mfma_f32_16x16x32_bf16 v[40:43], v[212:215], v[140:143], v[40:43]
  ds_read_b64_tr_b16 v[252:253], v68 offset:128
  ds_read_b64_tr_b16 v[254:255], v68 offset:1408
  s_waitcnt vmcnt(7) lgkmcnt(10)
  v_mfma_f32_16x16x32_bf16 v[24:27], v[216:219], v[144:147], v[24:27]
  s_add_u32 s4, s65, 393216
  buffer_load_dwordx4 v[176:179], v56, s[36:39], s4 offen sc1
  ds_read_b64_tr_b16 v[196:197], v68 offset:5120
  ds_read_b64_tr_b16 v[198:199], v68 offset:6400
  v_mfma_f32_16x16x32_bf16 v[28:31], v[220:223], v[144:147], v[28:31]
  ds_read_b64_tr_b16 v[200:201], v68 offset:5152
  ds_read_b64_tr_b16 v[202:203], v68 offset:6432
  v_mfma_f32_16x16x32_bf16 v[32:35], v[224:227], v[144:147], v[32:35]
  ds_read_b64_tr_b16 v[204:205], v68 offset:5184
  ds_read_b64_tr_b16 v[206:207], v68 offset:6464
  v_mfma_f32_16x16x32_bf16 v[36:39], v[228:231], v[144:147], v[36:39]
  ds_read_b64_tr_b16 v[208:209], v68 offset:5216
  ds_read_b64_tr_b16 v[210:211], v68 offset:6496
  v_mfma_f32_16x16x32_bf16 v[40:43], v[232:235], v[144:147], v[40:43]
  ds_read_b64_tr_b16 v[212:213], v68 offset:5248
  ds_read_b64_tr_b16 v[214:215], v68 offset:6528
  s_waitcnt vmcnt(7) lgkmcnt(10)
  v_mfma_f32_16x16x32_bf16 v[24:27], v[236:239], v[148:151], v[24:27]
  s_mov_b32 s4, 0
  buffer_load_dwordx2 v[180:181], v57, s[36:39], s4 offen sc1
  ds_read_b64_tr_b16 v[216:217], v68 offset:10240
  ds_read_b64_tr_b16 v[218:219], v68 offset:11520
  v_mfma_f32_16x16x32_bf16 v[28:31], v[240:243], v[148:151], v[28:31]
  ds_read_b64_tr_b16 v[220:221], v68 offset:10272
  ds_read_b64_tr_b16 v[222:223], v68 offset:11552
  v_mfma_f32_16x16x32_bf16 v[32:35], v[244:247], v[148:151], v[32:35]
  ds_read_b64_tr_b16 v[224:225], v68 offset:10304
  ds_read_b64_tr_b16 v[226:227], v68 offset:11584
  v_mfma_f32_16x16x32_bf16 v[36:39], v[248:251], v[148:151], v[36:39]
  ds_read_b64_tr_b16 v[228:229], v68 offset:10336
  ds_read_b64_tr_b16 v[230:231], v68 offset:11616
  v_mfma_f32_16x16x32_bf16 v[40:43], v[252:255], v[148:151], v[40:43]
  ds_read_b64_tr_b16 v[232:233], v68 offset:10368
  ds_read_b64_tr_b16 v[234:235], v68 offset:11648
  s_waitcnt vmcnt(7) lgkmcnt(10)
  v_mfma_f32_16x16x32_bf16 v[24:27], v[196:199], v[152:155], v[24:27]
  s_mov_b32 s4, 16384
  buffer_load_dwordx2 v[182:183], v57, s[36:39], s4 offen sc1
  ds_read_b64_tr_b16 v[236:237], v68 offset:15360
  ds_read_b64_tr_b16 v[238:239], v68 offset:16640
  v_mfma_f32_16x16x32_bf16 v[28:31], v[200:203], v[152:155], v[28:31]
  ds_read_b64_tr_b16 v[240:241], v68 offset:15392
  ds_read_b64_tr_b16 v[242:243], v68 offset:16672
  v_mfma_f32_16x16x32_bf16 v[32:35], v[204:207], v[152:155], v[32:35]
  ds_read_b64_tr_b16 v[244:245], v68 offset:15424
  ds_read_b64_tr_b16 v[246:247], v68 offset:16704
  v_mfma_f32_16x16x32_bf16 v[36:39], v[208:211], v[152:155], v[36:39]
  ds_read_b64_tr_b16 v[248:249], v68 offset:15456
  ds_read_b64_tr_b16 v[250:251], v68 offset:16736
  v_mfma_f32_16x16x32_bf16 v[40:43], v[212:215], v[152:155], v[40:43]
  ds_read_b64_tr_b16 v[252:253], v68 offset:15488
  ds_read_b64_tr_b16 v[254:255], v68 offset:16768
  s_waitcnt vmcnt(7) lgkmcnt(10)
  v_mfma_f32_16x16x32_bf16 v[24:27], v[216:219], v[156:159], v[24:27]
  s_mov_b32 s4, 131072
  buffer_load_dwordx2 v[184:185], v57, s[36:39], s4 offen sc1
  ds_read_b64_tr_b16 v[196:197], v69 offset:0
  ds_read_b64_tr_b16 v[198:199], v69 offset:1280
  v_mfma_f32_16x16x32_bf16 v[28:31], v[220:223], v[156:159], v[28:31]
  ds_read_b64_tr_b16 v[200:201], v69 offset:32
  ds_read_b64_tr_b16 v[202:203], v69 offset:1312
  v_mfma_f32_16x16x32_bf16 v[32:35], v[224:227], v[156:159], v[32:35]
  ds_read_b64_tr_b16 v[204:205], v69 offset:64
  ds_read_b64_tr_b16 v[206:207], v69 offset:1344
  v_mfma_f32_16x16x32_bf16 v[36:39], v[228:231], v[156:159], v[36:39]
  ds_read_b64_tr_b16 v[208:209], v69 offset:96
  ds_read_b64_tr_b16 v[210:211], v69 offset:1376
  v_mfma_f32_16x16x32_bf16 v[40:43], v[232:235], v[156:159], v[40:43]
  ds_read_b64_tr_b16 v[212:213], v69 offset:128
  ds_read_b64_tr_b16 v[214:215], v69 offset:1408
  s_waitcnt vmcnt(7) lgkmcnt(10)
  v_mfma_f32_16x16x32_bf16 v[24:27], v[236:239], v[160:163], v[24:27]
  s_mov_b32 s4, 147456
  buffer_load_dwordx2 v[186:187], v57, s[36:39], s4 offen sc1
  ds_read_b64_tr_b16 v[216:217], v69 offset:5120
  ds_read_b64_tr_b16 v[218:219], v69 offset:6400
  v_mfma_f32_16x16x32_bf16 v[28:31], v[240:243], v[160:163], v[28:31]
  ds_read_b64_tr_b16 v[220:221], v69 offset:5152
  ds_read_b64_tr_b16 v[222:223], v69 offset:6432
  v_mfma_f32_16x16x32_bf16 v[32:35], v[244:247], v[160:163], v[32:35]
  ds_read_b64_tr_b16 v[224:225], v69 offset:5184
  ds_read_b64_tr_b16 v[226:227], v69 offset:6464
  v_mfma_f32_16x16x32_bf16 v[36:39], v[248:251], v[160:163], v[36:39]
  ds_read_b64_tr_b16 v[228:229], v69 offset:5216
  ds_read_b64_tr_b16 v[230:231], v69 offset:6496
  v_mfma_f32_16x16x32_bf16 v[40:43], v[252:255], v[160:163], v[40:43]
  ds_read_b64_tr_b16 v[232:233], v69 offset:5248
  ds_read_b64_tr_b16 v[234:235], v69 offset:6528
  s_waitcnt vmcnt(7) lgkmcnt(10)
  v_mfma_f32_16x16x32_bf16 v[24:27], v[196:199], v[164:167], v[24:27]
  s_mov_b32 s4, 262144
  buffer_load_dwordx2 v[188:189], v57, s[36:39], s4 offen sc1
  ds_read_b64_tr_b16 v[236:237], v69 offset:10240
  ds_read_b64_tr_b16 v[238:239], v69 offset:11520
  v_mfma_f32_16x16x32_bf16 v[28:31], v[200:203], v[164:167], v[28:31]
  ds_read_b64_tr_b16 v[240:241], v69 offset:10272
  ds_read_b64_tr_b16 v[242:243], v69 offset:11552
  v_mfma_f32_16x16x32_bf16 v[32:35], v[204:207], v[164:167], v[32:35]
  ds_read_b64_tr_b16 v[244:245], v69 offset:10304
  ds_read_b64_tr_b16 v[246:247], v69 offset:11584
  v_mfma_f32_16x16x32_bf16 v[36:39], v[208:211], v[164:167], v[36:39]
  ds_read_b64_tr_b16 v[248:249], v69 offset:10336
  ds_read_b64_tr_b16 v[250:251], v69 offset:11616
  v_mfma_f32_16x16x32_bf16 v[40:43], v[212:215], v[164:167], v[40:43]
  ds_read_b64_tr_b16 v[252:253], v69 offset:10368
  ds_read_b64_tr_b16 v[254:255], v69 offset:11648
  s_waitcnt vmcnt(7) lgkmcnt(10)
  v_mfma_f32_16x16x32_bf16 v[24:27], v[216:219], v[168:171], v[24:27]
  s_mov_b32 s4, 278528
  buffer_load_dwordx2 v[190:191], v57, s[36:39], s4 offen sc1
  ds_read_b64_tr_b16 v[196:197], v69 offset:15360
  ds_read_b64_tr_b16 v[198:199], v69 offset:16640
  v_mfma_f32_16x16x32_bf16 v[28:31], v[220:223], v[168:171], v[28:31]
  ds_read_b64_tr_b16 v[200:201], v69 offset:15392
  ds_read_b64_tr_b16 v[202:203], v69 offset:16672
  v_mfma_f32_16x16x32_bf16 v[32:35], v[224:227], v[168:171], v[32:35]
  ds_read_b64_tr_b16 v[204:205], v69 offset:15424
  ds_read_b64_tr_b16 v[206:207], v69 offset:16704
  v_mfma_f32_16x16x32_bf16 v[36:39], v[228:231], v[168:171], v[36:39]
  ds_read_b64_tr_b16 v[208:209], v69 offset:15456
  ds_read_b64_tr_b16 v[210:211], v69 offset:16736
  v_mfma_f32_16x16x32_bf16 v[40:43], v[232:235], v[168:171], v[40:43]
  ds_read_b64_tr_b16 v[212:213], v69 offset:15488
  ds_read_b64_tr_b16 v[214:215], v69 offset:16768
  s_waitcnt vmcnt(7) lgkmcnt(10)
  v_mfma_f32_16x16x32_bf16 v[24:27], v[236:239], v[172:175], v[24:27]
  s_mov_b32 s4, 393216
  buffer_load_dwordx2 v[192:193], v57, s[36:39], s4 offen sc1
  ds_read_b64_tr_b16 v[216:217], v60 offset:0
  ds_read_b64_tr_b16 v[218:219], v60 offset:1280
  v_mfma_f32_16x16x32_bf16 v[28:31], v[240:243], v[172:175], v[28:31]
  ds_read_b64_tr_b16 v[220:221], v60 offset:32
  ds_read_b64_tr_b16 v[222:223], v60 offset:1312
  v_mfma_f32_16x16x32_bf16 v[32:35], v[244:247], v[172:175], v[32:35]
  ds_read_b64_tr_b16 v[224:225], v60 offset:64
  ds_read_b64_tr_b16 v[226:227], v60 offset:1344
  v_mfma_f32_16x16x32_bf16 v[36:39], v[248:251], v[172:175], v[36:39]
  ds_read_b64_tr_b16 v[228:229], v60 offset:96
  ds_read_b64_tr_b16 v[230:231], v60 offset:1376
  v_mfma_f32_16x16x32_bf16 v[40:43], v[252:255], v[172:175], v[40:43]
  ds_read_b64_tr_b16 v[232:233], v60 offset:128
  ds_read_b64_tr_b16 v[234:235], v60 offset:1408
  s_waitcnt vmcnt(7) lgkmcnt(10)
  v_mfma_f32_16x16x32_bf16 v[24:27], v[196:199], v[176:179], v[24:27]
  s_mov_b32 s4, 409600
  buffer_load_dwordx2 v[194:195], v57, s[36:39], s4 offen sc1
  s_mov_b64 exec, 1
  ds_add_u32 v4, v5
  s_mov_b64 exec, -1
  ds_read_b64_tr_b16 v[236:237], v60 offset:5120
  ds_read_b64_tr_b16 v[238:239], v60 offset:6400
  v_mfma_f32_16x16x32_bf16 v[28:31], v[200:203], v[176:179], v[28:31]
  ds_read_b64_tr_b16 v[240:241], v60 offset:5152
  ds_read_b64_tr_b16 v[242:243], v60 offset:6432
  v_mfma_f32_16x16x32_bf16 v[32:35], v[204:207], v[176:179], v[32:35]
  ds_read_b64_tr_b16 v[244:245], v60 offset:5184
  ds_read_b64_tr_b16 v[246:247], v60 offset:6464
  v_mfma_f32_16x16x32_bf16 v[36:39], v[208:211], v[176:179], v[36:39]
  ds_read_b64_tr_b16 v[248:249], v60 offset:5216
  ds_read_b64_tr_b16 v[250:251], v60 offset:6496
  v_mfma_f32_16x16x32_bf16 v[40:43], v[212:215], v[176:179], v[40:43]
  ds_read_b64_tr_b16 v[252:253], v60 offset:5248
  ds_read_b64_tr_b16 v[254:255], v60 offset:6528
  s_waitcnt vmcnt(6) lgkmcnt(10)
  v_mfma_f32_16x16x32_bf16 v[24:27], v[216:219], v[180:183], v[24:27]
  ds_read_b64_tr_b16 v[196:197], v60 offset:10240
  ds_read_b64_tr_b16 v[198:199], v60 offset:11520
  v_mfma_f32_16x16x32_bf16 v[28:31], v[220:223], v[180:183], v[28:31]
  ds_read_b64_tr_b16 v[200:201], v60 offset:10272
  ds_read_b64_tr_b16 v[202:203], v60 offset:11552
  v_mfma_f32_16x16x32_bf16 v[32:35], v[224:227], v[180:183], v[32:35]
  ds_read_b64_tr_b16 v[204:205], v60 offset:10304
  ds_read_b64_tr_b16 v[206:207], v60 offset:11584
  v_mfma_f32_16x16x32_bf16 v[36:39], v[228:231], v[180:183], v[36:39]
  ds_read_b64_tr_b16 v[208:209], v60 offset:10336
  ds_read_b64_tr_b16 v[210:211], v60 offset:11616
  v_mfma_f32_16x16x32_bf16 v[40:43], v[232:235], v[180:183], v[40:43]
  ds_read_b64_tr_b16 v[212:213], v60 offset:10368
  ds_read_b64_tr_b16 v[214:215], v60 offset:11648
  s_waitcnt vmcnt(4) lgkmcnt(10)
  v_mfma_f32_16x16x32_bf16 v[24:27], v[236:239], v[184:187], v[24:27]
  ds_read_b64_tr_b16 v[216:217], v60 offset:15360
  ds_read_b64_tr_b16 v[218:219], v60 offset:16640
  v_mfma_f32_16x16x32_bf16 v[28:31], v[240:243], v[184:187], v[28:31]
  ds_read_b64_tr_b16 v[220:221], v60 offset:15392
  ds_read_b64_tr_b16 v[222:223], v60 offset:16672
  v_mfma_f32_16x16x32_bf16 v[32:35], v[244:247], v[184:187], v[32:35]
  ds_read_b64_tr_b16 v[224:225], v60 offset:15424
  ds_read_b64_tr_b16 v[226:227], v60 offset:16704
  v_mfma_f32_16x16x32_bf16 v[36:39], v[248:251], v[184:187], v[36:39]
  ds_read_b64_tr_b16 v[228:229], v60 offset:15456
  ds_read_b64_tr_b16 v[230:231], v60 offset:16736
  v_mfma_f32_16x16x32_bf16 v[40:43], v[252:255], v[184:187], v[40:43]
  ds_read_b64_tr_b16 v[232:233], v60 offset:15488
  ds_read_b64_tr_b16 v[234:235], v60 offset:16768
  s_waitcnt vmcnt(2) lgkmcnt(10)
  v_mfma_f32_16x16x32_bf16 v[24:27], v[196:199], v[188:191], v[24:27]
  v_mfma_f32_16x16x32_bf16 v[28:31], v[200:203], v[188:191], v[28:31]
  v_mfma_f32_16x16x32_bf16 v[32:35], v[204:207], v[188:191], v[32:35]
  v_mfma_f32_16x16x32_bf16 v[36:39], v[208:211], v[188:191], v[36:39]
  v_mfma_f32_16x16x32_bf16 v[40:43], v[212:215], v[188:191], v[40:43]
  s_waitcnt vmcnt(0) lgkmcnt(0)
  v_mfma_f32_16x16x32_bf16 v[24:27], v[216:219], v[192:195], v[24:27]
  v_mfma_f32_16x16x32_bf16 v[28:31], v[220:223], v[192:195], v[28:31]
  v_mfma_f32_16x16x32_bf16 v[32:35], v[224:227], v[192:195], v[32:35]
  v_mfma_f32_16x16x32_bf16 v[36:39], v[228:231], v[192:195], v[36:39]
  v_mfma_f32_16x16x32_bf16 v[40:43], v[232:235], v[192:195], v[40:43]
L_gdone:
  s_nop 7
  s_cmp_eq_u32 s8, 1
  s_cbranch_scc1 L_nc_66
  v_cmp_u_f32 vcc, v24, v40
  s_cbranch_vccnz L_fallback
L_nc_66:
  v_cvt_pk_bf16_f32 v116, v24, v25
  v_cvt_pk_bf16_f32 v117, v26, v27
  ds_write_b64 v61, v[116:117] offset:0
  v_cvt_pk_bf16_f32 v118, v28, v29
  v_cvt_pk_bf16_f32 v119, v30, v31
  ds_write_b64 v61, v[118:119] offset:32
  v_cvt_pk_bf16_f32 v120, v32, v33
  v_cvt_pk_bf16_f32 v121, v34, v35
  ds_write_b64 v61, v[120:121] offset:64
  v_cvt_pk_bf16_f32 v122, v36, v37
  v_cvt_pk_bf16_f32 v123, v38, v39
  ds_write_b64 v61, v[122:123] offset:96
  v_cvt_pk_bf16_f32 v124, v40, v41
  v_cvt_pk_bf16_f32 v125, v42, v43
  ds_write_b64 v61, v[124:125] offset:128
  s_waitcnt lgkmcnt(0)
  ds_read_b128 v[132:135], v62
  ds_read_b128 v[136:139], v63
  ds_read_b128 v[140:143], v64
  s_waitcnt lgkmcnt(2)
  buffer_store_dwordx4 v[132:135], v65, s[32:35], 0 offen
  s_waitcnt lgkmcnt(1)
  buffer_store_dwordx4 v[136:139], v66, s[32:35], 0 offen
  s_waitcnt lgkmcnt(0)
  buffer_store_dwordx4 v[140:143], v67, s[32:35], 0 offen
  s_branch L_fin
L_gemmR:
  s_add_u32 s4, s62, 0
  buffer_load_dwordx4 v[116:119], v56, s[36:39], s4 offen sc1
  s_add_u32 s4, s62, 131072
  buffer_load_dwordx4 v[120:123], v56, s[36:39], s4 offen sc1
  s_add_u32 s4, s62, 262144
  buffer_load_dwordx4 v[124:127], v56, s[36:39], s4 offen sc1
  s_add_u32 s4, s62, 393216
  buffer_load_dwordx4 v[128:131], v56, s[36:39], s4 offen sc1
  s_add_u32 s4, s63, 0
  buffer_load_dwordx4 v[132:135], v56, s[36:39], s4 offen sc1
  s_add_u32 s4, s63, 131072
  buffer_load_dwordx4 v[136:139], v56, s[36:39], s4 offen sc1
  s_add_u32 s4, s63, 262144
  buffer_load_dwordx4 v[140:143], v56, s[36:39], s4 offen sc1
  s_add_u32 s4, s63, 393216
  buffer_load_dwordx4 v[144:147], v56, s[36:39], s4 offen sc1
  v_mov_b32 v4, 70372
  v_mov_b32 v5, 1
  ds_read_b128 v[196:199], v58 offset:0
  ds_read_b128 v[200:203], v58 offset:1024
  ds_read_b128 v[204:207], v58 offset:2048
  ds_read_b128 v[208:211], v58 offset:3072
  ds_read_b128 v[212:215], v58 offset:4096
  ds_read_b128 v[216:219], v58 offset:5120
  ds_read_b128 v[220:223], v58 offset:6144
  ds_read_b128 v[224:227], v58 offset:7168
  ds_read_b128 v[228:231], v58 offset:8192
  ds_read_b128 v[232:235], v58 offset:9216
  s_waitcnt vmcnt(7) lgkmcnt(5)
  v_mfma_f32_16x16x32_bf16 v[24:27], v[196:199], v[116:119], 0
  s_add_u32 s4, s64, 0
  buffer_load_dwordx4 v[148:151], v56, s[36:39], s4 offen sc1
  ds_read_b128 v[236:239], v58 offset:10240
  v_mfma_f32_16x16x32_bf16 v[28:31], v[200:203], v[116:119], 0
  ds_read_b128 v[240:243], v58 offset:11264
  v_mfma_f32_16x16x32_bf16 v[32:35], v[204:207], v[116:119], 0
  ds_read_b128 v[244:247], v58 offset:12288
  v_mfma_f32_16x16x32_bf16 v[36:39], v[208:211], v[116:119], 0
  ds_read_b128 v[248:251], v58 offset:13312
  v_mfma_f32_16x16x32_bf16 v[40:43], v[212:215], v[116:119], 0
  ds_read_b128 v[252:255], v58 offset:14336
  s_waitcnt vmcnt(7) lgkmcnt(5)
  v_mfma_f32_16x16x32_bf16 v[24:27], v[216:219], v[120:123], v[24:27]
  s_add_u32 s4, s64, 131072
  buffer_load_dwordx4 v[152:155], v56, s[36:39], s4 offen sc1
  ds_read_b128 v[196:199], v58 offset:15360
  v_mfma_f32_16x16x32_bf16 v[28:31], v[220:223], v[120:123], v[28:31]
  ds_read_b128 v[200:203], v58 offset:16384
  v_mfma_f32_16x16x32_bf16 v[32:35], v[224:227], v[120:123], v[32:35]
  ds_read_b128 v[204:207], v58 offset:17408
  v_mfma_f32_16x16x32_bf16 v[36:39], v[228:231], v[120:123], v[36:39]
  ds_read_b128 v[208:211], v58 offset:18432
  v_mfma_f32_16x16x32_bf16 v[40:43], v[232:235], v[120:123], v[40:43]
  ds_read_b128 v[212:215], v58 offset:19456
  s_waitcnt vmcnt(7) lgkmcnt(5)
  v_mfma_f32_16x16x32_bf16 v[24:27], v[236:239], v[124:127], v[24:27]
  s_add_u32 s4, s64, 262144
  buffer_load_dwordx4 v[156:159], v56, s[36:39], s4 offen sc1
  ds_read_b128 v[216:219], v59 offset:0
  v_mfma_f32_16x16x32_bf16 v[28:31], v[240:243], v[124:127], v[28:31]
  ds_read_b128 v[220:223], v59 offset:1024
  v_mfma_f32_16x16x32_bf16 v[32:35], v[244:247], v[124:127], v[32:35]
  ds_read_b128 v[224:227], v59 offset:2048
  v_mfma_f32_16x16x32_bf16 v[36:39], v[248:251], v[124:127], v[36:39]
  ds_read_b128 v[228:231], v59 offset:3072
  v_mfma_f32_16x16x32_bf16 v[40:43], v[252:255], v[124:127], v[40:43]
  ds_read_b128 v[232:235], v59 offset:4096
  s_waitcnt vmcnt(7) lgkmcnt(5)
  v_mfma_f32_16x16x32_bf16 v[24:27], v[196:199], v[128:131], v[24:27]
  s_add_u32 s4, s64, 393216
  buffer_load_dwordx4 v[160:163], v56, s[36:39], s4 offen sc1
  ds_read_b128 v[236:239], v59 offset:5120
  v_mfma_f32_16x16x32_bf16 v[28:31], v[200:203], v[128:131], v[28:31]
  ds_read_b128 v[240:243], v59 offset:6144
  v_mfma_f32_16x16x32_bf16 v[32:35], v[204:207], v[128:131], v[32:35]
  ds_read_b128 v[244:247], v59 offset:7168
  v_mfma_f32_16x16x32_bf16 v[36:39], v[208:211], v[128:131], v[36:39]
  ds_read_b128 v[248:251], v59 offset:8192
  v_mfma_f32_16x16x32_bf16 v[40:43], v[212:215], v[128:131], v[40:43]
  ds_read_b128 v[252:255], v59 offset:9216
  s_waitcnt vmcnt(7) lgkmcnt(5)
  v_mfma_f32_16x16x32_bf16 v[24:27], v[216:219], v[132:135], v[24:27]
  s_add_u32 s4, s65, 0
  buffer_load_dwordx4 v[164:167], v56, s[36:39], s4 offen sc1
  ds_read_b128 v[196:199], v59 offset:10240
  v_mfma_f32_16x16x32_bf16 v[28:31], v[220:223], v[132:135], v[28:31]
  ds_read_b128 v[200:203], v59 offset:11264
  v_mfma_f32_16x16x32_bf16 v[32:35], v[224:227], v[132:135], v[32:35]
  ds_read_b128 v[204:207], v59 offset:12288
  v_mfma_f32_16x16x32_bf16 v[36:39], v[228:231], v[132:135], v[36:39]
  ds_read_b128 v[208:211], v59 offset:13312
  v_mfma_f32_16x16x32_bf16 v[40:43], v[232:235], v[132:135], v[40:43]
  ds_read_b128 v[212:215], v59 offset:14336
  s_waitcnt vmcnt(7) lgkmcnt(5)
  v_mfma_f32_16x16x32_bf16 v[24:27], v[236:239], v[136:139], v[24:27]
  s_add_u32 s4, s65, 131072
  buffer_load_dwordx4 v[168:171], v56, s[36:39], s4 offen sc1
  ds_read_b128 v[216:219], v59 offset:15360
  v_mfma_f32_16x16x32_bf16 v[28:31], v[240:243], v[136:139], v[28:31]
  ds_read_b128 v[220:223], v59 offset:16384
  v_mfma_f32_16x16x32_bf16 v[32:35], v[244:247], v[136:139], v[32:35]
  ds_read_b128 v[224:227], v59 offset:17408
  v_mfma_f32_16x16x32_bf16 v[36:39], v[248:251], v[136:139], v[36:39]
  ds_read_b128 v[228:231], v59 offset:18432
  v_mfma_f32_16x16x32_bf16 v[40:43], v[252:255], v[136:139], v[40:43]
  ds_read_b128 v[232:235], v59 offset:19456
  s_waitcnt vmcnt(7) lgkmcnt(5)
  v_mfma_f32_16x16x32_bf16 v[24:27], v[196:199], v[140:143], v[24:27]
  s_add_u32 s4, s65, 262144
  buffer_load_dwordx4 v[172:175], v56, s[36:39], s4 offen sc1
  ds_read_b128 v[236:239], v68 offset:0
  v_mfma_f32_16x16x32_bf16 v[28:31], v[200:203], v[140:143], v[28:31]
  ds_read_b128 v[240:243], v68 offset:1024
  v_mfma_f32_16x16x32_bf16 v[32:35], v[204:207], v[140:143], v[32:35]
  ds_read_b128 v[244:247], v68 offset:2048
  v_mfma_f32_16x16x32_bf16 v[36:39], v[208:211], v[140:143], v[36:39]
  ds_read_b128 v[248:251], v68 offset:3072
  v_mfma_f32_16x16x32_bf16 v[40:43], v[212:215], v[140:143], v[40:43]
  ds_read_b128 v[252:255], v68 offset:4096
  s_waitcnt vmcnt(7) lgkmcnt(5)
  v_mfma_f32_16x16x32_bf16 v[24:27], v[216:219], v[144:147], v[24:27]
  s_add_u32 s4, s65, 393216
  buffer_load_dwordx4 v[176:179], v56, s[36:39], s4 offen sc1
  ds_read_b128 v[196:199], v68 offset:5120
  v_mfma_f32_16x16x32_bf16 v[28:31], v[220:223], v[144:147], v[28:31]
  ds_read_b128 v[200:203], v68 offset:6144
  v_mfma_f32_16x16x32_bf16 v[32:35], v[224:227], v[144:147], v[32:35]
  ds_read_b128 v[204:207], v68 offset:7168
  v_mfma_f32_16x16x32_bf16 v[36:39], v[228:231], v[144:147], v[36:39]
  ds_read_b128 v[208:211], v68 offset:8192
  v_mfma_f32_16x16x32_bf16 v[40:43], v[232:235], v[144:147], v[40:43]
  ds_read_b128 v[212:215], v68 offset:9216
  s_waitcnt vmcnt(7) lgkmcnt(5)
  v_mfma_f32_16x16x32_bf16 v[24:27], v[236:239], v[148:151], v[24:27]
  s_mov_b32 s4, 0
  buffer_load_dwordx2 v[180:181], v57, s[36:39], s4 offen sc1
  ds_read_b128 v[216:219], v68 offset:10240
  v_mfma_f32_16x16x32_bf16 v[28:31], v[240:243], v[148:151], v[28:31]
  ds_read_b128 v[220:223], v68 offset:11264
  v_mfma_f32_16x16x32_bf16 v[32:35], v[244:247], v[148:151], v[32:35]
  ds_read_b128 v[224:227], v68 offset:12288
  v_mfma_f32_16x16x32_bf16 v[36:39], v[248:251], v[148:151], v[36:39]
  ds_read_b128 v[228:231], v68 offset:13312
  v_mfma_f32_16x16x32_bf16 v[40:43], v[252:255], v[148:151], v[40:43]
  ds_read_b128 v[232:235], v68 offset:14336
  s_waitcnt vmcnt(7) lgkmcnt(5)
  v_mfma_f32_16x16x32_bf16 v[24:27], v[196:199], v[152:155], v[24:27]
  s_mov_b32 s4, 16384
  buffer_load_dwordx2 v[182:183], v57, s[36:39], s4 offen sc1
  ds_read_b128 v[236:239], v68 offset:15360
  v_mfma_f32_16x16x32_bf16 v[28:31], v[200:203], v[152:155], v[28:31]
  ds_read_b128 v[240:243], v68 offset:16384
  v_mfma_f32_16x16x32_bf16 v[32:35], v[204:207], v[152:155], v[32:35]
  ds_read_b128 v[244:247], v68 offset:17408
  v_mfma_f32_16x16x32_bf16 v[36:39], v[208:211], v[152:155], v[36:39]
  ds_read_b128 v[248:251], v68 offset:18432
  v_mfma_f32_16x16x32_bf16 v[40:43], v[212:215], v[152:155], v[40:43]
  ds_read_b128 v[252:255], v68 offset:19456
  s_waitcnt vmcnt(7) lgkmcnt(5)
  v_mfma_f32_16x16x32_bf16 v[24:27], v[216:219], v[156:159], v[24:27]
  s_mov_b32 s4, 131072
  buffer_load_dwordx2 v[184:185], v57, s[36:39], s4 offen sc1
  ds_read_b128 v[196:199], v69 offset:0
  v_mfma_f32_16x16x32_bf16 v[28:31], v[220:223], v[156:159], v[28:31]
  ds_read_b128 v[200:203], v69 offset:1024
  v_mfma_f32_16x16x32_bf16 v[32:35], v[224:227], v[156:159], v[32:35]
  ds_read_b128 v[204:207], v69 offset:2048
  v_mfma_f32_16x16x32_bf16 v[36:39], v[228:231], v[156:159], v[36:39]
  ds_read_b128 v[208:211], v69 offset:3072
  v_mfma_f32_16x16x32_bf16 v[40:43], v[232:235], v[156:159], v[40:43]
  ds_read_b128 v[212:215], v69 offset:4096
  s_waitcnt vmcnt(7) lgkmcnt(5)
  v_mfma_f32_16x16x32_bf16 v[24:27], v[236:239], v[160:163], v[24:27]
  s_mov_b32 s4, 147456
  buffer_load_dwordx2 v[186:187], v57, s[36:39], s4 offen sc1
  ds_read_b128 v[216:219], v69 offset:5120
  v_mfma_f32_16x16x32_bf16 v[28:31], v[240:243], v[160:163], v[28:31]
  ds_read_b128 v[220:223], v69 offset:6144
  v_mfma_f32_16x16x32_bf16 v[32:35], v[244:247], v[160:163], v[32:35]
  ds_read_b128 v[224:227], v69 offset:7168
  v_mfma_f32_16x16x32_bf16 v[36:39], v[248:251], v[160:163], v[36:39]
  ds_read_b128 v[228:231], v69 offset:8192
  v_mfma_f32_16x16x32_bf16 v[40:43], v[252:255], v[160:163], v[40:43]
  ds_read_b128 v[232:235], v69 offset:9216
  s_waitcnt vmcnt(7) lgkmcnt(5)
  v_mfma_f32_16x16x32_bf16 v[24:27], v[196:199], v[164:167], v[24:27]
  s_mov_b32 s4, 262144
  buffer_load_dwordx2 v[188:189], v57, s[36:39], s4 offen sc1
  ds_read_b128 v[236:239], v69 offset:10240
  v_mfma_f32_16x16x32_bf16 v[28:31], v[200:203], v[164:167], v[28:31]
  ds_read_b128 v[240:243], v69 offset:11264
  v_mfma_f32_16x16x32_bf16 v[32:35], v[204:207], v[164:167], v[32:35]
  ds_read_b128 v[244:247], v69 offset:12288
  v_mfma_f32_16x16x32_bf16 v[36:39], v[208:211], v[164:167], v[36:39]
  ds_read_b128 v[248:251], v69 offset:13312
  v_mfma_f32_16x16x32_bf16 v[40:43], v[212:215], v[164:167], v[40:43]
  ds_read_b128 v[252:255], v69 offset:14336
  s_waitcnt vmcnt(7) lgkmcnt(5)
  v_mfma_f32_16x16x32_bf16 v[24:27], v[216:219], v[168:171], v[24:27]
  s_mov_b32 s4, 278528
  buffer_load_dwordx2 v[190:191], v57, s[36:39], s4 offen sc1
  ds_read_b128 v[196:199], v69 offset:15360
  v_mfma_f32_16x16x32_bf16 v[28:31], v[220:223], v[168:171], v[28:31]
  ds_read_b128 v[200:203], v69 offset:16384
  v_mfma_f32_16x16x32_bf16 v[32:35], v[224:227], v[168:171], v[32:35]
  ds_read_b128 v[204:207], v69 offset:17408
  v_mfma_f32_16x16x32_bf16 v[36:39], v[228:231], v[168:171], v[36:39]
  ds_read_b128 v[208:211], v69 offset:18432
  v_mfma_f32_16x16x32_bf16 v[40:43], v[232:235], v[168:171], v[40:43]
  ds_read_b128 v[212:215], v69 offset:19456
  s_waitcnt vmcnt(7) lgkmcnt(5)
  v_mfma_f32_16x16x32_bf16 v[24:27], v[236:239], v[172:175], v[24:27]
  s_mov_b32 s4, 393216
  buffer_load_dwordx2 v[192:193], v57, s[36:39], s4 offen sc1
  ds_read_b128 v[216:219], v17 offset:0
  v_mfma_f32_16x16x32_bf16 v[28:31], v[240:243], v[172:175], v[28:31]
  ds_read_b128 v[220:223], v17 offset:1024
  v_mfma_f32_16x16x32_bf16 v[32:35], v[244:247], v[172:175], v[32:35]
  ds_read_b128 v[224:227], v17 offset:2048
  v_mfma_f32_16x16x32_bf16 v[36:39], v[248:251], v[172:175], v[36:39]
  ds_read_b128 v[228:231], v17 offset:3072
  v_mfma_f32_16x16x32_bf16 v[40:43], v[252:255], v[172:175], v[40:43]
  ds_read_b128 v[232:235], v17 offset:4096
  s_waitcnt vmcnt(7) lgkmcnt(5)
  v_mfma_f32_16x16x32_bf16 v[24:27], v[196:199], v[176:179], v[24:27]
  s_mov_b32 s4, 409600
  buffer_load_dwordx2 v[194:195], v57, s[36:39], s4 offen sc1
  s_mov_b64 exec, 1
  ds_add_u32 v4, v5
  s_mov_b64 exec, -1
  ds_read_b128 v[236:239], v17 offset:5120
  v_mfma_f32_16x16x32_bf16 v[28:31], v[200:203], v[176:179], v[28:31]
  ds_read_b128 v[240:243], v17 offset:6144
  v_mfma_f32_16x16x32_bf16 v[32:35], v[204:207], v[176:179], v[32:35]
  ds_read_b128 v[244:247], v17 offset:7168
  v_mfma_f32_16x16x32_bf16 v[36:39], v[208:211], v[176:179], v[36:39]
  ds_read_b128 v[248:251], v17 offset:8192
  v_mfma_f32_16x16x32_bf16 v[40:43], v[212:215], v[176:179], v[40:43]
  ds_read_b128 v[252:255], v17 offset:9216
  s_waitcnt vmcnt(6) lgkmcnt(5)
  v_mfma_f32_16x16x32_bf16 v[24:27], v[216:219], v[180:183], v[24:27]
  ds_read_b128 v[196:199], v17 offset:10240
  v_mfma_f32_16x16x32_bf16 v[28:31], v[220:223], v[180:183], v[28:31]
  ds_read_b128 v[200:203], v17 offset:11264
  v_mfma_f32_16x16x32_bf16 v[32:35], v[224:227], v[180:183], v[32:35]
  ds_read_b128 v[204:207], v17 offset:12288
  v_mfma_f32_16x16x32_bf16 v[36:39], v[228:231], v[180:183], v[36:39]
  ds_read_b128 v[208:211], v17 offset:13312
  v_mfma_f32_16x16x32_bf16 v[40:43], v[232:235], v[180:183], v[40:43]
  ds_read_b128 v[212:215], v17 offset:14336
  s_waitcnt vmcnt(4) lgkmcnt(5)
  v_mfma_f32_16x16x32_bf16 v[24:27], v[236:239], v[184:187], v[24:27]
  ds_read_b128 v[216:219], v17 offset:15360
  v_mfma_f32_16x16x32_bf16 v[28:31], v[240:243], v[184:187], v[28:31]
  ds_read_b128 v[220:223], v17 offset:16384
  v_mfma_f32_16x16x32_bf16 v[32:35], v[244:247], v[184:187], v[32:35]
  ds_read_b128 v[224:227], v17 offset:17408
  v_mfma_f32_16x16x32_bf16 v[36:39], v[248:251], v[184:187], v[36:39]
  ds_read_b128 v[228:231], v17 offset:18432
  v_mfma_f32_16x16x32_bf16 v[40:43], v[252:255], v[184:187], v[40:43]
  ds_read_b128 v[232:235], v17 offset:19456
  s_waitcnt vmcnt(2) lgkmcnt(5)
  v_mfma_f32_16x16x32_bf16 v[24:27], v[196:199], v[188:191], v[24:27]
  v_mfma_f32_16x16x32_bf16 v[28:31], v[200:203], v[188:191], v[28:31]
  v_mfma_f32_16x16x32_bf16 v[32:35], v[204:207], v[188:191], v[32:35]
  v_mfma_f32_16x16x32_bf16 v[36:39], v[208:211], v[188:191], v[36:39]
  v_mfma_f32_16x16x32_bf16 v[40:43], v[212:215], v[188:191], v[40:43]
  s_waitcnt vmcnt(0) lgkmcnt(0)
  v_mfma_f32_16x16x32_bf16 v[24:27], v[216:219], v[192:195], v[24:27]
  v_mfma_f32_16x16x32_bf16 v[28:31], v[220:223], v[192:195], v[28:31]
  v_mfma_f32_16x16x32_bf16 v[32:35], v[224:227], v[192:195], v[32:35]
  v_mfma_f32_16x16x32_bf16 v[36:39], v[228:231], v[192:195], v[36:39]
  v_mfma_f32_16x16x32_bf16 v[40:43], v[232:235], v[192:195], v[40:43]
  s_branch L_gdone
L_fallback:
  s_mov_b64 exec, -1
  s_mov_b32 s8, 1
  s_cmp_eq_u32 s57, 1
  s_cbranch_scc1 L_fq_67
  s_lshl_b32 s4, s49, 4
  s_add_u32 s4, s4, s50
  s_lshl_b32 s4, s4, 7
  s_add_u32 s4, s4, 13697024
  s_sub_u32 s5, s4, 2048
  s_cmp_eq_u32 s49, 1
  s_cselect_b32 s5, s5, s4
  v_mov_b32 v4, s58
  v_mov_b32 v5, s59
  v_mov_b32 v6, s58
  v_mov_b32 v7, s59
  s_mov_b64 exec, 0xff
  buffer_store_dwordx4 v[4:7], v17, s[36:39], s4 offen sc1
  buffer_store_dwordx4 v[4:7], v17, s[36:39], s5 offen sc1
  s_mov_b64 exec, -1
L_fq_67:
  s_mov_b64 exec, 0xffff
L_pl_68:
  buffer_load_dwordx2 v[8:9], v71, s[36:39], 0 offen sc1
  s_waitcnt vmcnt(0)
  v_cmp_ne_u64 vcc, s[58:59], v[8:9]
  s_cbranch_vccz L_plf_69
  s_sleep 2
  s_branch L_pl_68
L_plf_69:
  s_mov_b64 exec, -1
  s_branch L_gemm
L_lb_58:
  s_waitcnt vmcnt(0)
  v_mov_b32 v4, 70376
  v_mov_b32 v5, 1
  s_mov_b64 exec, 1
  ds_add_u32 v4, v5
  s_mov_b64 exec, -1
  s_cmp_eq_u32 s73, 0
  s_cbranch_scc1 L_nb2_70
  s_mov_b32 s15, 0
  s_and_b32 s4, s46, 1
  s_bfe_u32 s12, s46, 0x10001
  s_cmp_eq_u32 s4, 0
  s_cselect_b32 s5, 152320, 0
  s_cselect_b32 s6, 20480, 0
  s_cselect_b32 s7, 0, 29696
  s_add_u32 s5, s5, s7
  v_add_u32 v101, s5, v60
  s_cmp_eq_u32 s4, 0
  s_cselect_b32 s7, 0, 33792
  s_add_u32 s6, s6, s7
  v_add_u32 v102, s6, v60
  v_add_u32 v103, 156416, v60
  v_add_u32 v104, 24576, v60
  s_and_b32 s6, s2, 1
  s_lshl_b32 s6, s6, 10
  s_add_u32 s6, s6, s16
  v_lshl_add_u32 v4, v3, 7, s6
  s_lshl_b32 s7, s17, 7
  s_add_u32 s8, s7, 1280
  s_sub_u32 s9, 2556, s7
  s_cmp_eq_u32 s4, 0
  s_cselect_b32 s8, s8, s9
  s_cselect_b32 s9, 4, -4
  s_xor_b32 s10, s4, s12
  s_cmp_eq_u32 s10, 0
  s_cselect_b32 s10, 0xbf800000, 0x3f800000
  v_mul_i32_i24 v5, s9, v2
  v_add_u32 v5, s8, v5
  v_sub_u32 v6, 1184, v4
  s_cmp_eq_u32 s12, 0
  s_cselect_b64 vcc, -1, 0
  s_cselect_b32 s13, 0, 2211840
  s_cselect_b32 s14, 1, -1
  v_cndmask_b32 v6, v6, v4, vcc
  v_mul_u32_u24 v6, 2560, v6
  v_add_u32 v100, v6, v5
  s_and_b32 s5, s46, 3
  s_lshl_b32 s6, s5, 10
  v_add_u32 v105, s6, v17
  s_lshl_b32 s6, s5, 8
  s_add_u32 s6, s6, 8192
  v_lshrrev_b32 v4, 2, v1
  v_lshl_add_u32 v4, v4, 4, s6
  v_and_b32 v5, 3, v1
  v_cmp_eq_u32 vcc, 3, v5
  v_add_u32 v5, 16, v105
  s_and_b32 s11, s16, 15
  v_cndmask_b32 v106, v5, v4, vcc
  s_cmp_eq_u32 s11, 0
  s_cselect_b32 s11, s12, 0
  s_cmp_eq_u32 s46, 4
  s_cbranch_scc0 L_q5_77
  s_mov_b64 exec, 0xffff
  buffer_load_dwordx2 v[8:9], v59, s[36:39], 0 offen sc1
  s_mov_b64 exec, -1
L_q5_77:
  s_cmp_eq_u32 s101, 1
  s_cbranch_scc0 L_p1_72
  v_add_u32 v4, 152320, v105
  v_add_u32 v5, 152320, v106
  ds_read_b128 v[108:111], v4
  ds_read_b32 v112, v5
  v_add_u32 v4, 29696, v105
  s_waitcnt lgkmcnt(0)
  v_alignbit_b32 v108, v109, v108, 16
  v_alignbit_b32 v109, v110, v109, 16
  v_alignbit_b32 v110, v111, v110, 16
  v_alignbit_b32 v111, v112, v111, 16
  ds_write_b128 v4, v[108:111]
  s_waitcnt lgkmcnt(0)
  v_mov_b32 v4, 70368
  v_mov_b32 v5, 1
  s_mov_b64 exec, 1
  ds_add_u32 v4, v5
  s_mov_b64 exec, -1
  ds_read_b32 v5, v4
  s_waitcnt lgkmcnt(0)
  v_cmp_gt_u32 vcc, 1065369476, v5
  s_cbranch_vccz L_p2_73
  ds_read_b32 v5, v4
  s_waitcnt lgkmcnt(0)
  v_cmp_gt_u32 vcc, 1065369476, v5
  s_cbranch_vccz L_p2_73
  s_branch L_p1_72
L_p2_73:
  s_mov_b32 s15, 1
  ds_read_b64_tr_b16 v[180:181], v101 offset:0
  ds_read_b64_tr_b16 v[182:183], v101 offset:256
  ds_read_b64_tr_b16 v[184:185], v101 offset:2048
  ds_read_b64_tr_b16 v[186:187], v101 offset:2304
  ds_read_b64_tr_b16 v[188:189], v103 offset:0
  ds_read_b64_tr_b16 v[190:191], v103 offset:256
  ds_read_b64_tr_b16 v[192:193], v103 offset:2048
  ds_read_b64_tr_b16 v[194:195], v103 offset:2304
  ds_read_b64_tr_b16 v[196:197], v101 offset:512
  ds_read_b64_tr_b16 v[198:199], v101 offset:768
  ds_read_b64_tr_b16 v[200:201], v101 offset:2560
  ds_read_b64_tr_b16 v[202:203], v101 offset:2816
  ds_read_b64_tr_b16 v[204:205], v103 offset:512
  ds_read_b64_tr_b16 v[206:207], v103 offset:768
  ds_read_b64_tr_b16 v[208:209], v103 offset:2560
  ds_read_b64_tr_b16 v[210:211], v103 offset:2816
  s_waitcnt lgkmcnt(12)
  v_mfma_f32_32x32x16_bf16 v[116:131], v[68:71], v[180:183], 0
  v_mfma_f32_32x32x16_bf16 v[116:131], v[72:75], v[184:187], v[116:131]
  s_waitcnt lgkmcnt(8)
  v_mfma_f32_32x32x16_bf16 v[132:147], v[68:71], v[188:191], 0
  v_mfma_f32_32x32x16_bf16 v[132:147], v[72:75], v[192:195], v[132:147]
  s_waitcnt lgkmcnt(4)
  v_mfma_f32_32x32x16_bf16 v[148:163], v[84:87], v[196:199], 0
  v_mfma_f32_32x32x16_bf16 v[148:163], v[88:91], v[200:203], v[148:163]
  s_waitcnt lgkmcnt(0)
  v_mfma_f32_32x32x16_bf16 v[164:179], v[84:87], v[204:207], 0
  v_mfma_f32_32x32x16_bf16 v[164:179], v[88:91], v[208:211], v[164:179]
L_p1_72:
  s_cmp_eq_u32 s46, 4
  s_cbranch_scc0 L_q0_74
  s_mov_b64 exec, 0xffff
  s_waitcnt vmcnt(0)
  v_cmp_ne_u64 vcc, s[58:59], v[8:9]
  s_mov_b64 exec, -1
  s_cbranch_vccz L_q0_74a
  s_mov_b64 exec, 0xffff
L_pl_78:
  buffer_load_dwordx2 v[8:9], v59, s[36:39], 0 offen sc1
  s_waitcnt vmcnt(0)
  v_cmp_ne_u64 vcc, s[58:59], v[8:9]
  s_cbranch_vccz L_plf_79
  s_sleep 1
  s_branch L_pl_78
L_plf_79:
  s_mov_b64 exec, -1
L_q0_74a:
  v_mov_b32 v4, 70384
  v_mov_b32 v5, 1
  s_mov_b64 exec, 1
  ds_add_u32 v4, v5
  s_mov_b64 exec, -1
L_q0_74:
  v_mov_b32 v4, 70384
L_lw_80:
  ds_read_b32 v5, v4
  s_waitcnt lgkmcnt(0)
  v_cmp_gt_u32 vcc, 1065369473, v5
  s_cbranch_vccz L_lwf_81
  s_sleep 1
  s_branch L_lw_80
L_lwf_81:
  s_and_b32 s5, s46, 3
  s_lshl_b32 s6, s5, 10
  s_add_u32 m0, s6, 20480
  s_mov_b32 s4, 11534336
  buffer_load_dwordx4 v58, s[36:39], s4 offen sc1 lds
  s_add_u32 m0, s6, 24576
  s_mov_b32 s4, 11534720
  buffer_load_dwordx4 v58, s[36:39], s4 offen sc1 lds
  s_lshl_b32 s6, s5, 8
  s_add_u32 m0, s6, 28672
  s_mov_b32 s4, 11534336
  s_mov_b64 exec, 0xffff
  buffer_load_dwordx4 v62, s[36:39], s4 offen sc1 lds
  s_mov_b64 exec, -1
  s_cmp_eq_u32 s101, 1
  s_cbranch_scc1 L_ld_82
  s_and_b32 s5, s46, 3
  s_lshl_b32 s6, s5, 10
  s_add_u32 m0, s6, 152320
  s_mov_b32 s4, 11534336
  buffer_load_dwordx4 v57, s[36:39], s4 offen sc1 lds
  s_add_u32 m0, s6, 156416
  s_mov_b32 s4, 11534720
  buffer_load_dwordx4 v57, s[36:39], s4 offen sc1 lds
  s_lshl_b32 s6, s5, 8
  s_add_u32 m0, s6, 160512
  s_mov_b32 s4, 11534336
  s_mov_b64 exec, 0xffff
  buffer_load_dwordx4 v61, s[36:39], s4 offen sc1 lds
  s_mov_b64 exec, -1
L_ld_82:
  s_cmp_eq_u32 s15, 1
  s_cbranch_scc1 L_q4_76
  s_cmp_eq_u32 s101, 1
  s_cbranch_scc1 L_q3_75
  s_waitcnt vmcnt(0)
  v_add_u32 v4, 152320, v105
  v_add_u32 v5, 152320, v106
  ds_read_b128 v[108:111], v4
  ds_read_b32 v112, v5
  v_add_u32 v4, 29696, v105
  s_waitcnt lgkmcnt(0)
  v_alignbit_b32 v108, v109, v108, 16
  v_alignbit_b32 v109, v110, v109, 16
  v_alignbit_b32 v110, v111, v110, 16
  v_alignbit_b32 v111, v112, v111, 16
  ds_write_b128 v4, v[108:111]
  s_waitcnt lgkmcnt(0)
  v_mov_b32 v4, 70368
  v_mov_b32 v5, 1
  s_mov_b64 exec, 1
  ds_add_u32 v4, v5
  s_mov_b64 exec, -1
L_q3_75:
  v_mov_b32 v4, 70368
L_lw_83:
  ds_read_b32 v5, v4
  s_waitcnt lgkmcnt(0)
  v_cmp_gt_u32 vcc, 1065369476, v5
  s_cbranch_vccz L_lwf_84
  s_sleep 1
  s_branch L_lw_83
L_lwf_84:
  ds_read_b64_tr_b16 v[180:181], v101 offset:0
  ds_read_b64_tr_b16 v[182:183], v101 offset:256
  ds_read_b64_tr_b16 v[184:185], v101 offset:2048
  ds_read_b64_tr_b16 v[186:187], v101 offset:2304
  ds_read_b64_tr_b16 v[188:189], v103 offset:0
  ds_read_b64_tr_b16 v[190:191], v103 offset:256
  ds_read_b64_tr_b16 v[192:193], v103 offset:2048
  ds_read_b64_tr_b16 v[194:195], v103 offset:2304
  ds_read_b64_tr_b16 v[196:197], v101 offset:512
  ds_read_b64_tr_b16 v[198:199], v101 offset:768
  ds_read_b64_tr_b16 v[200:201], v101 offset:2560
  ds_read_b64_tr_b16 v[202:203], v101 offset:2816
  ds_read_b64_tr_b16 v[204:205], v103 offset:512
  ds_read_b64_tr_b16 v[206:207], v103 offset:768
  ds_read_b64_tr_b16 v[208:209], v103 offset:2560
  ds_read_b64_tr_b16 v[210:211], v103 offset:2816
  s_waitcnt lgkmcnt(12)
  v_mfma_f32_32x32x16_bf16 v[116:131], v[68:71], v[180:183], 0
  v_mfma_f32_32x32x16_bf16 v[116:131], v[72:75], v[184:187], v[116:131]
  s_waitcnt lgkmcnt(8)
  v_mfma_f32_32x32x16_bf16 v[132:147], v[68:71], v[188:191], 0
  v_mfma_f32_32x32x16_bf16 v[132:147], v[72:75], v[192:195], v[132:147]
  s_waitcnt lgkmcnt(4)
  v_mfma_f32_32x32x16_bf16 v[148:163], v[84:87], v[196:199], 0
  v_mfma_f32_32x32x16_bf16 v[148:163], v[88:91], v[200:203], v[148:163]
  s_waitcnt lgkmcnt(0)
  v_mfma_f32_32x32x16_bf16 v[164:179], v[84:87], v[204:207], 0
  v_mfma_f32_32x32x16_bf16 v[164:179], v[88:91], v[208:211], v[164:179]
L_q4_76:
  s_waitcnt vmcnt(0)
  v_add_u32 v4, 20480, v105
  v_add_u32 v5, 20480, v106
  ds_read_b128 v[108:111], v4
  ds_read_b32 v112, v5
  v_add_u32 v4, 33792, v105
  s_waitcnt lgkmcnt(0)
  v_alignbit_b32 v108, v109, v108, 16
  v_alignbit_b32 v109, v110, v109, 16
  v_alignbit_b32 v110, v111, v110, 16
  v_alignbit_b32 v111, v112, v111, 16
  ds_write_b128 v4, v[108:111]
  s_waitcnt lgkmcnt(0)
  v_mov_b32 v4, 70388
  v_mov_b32 v5, 1
  s_mov_b64 exec, 1
  ds_add_u32 v4, v5
  s_mov_b64 exec, -1
  s_cmp_eq_u32 s11, 1
  s_cbranch_scc1 L_nb2_70
  v_mov_b32 v4, 70388
L_lw_85:
  ds_read_b32 v5, v4
  s_waitcnt lgkmcnt(0)
  v_cmp_gt_u32 vcc, 1065369476, v5
  s_cbranch_vccz L_lwf_86
  s_sleep 1
  s_branch L_lw_85
L_lwf_86:
  ds_read_b64_tr_b16 v[180:181], v102 offset:0
  ds_read_b64_tr_b16 v[182:183], v102 offset:256
  ds_read_b64_tr_b16 v[184:185], v102 offset:2048
  ds_read_b64_tr_b16 v[186:187], v102 offset:2304
  ds_read_b64_tr_b16 v[188:189], v104 offset:0
  ds_read_b64_tr_b16 v[190:191], v104 offset:256
  ds_read_b64_tr_b16 v[192:193], v104 offset:2048
  ds_read_b64_tr_b16 v[194:195], v104 offset:2304
  ds_read_b64_tr_b16 v[196:197], v102 offset:512
  ds_read_b64_tr_b16 v[198:199], v102 offset:768
  ds_read_b64_tr_b16 v[200:201], v102 offset:2560
  ds_read_b64_tr_b16 v[202:203], v102 offset:2816
  ds_read_b64_tr_b16 v[204:205], v104 offset:512
  ds_read_b64_tr_b16 v[206:207], v104 offset:768
  ds_read_b64_tr_b16 v[208:209], v104 offset:2560
  ds_read_b64_tr_b16 v[210:211], v104 offset:2816
  s_waitcnt lgkmcnt(12)
  v_mfma_f32_32x32x16_bf16 v[116:131], v[76:79], v[180:183], v[116:131]
  v_mfma_f32_32x32x16_bf16 v[116:131], v[80:83], v[184:187], v[116:131]
  s_waitcnt lgkmcnt(8)
  v_mfma_f32_32x32x16_bf16 v[132:147], v[76:79], v[188:191], v[132:147]
  v_mfma_f32_32x32x16_bf16 v[132:147], v[80:83], v[192:195], v[132:147]
  s_waitcnt lgkmcnt(4)
  v_mfma_f32_32x32x16_bf16 v[148:163], v[92:95], v[196:199], v[148:163]
  v_mfma_f32_32x32x16_bf16 v[148:163], v[96:99], v[200:203], v[148:163]
  s_waitcnt lgkmcnt(0)
  v_mfma_f32_32x32x16_bf16 v[164:179], v[92:95], v[204:207], v[164:179]
  v_mfma_f32_32x32x16_bf16 v[164:179], v[96:99], v[208:211], v[164:179]
  s_cmp_eq_u32 s16, 16
  s_cbranch_scc0 L_x16_87
  s_mov_b64 exec, 0x10000
L_pl_88:
  buffer_load_dwordx2 v[8:9], v59, s[36:39], 0 offen sc1
  s_waitcnt vmcnt(0)
  v_cmp_ne_u64 vcc, s[58:59], v[8:9]
  s_cbranch_vccz L_plf_89
  s_sleep 1
  s_branch L_pl_88
L_plf_89:
  s_mov_b64 exec, -1
  s_and_b32 s4, s46, 1
  s_lshl_b32 s5, s17, 5
  s_add_u32 s4, s4, s5
  s_lshl_b32 s4, s4, 1
  s_add_u32 s4, s4, 13107200
  s_lshl_b32 s5, s5, 1
  s_add_u32 s5, s5, 13107584
  v_lshlrev_b32 v4, 1, v2
  buffer_load_ushort v5, v4, s[36:39], s4 offen sc1
  buffer_load_ushort v6, v4, s[36:39], s5 offen sc1
  s_waitcnt vmcnt(0)
  v_lshlrev_b32 v5, 16, v5
  v_lshlrev_b32 v6, 16, v6
  v_add_f32 v116, v5, v116
  v_add_f32 v132, v6, v132
  v_add_f32 v117, v5, v117
  v_add_f32 v133, v6, v133
  v_add_f32 v118, v5, v118
  v_add_f32 v134, v6, v134
  v_add_f32 v119, v5, v119
  v_add_f32 v135, v6, v135
  v_add_f32 v120, v5, v120
  v_add_f32 v136, v6, v136
  v_add_f32 v121, v5, v121
  v_add_f32 v137, v6, v137
  v_add_f32 v122, v5, v122
  v_add_f32 v138, v6, v138
  v_add_f32 v123, v5, v123
  v_add_f32 v139, v6, v139
  v_add_f32 v124, v5, v124
  v_add_f32 v140, v6, v140
  v_add_f32 v125, v5, v125
  v_add_f32 v141, v6, v141
  v_add_f32 v126, v5, v126
  v_add_f32 v142, v6, v142
  v_add_f32 v127, v5, v127
  v_add_f32 v143, v6, v143
  v_add_f32 v128, v5, v128
  v_add_f32 v144, v6, v144
  v_add_f32 v129, v5, v129
  v_add_f32 v145, v6, v145
  v_add_f32 v130, v5, v130
  v_add_f32 v146, v6, v146
  v_add_f32 v131, v5, v131
  v_add_f32 v147, v6, v147
L_x16_87:
  s_nop 9
  v_fmac_f32 v116, s10, v148
  v_fmac_f32 v117, s10, v149
  v_fmac_f32 v118, s10, v150
  v_fmac_f32 v119, s10, v151
  v_fmac_f32 v120, s10, v152
  v_fmac_f32 v121, s10, v153
  v_fmac_f32 v122, s10, v154
  v_fmac_f32 v123, s10, v155
  v_fmac_f32 v124, s10, v156
  v_fmac_f32 v125, s10, v157
  v_fmac_f32 v126, s10, v158
  v_fmac_f32 v127, s10, v159
  v_fmac_f32 v128, s10, v160
  v_fmac_f32 v129, s10, v161
  v_fmac_f32 v130, s10, v162
  v_fmac_f32 v131, s10, v163
  v_fmac_f32 v132, s10, v164
  v_fmac_f32 v133, s10, v165
  v_fmac_f32 v134, s10, v166
  v_fmac_f32 v135, s10, v167
  v_fmac_f32 v136, s10, v168
  v_fmac_f32 v137, s10, v169
  v_fmac_f32 v138, s10, v170
  v_fmac_f32 v139, s10, v171
  v_fmac_f32 v140, s10, v172
  v_fmac_f32 v141, s10, v173
  v_fmac_f32 v142, s10, v174
  v_fmac_f32 v143, s10, v175
  v_fmac_f32 v144, s10, v176
  v_fmac_f32 v145, s10, v177
  v_fmac_f32 v146, s10, v178
  v_fmac_f32 v147, s10, v179
  v_cvt_pk_bf16_f32 v116, v116, v132
  v_cvt_pk_bf16_f32 v117, v117, v133
  v_cvt_pk_bf16_f32 v118, v118, v134
  v_cvt_pk_bf16_f32 v119, v119, v135
  v_cvt_pk_bf16_f32 v120, v120, v136
  v_cvt_pk_bf16_f32 v121, v121, v137
  v_cvt_pk_bf16_f32 v122, v122, v138
  v_cvt_pk_bf16_f32 v123, v123, v139
  v_cvt_pk_bf16_f32 v124, v124, v140
  v_cvt_pk_bf16_f32 v125, v125, v141
  v_cvt_pk_bf16_f32 v126, v126, v142
  v_cvt_pk_bf16_f32 v127, v127, v143
  v_cvt_pk_bf16_f32 v128, v128, v144
  v_cvt_pk_bf16_f32 v129, v129, v145
  v_cvt_pk_bf16_f32 v130, v130, v146
  v_cvt_pk_bf16_f32 v131, v131, v147
  v_mov_b32 v4, 70372
L_lw_90:
  ds_read_b32 v5, v4
  s_waitcnt lgkmcnt(0)
  v_cmp_gt_u32 vcc, 1065369476, v5
  s_cbranch_vccz L_lwf_91
  s_sleep 1
  s_branch L_lw_90
L_lwf_91:
  s_mul_i32 s5, s14, 0
  s_add_u32 s5, s5, s13
  buffer_store_dword v116, v100, s[32:35], s5 offen
  s_mul_i32 s5, s14, 81920
  s_add_u32 s5, s5, s13
  buffer_store_dword v117, v100, s[32:35], s5 offen
  s_mul_i32 s5, s14, 163840
  s_add_u32 s5, s5, s13
  buffer_store_dword v118, v100, s[32:35], s5 offen
  s_mul_i32 s5, s14, 245760
  s_add_u32 s5, s5, s13
  buffer_store_dword v119, v100, s[32:35], s5 offen
  s_mul_i32 s5, s14, 655360
  s_add_u32 s5, s5, s13
  buffer_store_dword v120, v100, s[32:35], s5 offen
  s_mul_i32 s5, s14, 737280
  s_add_u32 s5, s5, s13
  buffer_store_dword v121, v100, s[32:35], s5 offen
  s_mul_i32 s5, s14, 819200
  s_add_u32 s5, s5, s13
  buffer_store_dword v122, v100, s[32:35], s5 offen
  s_mul_i32 s5, s14, 901120
  s_add_u32 s5, s5, s13
  buffer_store_dword v123, v100, s[32:35], s5 offen
  s_mul_i32 s5, s14, 1310720
  s_add_u32 s5, s5, s13
  buffer_store_dword v124, v100, s[32:35], s5 offen
  s_mul_i32 s5, s14, 1392640
  s_add_u32 s5, s5, s13
  buffer_store_dword v125, v100, s[32:35], s5 offen
  s_mul_i32 s5, s14, 1474560
  s_add_u32 s5, s5, s13
  buffer_store_dword v126, v100, s[32:35], s5 offen
  s_mul_i32 s5, s14, 1556480
  s_add_u32 s5, s5, s13
  buffer_store_dword v127, v100, s[32:35], s5 offen
  s_mul_i32 s5, s14, 1966080
  s_add_u32 s5, s5, s13
  buffer_store_dword v128, v100, s[32:35], s5 offen
  s_mul_i32 s5, s14, 2048000
  s_add_u32 s5, s5, s13
  buffer_store_dword v129, v100, s[32:35], s5 offen
  s_mul_i32 s5, s14, 2129920
  s_add_u32 s5, s5, s13
  buffer_store_dword v130, v100, s[32:35], s5 offen
  s_mul_i32 s5, s14, 2211840
  s_add_u32 s5, s5, s13
  buffer_store_dword v131, v100, s[32:35], s5 offen
L_nb2_70:
  s_cmp_eq_u32 s57, 1
  s_cbranch_scc1 L_fin
  s_cmp_eq_u32 s46, 5
  s_cbranch_scc0 L_fin
  v_mov_b32 v4, 70372
L_lw_92:
  ds_read_b32 v5, v4
  s_waitcnt lgkmcnt(0)
  v_cmp_gt_u32 vcc, 1065369476, v5
  s_cbranch_vccz L_lwf_93
  s_sleep 1
  s_branch L_lw_92
L_lwf_93:
  s_lshl_b32 s4, s49, 4
  s_add_u32 s4, s4, s50
  s_lshl_b32 s4, s4, 7
  s_add_u32 s4, s4, 13697024
  s_sub_u32 s5, s4, 2048
  s_cmp_eq_u32 s49, 1
  s_cselect_b32 s5, s5, s4
  v_mov_b32 v4, s58
  v_mov_b32 v5, s59
  v_mov_b32 v6, s58
  v_mov_b32 v7, s59
  s_mov_b64 exec, 0xff
  buffer_store_dwordx4 v[4:7], v17, s[36:39], s4 offen sc1
  buffer_store_dwordx4 v[4:7], v17, s[36:39], s5 offen sc1
  s_mov_b64 exec, -1
L_fin:
L_end:
  s_endpgm
L_slow:
  s_waitcnt lgkmcnt(0)
  s_cmp_eq_u32 s47, 2
  s_cbranch_scc0 L_s2j_94
  v_mov_b32 v100, v204
  v_mov_b32 v101, v205
  v_mov_b32 v102, v206
  v_mov_b32 v103, v207
  v_mov_b32 v104, v208
  v_mov_b32 v105, v209
  v_mov_b32 v106, v210
  v_mov_b32 v107, v211
  v_mov_b32 v108, v98
  v_mov_b32 v109, v99
  v_mov_b32 v10, v94
  v_mov_b32 v11, v95
  v_mov_b32 v12, v96
L_s2j_94:
  s_mov_b32 s8, 1
  v_mov_b32 v104, v108
  v_mov_b32 v105, v109
  ds_read_b128 v[172:175], v10 offset:4096
  ds_read_b128 v[176:179], v11 offset:4096
  s_waitcnt lgkmcnt(0)
  v_mfma_f32_32x32x16_bf16 v[116:131], v[172:175], v[100:103], v[24:39]
  v_mfma_f32_32x32x16_bf16 v[116:131], v[176:179], v[104:107], v[116:131]
  s_nop 7
  s_nop 3
  v_max3_f32 v110, v116, v117, v118
  v_max_f32 v110, v110, v119
  v_max3_f32 v110, v110, v120, v121
  v_max3_f32 v110, v110, v122, v123
  v_max3_f32 v110, v110, v124, v125
  v_max3_f32 v110, v110, v126, v127
  v_max3_f32 v110, v110, v128, v129
  v_max3_f32 v110, v110, v130, v131
  s_cmp_lt_u32 s53, 2
  s_cbranch_scc1 L_slow7
  ds_read_b128 v[172:175], v10 offset:3072
  ds_read_b128 v[176:179], v11 offset:3072
  s_waitcnt lgkmcnt(0)
  v_mfma_f32_32x32x16_bf16 v[116:131], v[172:175], v[100:103], 0
  v_mfma_f32_32x32x16_bf16 v[116:131], v[176:179], v[104:107], v[116:131]
  s_nop 7
  s_nop 3
  v_max3_f32 v110, v110, v116, v117
  v_max3_f32 v110, v110, v118, v119
  v_max3_f32 v110, v110, v120, v121
  v_max3_f32 v110, v110, v122, v123
  v_max3_f32 v110, v110, v124, v125
  v_max3_f32 v110, v110, v126, v127
  v_max3_f32 v110, v110, v128, v129
  v_max3_f32 v110, v110, v130, v131
  s_cmp_lt_u32 s53, 3
  s_cbranch_scc1 L_slow7
  ds_read_b128 v[172:175], v10 offset:2560
  ds_read_b128 v[176:179], v11 offset:2560
  s_waitcnt lgkmcnt(0)
  v_mfma_f32_32x32x16_bf16 v[116:131], v[172:175], v[100:103], 0
  v_mfma_f32_32x32x16_bf16 v[116:131], v[176:179], v[104:107], v[116:131]
  s_nop 7
  s_nop 3
  v_max3_f32 v110, v110, v116, v117
  v_max3_f32 v110, v110, v118, v119
  v_max3_f32 v110, v110, v120, v121
  v_max3_f32 v110, v110, v122, v123
  v_max3_f32 v110, v110, v124, v125
  v_max3_f32 v110, v110, v126, v127
  v_max3_f32 v110, v110, v128, v129
  v_max3_f32 v110, v110, v130, v131
  s_cmp_lt_u32 s53, 4
  s_cbranch_scc1 L_slow7
  ds_read_b128 v[172:175], v10 offset:2048
  ds_read_b128 v[176:179], v11 offset:2048
  s_waitcnt lgkmcnt(0)
  v_mfma_f32_32x32x16_bf16 v[116:131], v[172:175], v[100:103], 0
  v_mfma_f32_32x32x16_bf16 v[116:131], v[176:179], v[104:107], v[116:131]
  s_nop 7
  s_nop 3
  v_max3_f32 v110, v110, v116, v117
  v_max3_f32 v110, v110, v118, v119
  v_max3_f32 v110, v110, v120, v121
  v_max3_f32 v110, v110, v122, v123
  v_max3_f32 v110, v110, v124, v125
  v_max3_f32 v110, v110, v126, v127
  v_max3_f32 v110, v110, v128, v129
  v_max3_f32 v110, v110, v130, v131
  s_cmp_lt_u32 s53, 5
  s_cbranch_scc1 L_slow7
  ds_read_b128 v[172:175], v10 offset:1536
  ds_read_b128 v[176:179], v11 offset:1536
  s_waitcnt lgkmcnt(0)
  v_mfma_f32_32x32x16_bf16 v[116:131], v[172:175], v[100:103], 0
  v_mfma_f32_32x32x16_bf16 v[116:131], v[176:179], v[104:107], v[116:131]
  s_nop 7
  s_nop 3
  v_max3_f32 v110, v110, v116, v117
  v_max3_f32 v110, v110, v118, v119
  v_max3_f32 v110, v110, v120, v121
  v_max3_f32 v110, v110, v122, v123
  v_max3_f32 v110, v110, v124, v125
  v_max3_f32 v110, v110, v126, v127
  v_max3_f32 v110, v110, v128, v129
  v_max3_f32 v110, v110, v130, v131
  s_cmp_lt_u32 s53, 6
  s_cbranch_scc1 L_slow7
  ds_read_b128 v[172:175], v10 offset:1024
  ds_read_b128 v[176:179], v11 offset:1024
  s_waitcnt lgkmcnt(0)
  v_mfma_f32_32x32x16_bf16 v[116:131], v[172:175], v[100:103], 0
  v_mfma_f32_32x32x16_bf16 v[116:131], v[176:179], v[104:107], v[116:131]
  s_nop 7
  s_nop 3
  v_max3_f32 v110, v110, v116, v117
  v_max3_f32 v110, v110, v118, v119
  v_max3_f32 v110, v110, v120, v121
  v_max3_f32 v110, v110, v122, v123
  v_max3_f32 v110, v110, v124, v125
  v_max3_f32 v110, v110, v126, v127
  v_max3_f32 v110, v110, v128, v129
  v_max3_f32 v110, v110, v130, v131
  s_cmp_lt_u32 s53, 7
  s_cbranch_scc1 L_slow7
  ds_read_b128 v[172:175], v10 offset:512
  ds_read_b128 v[176:179], v11 offset:512
  s_waitcnt lgkmcnt(0)
  v_mfma_f32_32x32x16_bf16 v[116:131], v[172:175], v[100:103], 0
  v_mfma_f32_32x32x16_bf16 v[116:131], v[176:179], v[104:107], v[116:131]
  s_nop 7
  s_nop 3
  v_max3_f32 v110, v110, v116, v117
  v_max3_f32 v110, v110, v118, v119
  v_max3_f32 v110, v110, v120, v121
  v_max3_f32 v110, v110, v122, v123
  v_max3_f32 v110, v110, v124, v125
  v_max3_f32 v110, v110, v126, v127
  v_max3_f32 v110, v110, v128, v129
  v_max3_f32 v110, v110, v130, v131
  s_cmp_lt_u32 s53, 8
  s_cbranch_scc1 L_slow7
  ds_read_b128 v[172:175], v10 offset:0
  ds_read_b128 v[176:179], v11 offset:0
  s_waitcnt lgkmcnt(0)
  v_mfma_f32_32x32x16_bf16 v[116:131], v[172:175], v[100:103], v[40:55]
  v_mfma_f32_32x32x16_bf16 v[116:131], v[176:179], v[104:107], v[116:131]
  s_nop 7
  s_nop 3
  v_max3_f32 v110, v110, v116, v117
  v_max3_f32 v110, v110, v118, v119
  v_max3_f32 v110, v110, v120, v121
  v_max3_f32 v110, v110, v122, v123
  v_max3_f32 v110, v110, v124, v125
  v_max3_f32 v110, v110, v126, v127
  v_max3_f32 v110, v110, v128, v129
  v_max3_f32 v110, v110, v130, v131
L_slow7:
  ds_read_b128 v[172:175], v10 offset:3584
  ds_read_b128 v[176:179], v11 offset:3584
  s_waitcnt lgkmcnt(0)
  v_mfma_f32_32x32x16_bf16 v[116:131], v[172:175], v[100:103], 0
  v_mfma_f32_32x32x16_bf16 v[116:131], v[176:179], v[104:107], v[116:131]
  s_nop 7
  s_nop 3
  v_max3_f32 v110, v110, v116, v117
  v_max3_f32 v110, v110, v118, v119
  v_max3_f32 v110, v110, v120, v121
  v_max3_f32 v110, v110, v122, v123
  v_max3_f32 v110, v110, v124, v125
  v_max3_f32 v110, v110, v126, v127
  v_max3_f32 v110, v110, v128, v129
  v_max3_f32 v110, v110, v130, v131
  ds_read_b128 v[180:183], v10 offset:4096
  ds_read_b128 v[184:187], v11 offset:4096
  ds_read_b128 v[236:239], v10 offset:0
  ds_read_b128 v[240:243], v11 offset:0
  s_branch L_set
L_bcu:
  s_cmp_eq_u32 s46, 0
  s_cbranch_scc0 L_cq_95
  s_and_b32 s64, s45, 1
  s_lshl_b32 s64, s64, 7
  s_add_u32 s64, s64, 768
  s_mov_b32 s18, L_codeend-L_pcref2
  s_getpc_b64 s[62:63]
L_pcref2:
  v_lshl_add_u32 v6, v1, 8, s64
  v_cmp_gt_u32 s[64:65], s18, v6
  v_mov_b32 v5, s63
  v_add_co_u32 v4, vcc, s62, v6
  s_nop 1
  v_addc_co_u32 v5, vcc, 0, v5, vcc
  s_mov_b64 exec, s[64:65]
  s_cbranch_execz L_cq_95x
  global_load_dword v251, v[4:5], off
L_cq_95x:
  s_mov_b64 exec, -1
L_cq_95:
  s_waitcnt lgkmcnt(0)
  s_mov_b32 s20, s10
  s_mov_b32 s21, s11
  s_mov_b32 s22, 2621440
  s_mov_b32 s23, 0x20000
  s_mov_b32 s28, s8
  s_mov_b32 s29, s9
  s_mov_b32 s30, 819200
  s_mov_b32 s31, 0x20000
  s_mov_b32 s32, s12
  s_mov_b32 s33, s13
  s_mov_b32 s34, 5242880
  s_mov_b32 s35, 0x20000
  s_mov_b32 s40, s14
  s_mov_b32 s41, s15
  s_mov_b32 s42, 256
  s_mov_b32 s43, 0x20000
  s_mov_b32 s36, s16
  s_mov_b32 s37, s17
  s_mov_b32 s38, 14680064
  s_mov_b32 s39, 0x20000
  s_lshl_b32 s74, s44, 1
  s_add_u32 s74, s74, s45
  s_sub_u32 s47, s74, 30
  s_lshl_b32 s74, s47, 7
  s_add_u32 s74, s74, 13664256
  s_mov_b32 s73, 0
  s_bitcmp1_b32 0x0f000000, s45
  s_cselect_b32 s54, 1, 0
  s_cmp_ge_u32 s45, 28
  s_cselect_b32 s5, 4, 0
  s_sub_u32 s5, s45, s5
  s_mul_i32 s56, s5, 37
  s_lshr_b32 s56, s56, 8
  s_mul_i32 s4, s56, 7
  s_sub_u32 s100, s5, s4
  s_lshr_b32 s4, s44, 1
  s_mul_i32 s55, s4, 7
  s_add_u32 s55, s55, s100
  s_add_u32 s55, s55, 4
  s_and_b32 s5, s45, 3
  s_lshl_b32 s6, s5, 1
  s_add_u32 s6, s6, 1
  s_cmp_eq_u32 s54, 1
  s_cselect_b32 s55, s5, s55
  s_cselect_b32 s56, s4, s56
  s_cselect_b32 s100, s6, s100
  s_and_b32 s4, s44, 1
  s_lshl_b32 s4, s4, 2
  s_add_u32 s56, s56, s4
  s_lshl_b32 s62, s47, 1
  s_add_u32 s62, s62, 1
  s_mov_b32 s63, 0
  s_mov_b32 s4, s62
  s_sub_u32 s5, 2048, s62
  s_mov_b32 s6, -64
  s_cmp_ge_u32 s46, 4
  s_cselect_b32 s7, s5, s4
  s_cselect_b32 s49, s6, 64
  s_and_b32 s9, s46, 3
  s_lshl_b32 s9, s9, 3
  s_mul_i32 s10, s9, s49
  s_add_u32 s48, s7, s10
  v_lshrrev_b32 v4, 1, v1
  v_mul_i32_i24 v4, s49, v4
  v_add_u32 v4, s48, v4
  v_and_b32 v4, 2047, v4
  v_mul_u32_u24 v4, 1280, v4
  v_and_b32 v5, 1, v1
  v_mul_u32_u24 v5, 640, v5
  v_add_u32 v23, v4, v5
  s_mul_i32 s50, s46, 10752
  s_lshl_b32 s52, s46, 6
  s_add_u32 s52, s52, 161280
  s_and_b32 s51, s48, 2047
  s_mul_i32 s51, s51, 1280
  s_add_u32 m0, s50, 0
  s_add_u32 s48, s48, s49
  s_mov_b32 exec_hi, 0xff
  buffer_load_dwordx4 v17, s[20:23], s51 offen lds
  buffer_load_dwordx4 v17, s[20:23], s51 offen offset:640 lds
  s_mov_b32 exec_hi, -1
  s_and_b32 s51, s48, 2047
  s_mul_i32 s51, s51, 1280
  s_add_u32 m0, s50, 1344
  s_add_u32 s48, s48, s49
  s_mov_b32 exec_hi, 0xff
  buffer_load_dwordx4 v17, s[20:23], s51 offen lds
  buffer_load_dwordx4 v17, s[20:23], s51 offen offset:640 lds
  s_mov_b32 exec_hi, -1
  s_and_b32 s51, s48, 2047
  s_mul_i32 s51, s51, 1280
  s_add_u32 m0, s50, 2688
  s_add_u32 s48, s48, s49
  s_mov_b32 exec_hi, 0xff
  buffer_load_dwordx4 v17, s[20:23], s51 offen lds
  buffer_load_dwordx4 v17, s[20:23], s51 offen offset:640 lds
  s_mov_b32 exec_hi, -1
  s_and_b32 s69, s46, 1
  s_lshr_b32 s70, s46, 1
  s_lshr_b32 s13, s46, 2
  s_lshl_b32 s71, s13, 1
  s_add_u32 s71, s71, s46
  s_and_b32 s71, s71, 3
  s_xor_b32 s13, s13, 1
  s_lshl_b32 s13, s13, 1
  s_and_b32 s14, s71, 1
  s_lshr_b32 s15, s71, 1
  s_cmp_eq_u32 s15, 1
  s_cselect_b32 s16, 0x3e800000, 0
  v_bfe_u32 v4, v2, 2, 1
  v_lshlrev_b32 v4, 4, v4
  v_lshrrev_b32 v5, 3, v2
  v_lshl_add_u32 v4, v5, 2, v4
  v_and_b32 v5, 3, v2
  v_add_u32 v4, v4, v5
  s_lshl_b32 s4, s13, 5
  v_add_u32 v4, s4, v4
  v_lshl_add_u32 v4, v4, 1, s14
  v_cvt_f32_u32 v24, v4
  v_cvt_f32_u32 v5, v3
  v_mul_f32 v9, 4.0, v5
  v_mov_b32 v8, 1.0
  v_cndmask_b32 v8, v8, 0.5, s[60:61]
  v_mul_f32 v6, 0x3acccccd, v24
  v_fma_f32 v7, v6, v9, -s16
  v_mul_f32 v4, 0x41800000, v6
  v_cos_f32 v4, v4
  v_fmamk_f32 v164, v6, 0x3f800000, v7
  v_fmamk_f32 v165, v6, 0x40000000, v7
  v_fmamk_f32 v166, v6, 0x40400000, v7
  v_fmamk_f32 v167, v6, 0x40800000, v7
  v_fmamk_f32 v168, v6, 0x41100000, v7
  v_fmamk_f32 v169, v6, 0x41200000, v7
  v_fmamk_f32 v170, v6, 0x41300000, v7
  v_fmamk_f32 v171, v6, 0x41400000, v7
  v_fmamk_f32 v172, v6, 0x41880000, v7
  v_fmamk_f32 v173, v6, 0x41900000, v7
  v_fmamk_f32 v174, v6, 0x41980000, v7
  v_fmamk_f32 v175, v6, 0x41a00000, v7
  v_fmamk_f32 v176, v6, 0x41c80000, v7
  v_fmamk_f32 v177, v6, 0x41d00000, v7
  v_fmamk_f32 v178, v6, 0x41d80000, v7
  v_fmamk_f32 v179, v6, 0x41e00000, v7
  v_add_f32 v4, v4, v4
  v_sub_f32 v5, 0, v4
  v_cos_f32 v164, v164
  v_cos_f32 v165, v165
  v_cos_f32 v166, v166
  v_cos_f32 v167, v167
  v_cos_f32 v168, v168
  v_cos_f32 v169, v169
  v_cos_f32 v170, v170
  v_cos_f32 v171, v171
  v_cos_f32 v172, v172
  v_cos_f32 v173, v173
  v_cos_f32 v174, v174
  v_cos_f32 v175, v175
  v_cos_f32 v176, v176
  v_cos_f32 v177, v177
  v_cos_f32 v178, v178
  v_cos_f32 v179, v179
  v_cvt_pk_bf16_f32 v44, v164, v165
  v_cvt_pk_bf16_f32 v45, v166, v167
  v_cvt_pk_bf16_f32 v46, v168, v169
  v_cvt_pk_bf16_f32 v47, v170, v171
  v_cvt_pk_bf16_f32 v48, v172, v173
  v_cvt_pk_bf16_f32 v49, v174, v175
  v_cvt_pk_bf16_f32 v50, v176, v177
  v_cvt_pk_bf16_f32 v51, v178, v179
  v_pk_fma_f32 v[164:165], v[172:173], v[4:5], v[164:165] op_sel:[0,1,0] op_sel_hi:[1,1,1]
  v_pk_fma_f32 v[166:167], v[174:175], v[4:5], v[166:167] op_sel:[0,1,0] op_sel_hi:[1,1,1]
  v_pk_fma_f32 v[168:169], v[176:177], v[4:5], v[168:169] op_sel:[0,1,0] op_sel_hi:[1,1,1]
  v_pk_fma_f32 v[170:171], v[178:179], v[4:5], v[170:171] op_sel:[0,1,0] op_sel_hi:[1,1,1]
  v_cvt_pk_bf16_f32 v52, -v164, -v165
  v_cvt_pk_bf16_f32 v53, -v166, -v167
  v_cvt_pk_bf16_f32 v54, -v168, -v169
  v_cvt_pk_bf16_f32 v55, -v170, -v171
  v_pk_fma_f32 v[172:173], v[164:165], v[4:5], v[172:173] op_sel_hi:[1,0,1]
  v_pk_fma_f32 v[174:175], v[166:167], v[4:5], v[174:175] op_sel_hi:[1,0,1]
  v_pk_fma_f32 v[176:177], v[168:169], v[4:5], v[176:177] op_sel_hi:[1,0,1]
  v_pk_fma_f32 v[178:179], v[170:171], v[4:5], v[178:179] op_sel_hi:[1,0,1]
  v_cvt_pk_bf16_f32 v56, -v172, -v173
  v_cvt_pk_bf16_f32 v57, -v174, -v175
  v_cvt_pk_bf16_f32 v58, -v176, -v177
  v_cvt_pk_bf16_f32 v59, -v178, -v179
  v_pk_fma_f32 v[164:165], v[172:173], v[4:5], v[164:165] op_sel:[0,1,0] op_sel_hi:[1,1,1]
  v_pk_fma_f32 v[166:167], v[174:175], v[4:5], v[166:167] op_sel:[0,1,0] op_sel_hi:[1,1,1]
  v_pk_fma_f32 v[168:169], v[176:177], v[4:5], v[168:169] op_sel:[0,1,0] op_sel_hi:[1,1,1]
  v_pk_fma_f32 v[170:171], v[178:179], v[4:5], v[170:171] op_sel:[0,1,0] op_sel_hi:[1,1,1]
  v_cvt_pk_bf16_f32 v60, v164, v165
  v_cvt_pk_bf16_f32 v61, v166, v167
  v_cvt_pk_bf16_f32 v62, v168, v169
  v_cvt_pk_bf16_f32 v63, v170, v171
  v_pk_fma_f32 v[172:173], v[164:165], v[4:5], v[172:173] op_sel_hi:[1,0,1]
  v_pk_fma_f32 v[174:175], v[166:167], v[4:5], v[174:175] op_sel_hi:[1,0,1]
  v_pk_fma_f32 v[176:177], v[168:169], v[4:5], v[176:177] op_sel_hi:[1,0,1]
  v_pk_fma_f32 v[178:179], v[170:171], v[4:5], v[178:179] op_sel_hi:[1,0,1]
  v_cvt_pk_bf16_f32 v64, v172, v173
  v_cvt_pk_bf16_f32 v65, v174, v175
  v_cvt_pk_bf16_f32 v66, v176, v177
  v_cvt_pk_bf16_f32 v67, v178, v179
  v_pk_fma_f32 v[164:165], v[172:173], v[4:5], v[164:165] op_sel:[0,1,0] op_sel_hi:[1,1,1]
  v_pk_fma_f32 v[166:167], v[174:175], v[4:5], v[166:167] op_sel:[0,1,0] op_sel_hi:[1,1,1]
  v_pk_fma_f32 v[168:169], v[176:177], v[4:5], v[168:169] op_sel:[0,1,0] op_sel_hi:[1,1,1]
  v_pk_fma_f32 v[170:171], v[178:179], v[4:5], v[170:171] op_sel:[0,1,0] op_sel_hi:[1,1,1]
  v_cvt_pk_bf16_f32 v68, -v164, -v165
  v_cvt_pk_bf16_f32 v69, -v166, -v167
  v_cvt_pk_bf16_f32 v70, -v168, -v169
  v_cvt_pk_bf16_f32 v71, -v170, -v171
  v_pk_fma_f32 v[172:173], v[164:165], v[4:5], v[172:173] op_sel_hi:[1,0,1]
  v_pk_fma_f32 v[174:175], v[166:167], v[4:5], v[174:175] op_sel_hi:[1,0,1]
  v_pk_fma_f32 v[176:177], v[168:169], v[4:5], v[176:177] op_sel_hi:[1,0,1]
  v_pk_fma_f32 v[178:179], v[170:171], v[4:5], v[178:179] op_sel_hi:[1,0,1]
  v_cvt_pk_bf16_f32 v72, -v172, -v173
  v_cvt_pk_bf16_f32 v73, -v174, -v175
  s_and_b32 s51, s48, 2047
  s_mul_i32 s51, s51, 1280
  s_add_u32 m0, s50, 4032
  s_add_u32 s48, s48, s49
  s_mov_b32 exec_hi, 0xff
  buffer_load_dwordx4 v17, s[20:23], s51 offen lds
  buffer_load_dwordx4 v17, s[20:23], s51 offen offset:640 lds
  s_mov_b32 exec_hi, -1
  v_cvt_pk_bf16_f32 v74, -v176, -v177
  v_cvt_pk_bf16_f32 v75, -v178, -v179
  v_pk_fma_f32 v[164:165], v[172:173], v[4:5], v[164:165] op_sel:[0,1,0] op_sel_hi:[1,1,1]
  v_pk_fma_f32 v[166:167], v[174:175], v[4:5], v[166:167] op_sel:[0,1,0] op_sel_hi:[1,1,1]
  v_pk_fma_f32 v[168:169], v[176:177], v[4:5], v[168:169] op_sel:[0,1,0] op_sel_hi:[1,1,1]
  v_pk_fma_f32 v[170:171], v[178:179], v[4:5], v[170:171] op_sel:[0,1,0] op_sel_hi:[1,1,1]
  v_cvt_pk_bf16_f32 v76, v164, v165
  v_cvt_pk_bf16_f32 v77, v166, v167
  v_cvt_pk_bf16_f32 v78, v168, v169
  v_cvt_pk_bf16_f32 v79, v170, v171
  v_pk_fma_f32 v[172:173], v[164:165], v[4:5], v[172:173] op_sel_hi:[1,0,1]
  v_pk_fma_f32 v[174:175], v[166:167], v[4:5], v[174:175] op_sel_hi:[1,0,1]
  v_pk_fma_f32 v[176:177], v[168:169], v[4:5], v[176:177] op_sel_hi:[1,0,1]
  v_pk_fma_f32 v[178:179], v[170:171], v[4:5], v[178:179] op_sel_hi:[1,0,1]
  v_mul_f32 v179, v8, v179
  v_cvt_pk_bf16_f32 v80, v172, v173
  v_cvt_pk_bf16_f32 v81, v174, v175
  v_cvt_pk_bf16_f32 v82, v176, v177
  v_cvt_pk_bf16_f32 v83, v178, v179
  v_add_f32 v24, 0x42800000, v24
  v_mul_f32 v6, 0x3acccccd, v24
  v_fma_f32 v7, v6, v9, -s16
  v_mul_f32 v4, 0x41800000, v6
  v_cos_f32 v4, v4
  v_fmamk_f32 v164, v6, 0x3f800000, v7
  v_fmamk_f32 v165, v6, 0x40000000, v7
  v_fmamk_f32 v166, v6, 0x40400000, v7
  v_fmamk_f32 v167, v6, 0x40800000, v7
  v_fmamk_f32 v168, v6, 0x41100000, v7
  v_fmamk_f32 v169, v6, 0x41200000, v7
  v_fmamk_f32 v170, v6, 0x41300000, v7
  v_fmamk_f32 v171, v6, 0x41400000, v7
  v_fmamk_f32 v172, v6, 0x41880000, v7
  v_fmamk_f32 v173, v6, 0x41900000, v7
  v_fmamk_f32 v174, v6, 0x41980000, v7
  v_fmamk_f32 v175, v6, 0x41a00000, v7
  v_fmamk_f32 v176, v6, 0x41c80000, v7
  v_fmamk_f32 v177, v6, 0x41d00000, v7
  v_fmamk_f32 v178, v6, 0x41d80000, v7
  v_fmamk_f32 v179, v6, 0x41e00000, v7
  v_add_f32 v4, v4, v4
  v_sub_f32 v5, 0, v4
  v_cos_f32 v164, v164
  v_cos_f32 v165, v165
  v_cos_f32 v166, v166
  v_cos_f32 v167, v167
  v_cos_f32 v168, v168
  v_cos_f32 v169, v169
  s_and_b32 s51, s48, 2047
  s_mul_i32 s51, s51, 1280
  s_add_u32 m0, s50, 5376
  s_add_u32 s48, s48, s49
  s_mov_b32 exec_hi, 0xff
  buffer_load_dwordx4 v17, s[20:23], s51 offen lds
  buffer_load_dwordx4 v17, s[20:23], s51 offen offset:640 lds
  s_mov_b32 exec_hi, -1
  v_cos_f32 v170, v170
  v_cos_f32 v171, v171
  v_cos_f32 v172, v172
  v_cos_f32 v173, v173
  v_cos_f32 v174, v174
  v_cos_f32 v175, v175
  v_cos_f32 v176, v176
  v_cos_f32 v177, v177
  v_cos_f32 v178, v178
  v_cos_f32 v179, v179
  v_cvt_pk_bf16_f32 v84, v164, v165
  v_cvt_pk_bf16_f32 v85, v166, v167
  v_cvt_pk_bf16_f32 v86, v168, v169
  v_cvt_pk_bf16_f32 v87, v170, v171
  v_cvt_pk_bf16_f32 v88, v172, v173
  v_cvt_pk_bf16_f32 v89, v174, v175
  v_cvt_pk_bf16_f32 v90, v176, v177
  v_cvt_pk_bf16_f32 v91, v178, v179
  v_pk_fma_f32 v[164:165], v[172:173], v[4:5], v[164:165] op_sel:[0,1,0] op_sel_hi:[1,1,1]
  v_pk_fma_f32 v[166:167], v[174:175], v[4:5], v[166:167] op_sel:[0,1,0] op_sel_hi:[1,1,1]
  v_pk_fma_f32 v[168:169], v[176:177], v[4:5], v[168:169] op_sel:[0,1,0] op_sel_hi:[1,1,1]
  v_pk_fma_f32 v[170:171], v[178:179], v[4:5], v[170:171] op_sel:[0,1,0] op_sel_hi:[1,1,1]
  v_cvt_pk_bf16_f32 v92, -v164, -v165
  v_cvt_pk_bf16_f32 v93, -v166, -v167
  v_cvt_pk_bf16_f32 v94, -v168, -v169
  v_cvt_pk_bf16_f32 v95, -v170, -v171
  v_pk_fma_f32 v[172:173], v[164:165], v[4:5], v[172:173] op_sel_hi:[1,0,1]
  v_pk_fma_f32 v[174:175], v[166:167], v[4:5], v[174:175] op_sel_hi:[1,0,1]
  v_pk_fma_f32 v[176:177], v[168:169], v[4:5], v[176:177] op_sel_hi:[1,0,1]
  v_pk_fma_f32 v[178:179], v[170:171], v[4:5], v[178:179] op_sel_hi:[1,0,1]
  v_cvt_pk_bf16_f32 v96, -v172, -v173
  v_cvt_pk_bf16_f32 v97, -v174, -v175
  v_cvt_pk_bf16_f32 v98, -v176, -v177
  v_cvt_pk_bf16_f32 v99, -v178, -v179
  v_pk_fma_f32 v[164:165], v[172:173], v[4:5], v[164:165] op_sel:[0,1,0] op_sel_hi:[1,1,1]
  v_pk_fma_f32 v[166:167], v[174:175], v[4:5], v[166:167] op_sel:[0,1,0] op_sel_hi:[1,1,1]
  v_pk_fma_f32 v[168:169], v[176:177], v[4:5], v[168:169] op_sel:[0,1,0] op_sel_hi:[1,1,1]
  v_pk_fma_f32 v[170:171], v[178:179], v[4:5], v[170:171] op_sel:[0,1,0] op_sel_hi:[1,1,1]
  v_cvt_pk_bf16_f32 v100, v164, v165
  v_cvt_pk_bf16_f32 v101, v166, v167
  v_cvt_pk_bf16_f32 v102, v168, v169
  v_cvt_pk_bf16_f32 v103, v170, v171
  v_pk_fma_f32 v[172:173], v[164:165], v[4:5], v[172:173] op_sel_hi:[1,0,1]
  v_pk_fma_f32 v[174:175], v[166:167], v[4:5], v[174:175] op_sel_hi:[1,0,1]
  v_pk_fma_f32 v[176:177], v[168:169], v[4:5], v[176:177] op_sel_hi:[1,0,1]
  v_pk_fma_f32 v[178:179], v[170:171], v[4:5], v[178:179] op_sel_hi:[1,0,1]
  v_cvt_pk_bf16_f32 v104, v172, v173
  s_and_b32 s51, s48, 2047
  s_mul_i32 s51, s51, 1280
  s_add_u32 m0, s50, 6720
  s_add_u32 s48, s48, s49
  s_mov_b32 exec_hi, 0xff
  buffer_load_dwordx4 v17, s[20:23], s51 offen lds
  buffer_load_dwordx4 v17, s[20:23], s51 offen offset:640 lds
  s_mov_b32 exec_hi, -1
  v_cvt_pk_bf16_f32 v105, v174, v175
  v_cvt_pk_bf16_f32 v106, v176, v177
  v_cvt_pk_bf16_f32 v107, v178, v179
  v_pk_fma_f32 v[164:165], v[172:173], v[4:5], v[164:165] op_sel:[0,1,0] op_sel_hi:[1,1,1]
  v_pk_fma_f32 v[166:167], v[174:175], v[4:5], v[166:167] op_sel:[0,1,0] op_sel_hi:[1,1,1]
  v_pk_fma_f32 v[168:169], v[176:177], v[4:5], v[168:169] op_sel:[0,1,0] op_sel_hi:[1,1,1]
  v_pk_fma_f32 v[170:171], v[178:179], v[4:5], v[170:171] op_sel:[0,1,0] op_sel_hi:[1,1,1]
  v_cvt_pk_bf16_f32 v108, -v164, -v165
  v_cvt_pk_bf16_f32 v109, -v166, -v167
  v_cvt_pk_bf16_f32 v110, -v168, -v169
  v_cvt_pk_bf16_f32 v111, -v170, -v171
  v_pk_fma_f32 v[172:173], v[164:165], v[4:5], v[172:173] op_sel_hi:[1,0,1]
  v_pk_fma_f32 v[174:175], v[166:167], v[4:5], v[174:175] op_sel_hi:[1,0,1]
  v_pk_fma_f32 v[176:177], v[168:169], v[4:5], v[176:177] op_sel_hi:[1,0,1]
  v_pk_fma_f32 v[178:179], v[170:171], v[4:5], v[178:179] op_sel_hi:[1,0,1]
  v_cvt_pk_bf16_f32 v112, -v172, -v173
  v_cvt_pk_bf16_f32 v113, -v174, -v175
  v_cvt_pk_bf16_f32 v114, -v176, -v177
  v_cvt_pk_bf16_f32 v115, -v178, -v179
  v_pk_fma_f32 v[164:165], v[172:173], v[4:5], v[164:165] op_sel:[0,1,0] op_sel_hi:[1,1,1]
  v_pk_fma_f32 v[166:167], v[174:175], v[4:5], v[166:167] op_sel:[0,1,0] op_sel_hi:[1,1,1]
  v_pk_fma_f32 v[168:169], v[176:177], v[4:5], v[168:169] op_sel:[0,1,0] op_sel_hi:[1,1,1]
  v_pk_fma_f32 v[170:171], v[178:179], v[4:5], v[170:171] op_sel:[0,1,0] op_sel_hi:[1,1,1]
  v_cvt_pk_bf16_f32 v116, v164, v165
  v_cvt_pk_bf16_f32 v117, v166, v167
  v_cvt_pk_bf16_f32 v118, v168, v169
  v_cvt_pk_bf16_f32 v119, v170, v171
  v_pk_fma_f32 v[172:173], v[164:165], v[4:5], v[172:173] op_sel_hi:[1,0,1]
  v_pk_fma_f32 v[174:175], v[166:167], v[4:5], v[174:175] op_sel_hi:[1,0,1]
  v_pk_fma_f32 v[176:177], v[168:169], v[4:5], v[176:177] op_sel_hi:[1,0,1]
  v_pk_fma_f32 v[178:179], v[170:171], v[4:5], v[178:179] op_sel_hi:[1,0,1]
  v_mul_f32 v179, v8, v179
  v_cvt_pk_bf16_f32 v120, v172, v173
  v_cvt_pk_bf16_f32 v121, v174, v175
  v_cvt_pk_bf16_f32 v122, v176, v177
  v_cvt_pk_bf16_f32 v123, v178, v179
  v_add_f32 v24, 0x42800000, v24
  v_mov_b32 v124, 0x3f80bf80
  v_mov_b32 v125, 0x3f80bf80
  v_mov_b32 v126, 0x3f80bf80
  v_mov_b32 v127, 0x3f80bf80
  v_mov_b32 v128, 0x3f80bf80
  v_mov_b32 v129, 0x3f80bf80
  v_mov_b32 v130, 0x3f80bf80
  v_mov_b32 v131, 0x3f80bf80
  v_mov_b32 v4, 0x3f00bf80
  v_cndmask_b32 v131, v131, v4, s[60:61]
  v_mov_b32 v253, v24
  s_and_b32 s51, s48, 2047
  s_mul_i32 s51, s51, 1280
  s_add_u32 m0, s50, 8064
  s_add_u32 s48, s48, s49
  s_mov_b32 exec_hi, 0xff
  buffer_load_dwordx4 v17, s[20:23], s51 offen lds
  buffer_load_dwordx4 v17, s[20:23], s51 offen offset:640 lds
  s_mov_b32 exec_hi, -1
  v_mov_b32 v14, 2147483632
  v_mov_b32 v15, v14
  v_mov_b32 v16, v14
  s_mov_b32 s54, s62
  s_mov_b32 s65, 0
  v_add_u32 v4, 0, v1
  v_mul_u32_u24 v5, 205, v4
  v_lshrrev_b32 v5, 12, v5
  v_mul_u32_u24 v6, 20, v5
  v_sub_u32 v4, v4, v6
  v_and_b32 v6, 1, v5
  v_lshrrev_b32 v5, 1, v5
  v_mul_u32_u24 v5, 1344, v5
  v_mul_u32_u24 v6, 640, v6
  v_lshl_add_u32 v4, v4, 4, v5
  v_add3_u32 v18, v4, v6, s50
  v_add_u32 v4, 64, v1
  v_mul_u32_u24 v5, 205, v4
  v_lshrrev_b32 v5, 12, v5
  v_mul_u32_u24 v6, 20, v5
  v_sub_u32 v4, v4, v6
  v_and_b32 v6, 1, v5
  v_lshrrev_b32 v5, 1, v5
  v_mul_u32_u24 v5, 1344, v5
  v_mul_u32_u24 v6, 640, v6
  v_lshl_add_u32 v4, v4, 4, v5
  v_add3_u32 v19, v4, v6, s50
  v_add_u32 v4, 128, v1
  v_mul_u32_u24 v5, 205, v4
  v_lshrrev_b32 v5, 12, v5
  v_mul_u32_u24 v6, 20, v5
  v_sub_u32 v4, v4, v6
  v_and_b32 v6, 1, v5
  v_lshrrev_b32 v5, 1, v5
  v_mul_u32_u24 v5, 1344, v5
  v_mul_u32_u24 v6, 640, v6
  v_lshl_add_u32 v4, v4, 4, v5
  v_add3_u32 v20, v4, v6, s50
  v_add_u32 v4, 192, v1
  v_mul_u32_u24 v5, 205, v4
  v_lshrrev_b32 v5, 12, v5
  v_mul_u32_u24 v6, 20, v5
  v_sub_u32 v4, v4, v6
  v_and_b32 v6, 1, v5
  v_lshrrev_b32 v5, 1, v5
  v_mul_u32_u24 v5, 1344, v5
  v_mul_u32_u24 v6, 640, v6
  s_and_b32 s51, s48, 2047
  s_mul_i32 s51, s51, 1280
  s_add_u32 m0, s50, 9408
  s_add_u32 s48, s48, s49
  s_mov_b32 exec_hi, 0xff
  buffer_load_dwordx4 v17, s[20:23], s51 offen lds
  buffer_load_dwordx4 v17, s[20:23], s51 offen offset:640 lds
  s_mov_b32 exec_hi, -1
  v_lshl_add_u32 v4, v4, 4, v5
  v_add3_u32 v21, v4, v6, s50
  v_add_u32 v4, 256, v1
  v_mul_u32_u24 v5, 205, v4
  v_lshrrev_b32 v5, 12, v5
  v_mul_u32_u24 v6, 20, v5
  v_sub_u32 v4, v4, v6
  v_and_b32 v6, 1, v5
  v_lshrrev_b32 v5, 1, v5
  v_mul_u32_u24 v5, 1344, v5
  v_mul_u32_u24 v6, 640, v6
  v_lshl_add_u32 v4, v4, 4, v5
  v_add3_u32 v22, v4, v6, s50
  v_bfe_u32 v4, v1, 2, 2
  v_lshl_add_u32 v4, v3, 3, v4
  v_bfe_u32 v5, v1, 4, 1
  v_and_b32 v6, 3, v1
  v_lshlrev_b32 v7, 3, v6
  v_lshl_add_u32 v5, v5, 5, v7
  v_mul_u32_u24 v7, 1344, v4
  s_lshl_b32 s4, s70, 6
  v_add3_u32 v26, v7, v5, s4
  v_sub_u32 v27, v7, v5
  s_sub_u32 s4, 632, s4
  v_add_u32 v27, s4, v27
  v_lshlrev_b32 v6, 3, v4
  v_add_u32 v252, 161280, v6
  s_mul_i32 s4, s69, 20480
  s_lshl_b32 s5, s70, 11
  s_add_u32 s4, s4, s5
  v_add_u32 v10, s4, v17
  s_mul_i32 s4, s71, 10240
  v_add_u32 v11, s4, v17
  s_lshl_b32 s4, s46, 12
  s_add_u32 s4, s4, 40960
  v_and_b32 v4, 7, v1
  v_lshlrev_b32 v5, 1, v3
  v_xor_b32 v5, v5, v4
  v_lshlrev_b32 v5, 4, v5
  v_lshl_add_u32 v5, v2, 7, v5
  v_add_u32 v12, s4, v5
  v_lshrrev_b32 v5, 3, v1
  v_xor_b32 v4, v4, v5
  v_lshlrev_b32 v4, 4, v4
  v_lshl_add_u32 v4, v5, 7, v4
  v_add_u32 v13, s4, v4
  s_mul_i32 s18, s14, 384
  s_lshl_b32 s4, s13, 6
  s_add_u32 s18, s18, s4
  s_add_u32 s18, s18, 11534336
  s_lshr_b32 s17, s71, 1
  s_add_u32 s17, s17, 1
  s_cmp_eq_u32 s14, 1
  s_cselect_b32 s17, 3, s17
  s_cmp_eq_u32 s3, 0
  s_cselect_b32 s17, 0, s17
  s_cselect_b32 s64, 2, 5
  s_mul_i32 s64, s64, -64
  s_cmp_eq_u32 s3, 1
  s_cbranch_scc1 L_aend_5001n
  v_mul_f32 v6, 0x3acccccd, v253
  v_fma_f32 v7, v6, v9, -s16
  v_mul_f32 v4, 0x41800000, v6
  v_cos_f32 v4, v4
  v_fmamk_f32 v164, v6, 0x3f800000, v7
  v_fmamk_f32 v165, v6, 0x40000000, v7
  v_fmamk_f32 v166, v6, 0x40400000, v7
  v_fmamk_f32 v167, v6, 0x40800000, v7
  v_fmamk_f32 v168, v6, 0x41100000, v7
  v_fmamk_f32 v169, v6, 0x41200000, v7
  v_fmamk_f32 v170, v6, 0x41300000, v7
  v_fmamk_f32 v171, v6, 0x41400000, v7
  v_fmamk_f32 v172, v6, 0x41880000, v7
  v_fmamk_f32 v173, v6, 0x41900000, v7
  v_fmamk_f32 v174, v6, 0x41980000, v7
  v_fmamk_f32 v175, v6, 0x41a00000, v7
  v_fmamk_f32 v176, v6, 0x41c80000, v7
  v_fmamk_f32 v177, v6, 0x41d00000, v7
  v_fmamk_f32 v178, v6, 0x41d80000, v7
  v_fmamk_f32 v179, v6, 0x41e00000, v7
  v_add_f32 v4, v4, v4
  v_sub_f32 v5, 0, v4
  v_cos_f32 v164, v164
  v_cos_f32 v165, v165
  v_cos_f32 v166, v166
  v_cos_f32 v167, v167
  v_cos_f32 v168, v168
  v_cos_f32 v169, v169
  v_cos_f32 v170, v170
  v_cos_f32 v171, v171
  v_cos_f32 v172, v172
  v_cos_f32 v173, v173
  v_cos_f32 v174, v174
  v_cos_f32 v175, v175
  v_cos_f32 v176, v176
  v_cos_f32 v177, v177
  v_cos_f32 v178, v178
  v_cos_f32 v179, v179
  v_cvt_pk_bf16_f32 v124, v164, v165
  v_cvt_pk_bf16_f32 v125, v166, v167
  v_cvt_pk_bf16_f32 v126, v168, v169
  v_cvt_pk_bf16_f32 v127, v170, v171
  v_cvt_pk_bf16_f32 v128, v172, v173
  v_cvt_pk_bf16_f32 v129, v174, v175
  v_cvt_pk_bf16_f32 v130, v176, v177
  v_cvt_pk_bf16_f32 v131, v178, v179
  v_pk_fma_f32 v[164:165], v[172:173], v[4:5], v[164:165] op_sel:[0,1,0] op_sel_hi:[1,1,1]
  v_pk_fma_f32 v[166:167], v[174:175], v[4:5], v[166:167] op_sel:[0,1,0] op_sel_hi:[1,1,1]
  v_pk_fma_f32 v[168:169], v[176:177], v[4:5], v[168:169] op_sel:[0,1,0] op_sel_hi:[1,1,1]
  v_pk_fma_f32 v[170:171], v[178:179], v[4:5], v[170:171] op_sel:[0,1,0] op_sel_hi:[1,1,1]
  v_cvt_pk_bf16_f32 v132, -v164, -v165
  v_cvt_pk_bf16_f32 v133, -v166, -v167
  v_cvt_pk_bf16_f32 v134, -v168, -v169
  v_cvt_pk_bf16_f32 v135, -v170, -v171
  v_pk_fma_f32 v[172:173], v[164:165], v[4:5], v[172:173] op_sel_hi:[1,0,1]
  v_pk_fma_f32 v[174:175], v[166:167], v[4:5], v[174:175] op_sel_hi:[1,0,1]
  v_pk_fma_f32 v[176:177], v[168:169], v[4:5], v[176:177] op_sel_hi:[1,0,1]
  v_pk_fma_f32 v[178:179], v[170:171], v[4:5], v[178:179] op_sel_hi:[1,0,1]
  v_cvt_pk_bf16_f32 v136, -v172, -v173
  v_cvt_pk_bf16_f32 v137, -v174, -v175
  v_cvt_pk_bf16_f32 v138, -v176, -v177
  v_cvt_pk_bf16_f32 v139, -v178, -v179
  v_pk_fma_f32 v[164:165], v[172:173], v[4:5], v[164:165] op_sel:[0,1,0] op_sel_hi:[1,1,1]
  v_pk_fma_f32 v[166:167], v[174:175], v[4:5], v[166:167] op_sel:[0,1,0] op_sel_hi:[1,1,1]
  v_pk_fma_f32 v[168:169], v[176:177], v[4:5], v[168:169] op_sel:[0,1,0] op_sel_hi:[1,1,1]
  v_pk_fma_f32 v[170:171], v[178:179], v[4:5], v[170:171] op_sel:[0,1,0] op_sel_hi:[1,1,1]
  v_cvt_pk_bf16_f32 v140, v164, v165
  v_cvt_pk_bf16_f32 v141, v166, v167
  v_cvt_pk_bf16_f32 v142, v168, v169
  v_cvt_pk_bf16_f32 v143, v170, v171
  v_pk_fma_f32 v[172:173], v[164:165], v[4:5], v[172:173] op_sel_hi:[1,0,1]
  v_pk_fma_f32 v[174:175], v[166:167], v[4:5], v[174:175] op_sel_hi:[1,0,1]
  v_pk_fma_f32 v[176:177], v[168:169], v[4:5], v[176:177] op_sel_hi:[1,0,1]
  v_pk_fma_f32 v[178:179], v[170:171], v[4:5], v[178:179] op_sel_hi:[1,0,1]
  v_cvt_pk_bf16_f32 v144, v172, v173
  v_cvt_pk_bf16_f32 v145, v174, v175
  v_cvt_pk_bf16_f32 v146, v176, v177
  v_cvt_pk_bf16_f32 v147, v178, v179
  v_pk_fma_f32 v[164:165], v[172:173], v[4:5], v[164:165] op_sel:[0,1,0] op_sel_hi:[1,1,1]
  v_pk_fma_f32 v[166:167], v[174:175], v[4:5], v[166:167] op_sel:[0,1,0] op_sel_hi:[1,1,1]
  v_pk_fma_f32 v[168:169], v[176:177], v[4:5], v[168:169] op_sel:[0,1,0] op_sel_hi:[1,1,1]
  v_pk_fma_f32 v[170:171], v[178:179], v[4:5], v[170:171] op_sel:[0,1,0] op_sel_hi:[1,1,1]
  v_cvt_pk_bf16_f32 v148, -v164, -v165
  v_cvt_pk_bf16_f32 v149, -v166, -v167
  v_cvt_pk_bf16_f32 v150, -v168, -v169
  v_cvt_pk_bf16_f32 v151, -v170, -v171
  v_pk_fma_f32 v[172:173], v[164:165], v[4:5], v[172:173] op_sel_hi:[1,0,1]
  v_pk_fma_f32 v[174:175], v[166:167], v[4:5], v[174:175] op_sel_hi:[1,0,1]
  v_pk_fma_f32 v[176:177], v[168:169], v[4:5], v[176:177] op_sel_hi:[1,0,1]
  v_pk_fma_f32 v[178:179], v[170:171], v[4:5], v[178:179] op_sel_hi:[1,0,1]
  v_cvt_pk_bf16_f32 v152, -v172, -v173
  v_cvt_pk_bf16_f32 v153, -v174, -v175
  v_cvt_pk_bf16_f32 v154, -v176, -v177
  v_cvt_pk_bf16_f32 v155, -v178, -v179
  v_pk_fma_f32 v[164:165], v[172:173], v[4:5], v[164:165] op_sel:[0,1,0] op_sel_hi:[1,1,1]
  v_pk_fma_f32 v[166:167], v[174:175], v[4:5], v[166:167] op_sel:[0,1,0] op_sel_hi:[1,1,1]
  v_pk_fma_f32 v[168:169], v[176:177], v[4:5], v[168:169] op_sel:[0,1,0] op_sel_hi:[1,1,1]
  v_pk_fma_f32 v[170:171], v[178:179], v[4:5], v[170:171] op_sel:[0,1,0] op_sel_hi:[1,1,1]
  v_cvt_pk_bf16_f32 v156, v164, v165
  v_cvt_pk_bf16_f32 v157, v166, v167
  v_cvt_pk_bf16_f32 v158, v168, v169
  v_cvt_pk_bf16_f32 v159, v170, v171
  v_pk_fma_f32 v[172:173], v[164:165], v[4:5], v[172:173] op_sel_hi:[1,0,1]
  v_pk_fma_f32 v[174:175], v[166:167], v[4:5], v[174:175] op_sel_hi:[1,0,1]
  v_pk_fma_f32 v[176:177], v[168:169], v[4:5], v[176:177] op_sel_hi:[1,0,1]
  v_pk_fma_f32 v[178:179], v[170:171], v[4:5], v[178:179] op_sel_hi:[1,0,1]
  v_mul_f32 v179, v8, v179
  v_cvt_pk_bf16_f32 v160, v172, v173
  v_cvt_pk_bf16_f32 v161, v174, v175
  v_cvt_pk_bf16_f32 v162, v176, v177
  v_cvt_pk_bf16_f32 v163, v178, v179
L_aend_5001n:
  s_or_b32 s4, s63, s69
  s_sub_u32 s4, 17, s4
  s_and_b32 s5, s63, s69
  s_sub_u32 s6, s5, 16
  v_cmp_gt_u32 s[66:67], s4, v2
  s_cmp_eq_u32 s69, 1
  s_cselect_b32 s10, 0x3e800000, 0
  s_cselect_b32 s11, 0x3f000000, 0x3e800000
  s_cselect_b32 s12, 0xbf800000, 0x3f800000
  s_cselect_b32 s68, 0x80008000, 0
  s_cmp_eq_u32 s63, 1
  s_cselect_b32 s11, s10, s11
  s_cselect_b32 s68, 0, s68
  s_cselect_b32 s7, 32, s62
  v_add_u32 v4, s69, v2
  s_mov_b32 m0, s52
  s_mov_b64 exec, 0xffff
  buffer_load_dword v23, s[20:23], 0 offen lds
  s_mov_b64 exec, -1
  v_add_u32 v5, s6, v2
  v_cndmask_b32 v4, v5, v4, s[66:67]
  v_mov_b32 v5, s11
  v_mov_b32 v6, s10
  v_cndmask_b32 v5, v5, v6, s[66:67]
  v_mov_b32 v6, s7
  v_mov_b32 v7, s62
  v_cmp_eq_u32 vcc, 16, v4
  v_cndmask_b32 v6, v6, v7, s[66:67]
  v_cvt_f32_u32 v4, v4
  v_cndmask_b32 v5, v5, 0, vcc
  v_cndmask_b32 v6, v6, 0, vcc
  v_lshl_add_u32 v6, v3, 9, v6
  v_cvt_f32_u32 v6, v6
  v_mul_f32 v7, 0x3a000000, v4
  v_mul_f32 v4, 0x3d000000, v4
  v_fma_f32 v7, v7, v6, -v5
  s_cmp_eq_u32 s63, 1
  s_cselect_b64 s[10:11], s[66:67], -1
  s_cselect_b64 s[66:67], s[66:67], 0
  v_cndmask_b32 v254, 0, -1, s[10:11]
  v_cndmask_b32 v255, -1, 0, s[66:67]
  s_mul_i32 s5, s5, 15
  s_cmp_eq_u32 s5, 0
  s_cselect_b32 s5, 99, s5
  v_cmp_eq_u32 vcc, s5, v2
  v_mov_b32 v24, s12
  v_fmamk_f32 v28, v4, 0x0, v7
  v_fmamk_f32 v29, v4, 0x3f800000, v7
  v_fmamk_f32 v30, v4, 0x40000000, v7
  v_fmamk_f32 v31, v4, 0x40400000, v7
  v_fmamk_f32 v32, v4, 0x40800000, v7
  v_fmamk_f32 v33, v4, 0x40a00000, v7
  v_fmamk_f32 v34, v4, 0x40c00000, v7
  v_fmamk_f32 v35, v4, 0x40e00000, v7
  v_fmamk_f32 v36, v4, 0x41800000, v7
  v_fmamk_f32 v37, v4, 0x41880000, v7
  v_fmamk_f32 v38, v4, 0x41900000, v7
  v_fmamk_f32 v39, v4, 0x41980000, v7
  v_fmamk_f32 v40, v4, 0x41a00000, v7
  v_fmamk_f32 v41, v4, 0x41a80000, v7
  v_fmamk_f32 v42, v4, 0x41b00000, v7
  v_fmamk_f32 v43, v4, 0x41b80000, v7
  v_cndmask_b32 v24, v24, 1.0, vcc
  v_cos_f32 v28, v28
  v_cos_f32 v29, v29
  v_cos_f32 v30, v30
  v_cos_f32 v31, v31
  v_cos_f32 v32, v32
  v_cos_f32 v33, v33
  v_cos_f32 v34, v34
  v_cos_f32 v35, v35
  v_cos_f32 v36, v36
  v_cos_f32 v37, v37
  v_cos_f32 v38, v38
  v_cos_f32 v39, v39
  v_cos_f32 v40, v40
  v_cos_f32 v41, v41
  v_cos_f32 v42, v42
  v_cos_f32 v43, v43
  s_nop 0
  v_cvt_pk_bf16_f32 v28, v28, v29
  v_cvt_pk_bf16_f32 v29, v30, v31
  v_cvt_pk_bf16_f32 v30, v32, v33
  v_cvt_pk_bf16_f32 v31, v34, v35
  v_cvt_pk_bf16_f32 v32, v36, v37
  v_cvt_pk_bf16_f32 v33, v38, v39
  v_cvt_pk_bf16_f32 v34, v40, v41
  v_cvt_pk_bf16_f32 v35, v42, v43
  v_xor_b32 v36, s68, v28
  v_and_b32 v36, v255, v36
  v_and_b32 v28, v254, v28
  v_xor_b32 v37, s68, v29
  v_and_b32 v37, v255, v37
  v_and_b32 v29, v254, v29
  v_xor_b32 v38, s68, v30
  v_and_b32 v38, v255, v38
  v_and_b32 v30, v254, v30
  v_xor_b32 v39, s68, v31
  v_and_b32 v39, v255, v39
  v_and_b32 v31, v254, v31
  v_xor_b32 v40, s68, v32
  v_and_b32 v40, v255, v40
  v_and_b32 v32, v254, v32
  v_xor_b32 v41, s68, v33
  v_and_b32 v41, v255, v41
  v_and_b32 v33, v254, v33
  v_xor_b32 v42, s68, v34
  v_and_b32 v42, v255, v42
  v_and_b32 v34, v254, v34
  v_xor_b32 v43, s68, v35
  v_and_b32 v43, v255, v43
  v_and_b32 v35, v254, v35
  s_or_b32 s4, s65, s15
  s_sub_u32 s4, 17, s4
  s_lshl_b32 s5, s15, 6
  s_add_u32 s5, s5, s54
  s_and_b32 s6, s65, s15
  s_sub_u32 s7, s6, 16
  s_mul_i32 s6, s6, 15
  s_cmp_eq_u32 s6, 0
  s_cselect_b32 s6, 99, s6
  v_and_b32 v254, 7, v1
  v_lshlrev_b32 v254, 4, v254
  v_mov_b32 v255, 2147483632
  v_lshrrev_b32 v4, 3, v1
  v_add_u32 v4, 0, v4
  v_cmp_gt_u32 vcc, s4, v4
  v_add_u32 v5, s15, v4
  v_add_u32 v6, s7, v4
  v_cndmask_b32 v5, v6, v5, vcc
  v_cndmask_b32 v6, 32, 0, vcc
  v_cmp_eq_u32 vcc, s6, v4
  v_lshl_add_u32 v5, v5, 7, v6
  v_add_u32 v5, s5, v5
  v_mul_u32_u24 v5, 768, v5
  v_add_u32 v5, v5, v254
  v_cndmask_b32 v14, v5, v255, vcc
  v_lshrrev_b32 v4, 3, v1
  v_add_u32 v4, 8, v4
  v_cmp_gt_u32 vcc, s4, v4
  v_add_u32 v5, s15, v4
  v_add_u32 v6, s7, v4
  v_cndmask_b32 v5, v6, v5, vcc
  v_cndmask_b32 v6, 32, 0, vcc
  v_cmp_eq_u32 vcc, s6, v4
  v_lshl_add_u32 v5, v5, 7, v6
  v_add_u32 v5, s5, v5
  v_mul_u32_u24 v5, 768, v5
  v_add_u32 v5, v5, v254
  v_cndmask_b32 v15, v5, v255, vcc
  v_lshrrev_b32 v4, 3, v1
  v_add_u32 v4, 16, v4
  v_cmp_gt_u32 vcc, s4, v4
  v_add_u32 v5, s15, v4
  v_add_u32 v6, s7, v4
  v_cndmask_b32 v5, v6, v5, vcc
  v_cndmask_b32 v6, 32, 0, vcc
  v_cmp_eq_u32 vcc, s6, v4
  v_lshl_add_u32 v5, v5, 7, v6
  v_add_u32 v5, s5, v5
  v_mul_u32_u24 v5, 768, v5
  v_add_u32 v5, v5, v254
  v_cndmask_b32 v16, v5, v255, vcc
  v_lshrrev_b32 v4, 3, v1
  v_add_u32 v4, 24, v4
  v_cmp_gt_u32 vcc, s4, v4
  v_add_u32 v5, s15, v4
  v_add_u32 v6, s7, v4
  v_cndmask_b32 v5, v6, v5, vcc
  v_cndmask_b32 v6, 32, 0, vcc
  v_cmp_eq_u32 vcc, s6, v4
  v_lshl_add_u32 v5, v5, 7, v6
  v_add_u32 v5, s5, v5
  v_mul_u32_u24 v5, 768, v5
  v_add_u32 v5, v5, v254
  v_cndmask_b32 v8, v5, v255, vcc
L_aend_5001:
  s_add_u32 s62, s62, 1
  s_sub_u32 s5, 2048, s62
  s_cmp_eq_u32 s47, 15
  s_cselect_b32 s62, 0, s62
  s_cselect_b32 s63, 1, 0
  s_cselect_b32 s5, 32, s5
  s_cselect_b32 s6, 64, -64
  s_mov_b32 s4, s62
  s_cmp_lt_u32 s46, 7
  s_cselect_b32 s19, 1, 2
  s_cselect_b32 s53, 1, 0
  s_cmp_ge_u32 s46, 4
  s_cselect_b32 s7, s5, s4
  s_cselect_b32 s49, s6, 64
  s_and_b32 s9, s46, 3
  s_lshl_b32 s9, s9, 3
  s_mul_i32 s10, s9, s49
  s_add_u32 s48, s7, s10
  v_lshrrev_b32 v4, 1, v1
  v_mul_i32_i24 v4, s49, v4
  v_add_u32 v4, s48, v4
  v_and_b32 v4, 2047, v4
  v_mul_u32_u24 v4, 1280, v4
  v_and_b32 v5, 1, v1
  v_mul_u32_u24 v5, 640, v5
  v_add_u32 v23, v4, v5
  s_mul_i32 s50, s46, 10752
  s_lshl_b32 s52, s46, 6
  s_add_u32 s52, s52, 161792
  s_cmp_lt_u32 s46, 7
  s_cselect_b32 s7, 86016, 0
  s_add_u32 s50, s50, s7
  v_mov_b32 v4, 162816
  v_mov_b32 v5, 0
  ds_write_b32 v4, v5
  ds_write_b32 v4, v5 offset:4
  ds_write_b32 v4, v5 offset:8
  s_waitcnt vmcnt(0)
  ds_read_b128 v[164:167], v18
  ds_read_b32 v168, v18 offset:16
  ds_read_b128 v[172:175], v19
  ds_read_b32 v176, v19 offset:16
  ds_read_b128 v[180:183], v20
  ds_read_b32 v184, v20 offset:16
  ds_read_b128 v[188:191], v21
  ds_read_b32 v192, v21 offset:16
  ds_read_b128 v[196:199], v22
  ds_read_b32 v200, v22 offset:16
  s_cmp_eq_u32 s53, 1
  s_cbranch_scc0 L_gi_96
  s_and_b32 s51, s48, 2047
  s_mul_i32 s51, s51, 1280
  s_add_u32 m0, s50, 0
  s_add_u32 s48, s48, s49
  s_mov_b32 exec_hi, 0xff
  buffer_load_dwordx4 v17, s[20:23], s51 offen lds
  buffer_load_dwordx4 v17, s[20:23], s51 offen offset:640 lds
  s_mov_b32 exec_hi, -1
  s_and_b32 s51, s48, 2047
  s_mul_i32 s51, s51, 1280
  s_add_u32 m0, s50, 1344
  s_add_u32 s48, s48, s49
  s_mov_b32 exec_hi, 0xff
  buffer_load_dwordx4 v17, s[20:23], s51 offen lds
  buffer_load_dwordx4 v17, s[20:23], s51 offen offset:640 lds
  s_mov_b32 exec_hi, -1
L_gi_96:
  s_waitcnt lgkmcnt(8)
  v_alignbit_b32 v164, v165, v164, 16
  v_alignbit_b32 v165, v166, v165, 16
  v_alignbit_b32 v166, v167, v166, 16
  v_alignbit_b32 v167, v168, v167, 16
  ds_write_b128 v18, v[164:167]
  s_waitcnt lgkmcnt(7)
  v_alignbit_b32 v172, v173, v172, 16
  v_alignbit_b32 v173, v174, v173, 16
  v_alignbit_b32 v174, v175, v174, 16
  v_alignbit_b32 v175, v176, v175, 16
  ds_write_b128 v19, v[172:175]
  s_waitcnt lgkmcnt(6)
  v_alignbit_b32 v180, v181, v180, 16
  v_alignbit_b32 v181, v182, v181, 16
  v_alignbit_b32 v182, v183, v182, 16
  v_alignbit_b32 v183, v184, v183, 16
  ds_write_b128 v20, v[180:183]
  s_waitcnt lgkmcnt(5)
  v_alignbit_b32 v188, v189, v188, 16
  v_alignbit_b32 v189, v190, v189, 16
  v_alignbit_b32 v190, v191, v190, 16
  v_alignbit_b32 v191, v192, v191, 16
  ds_write_b128 v21, v[188:191]
  s_waitcnt lgkmcnt(4)
  v_alignbit_b32 v196, v197, v196, 16
  v_alignbit_b32 v197, v198, v197, 16
  v_alignbit_b32 v198, v199, v198, 16
  v_alignbit_b32 v199, v200, v199, 16
  ds_write_b128 v22, v[196:199]
  s_setprio 0
  s_cmp_eq_u32 s70, 3
  s_cbranch_scc0 L_pr_97
  s_setprio 1
L_pr_97:
  s_waitcnt lgkmcnt(0)
  s_barrier
  s_cmp_lt_u32 s46, 2
  s_cbranch_scc0 L_nx_98
  ds_read_b64_tr_b16 v[180:181], v252 offset:0
  ds_read_b64_tr_b16 v[182:183], v252 offset:32
  ds_read_b64_tr_b16 v[184:185], v252 offset:128
  ds_read_b64_tr_b16 v[186:187], v252 offset:160
  ds_read_b64_tr_b16 v[188:189], v252 offset:256
  ds_read_b64_tr_b16 v[190:191], v252 offset:288
  ds_read_b64_tr_b16 v[192:193], v252 offset:384
  ds_read_b64_tr_b16 v[194:195], v252 offset:416
  s_waitcnt lgkmcnt(0)
  v_mfma_f32_32x32x16_bf16 v[164:179], v[180:183], v[28:31], 0
  v_mfma_f32_32x32x16_bf16 v[164:179], v[184:187], v[32:35], v[164:179]
  v_mfma_f32_32x32x16_bf16 v[164:179], v[188:191], v[36:39], v[164:179]
  v_mfma_f32_32x32x16_bf16 v[164:179], v[192:195], v[40:43], v[164:179]
  s_lshl_b32 s4, s46, 8
  s_add_u32 s4, s4, 162304
  v_lshl_add_u32 v4, v2, 2, s4
  s_nop 9
  v_add_f32 v5, v164, v166
  v_sub_f32 v6, v164, v166
  s_mov_b32 exec_hi, 0
  ds_write_b32 v4, v5
  ds_write_b32 v4, v6 offset:128
  s_mov_b32 exec_hi, -1
L_nx_98:
  v_add_u32 v4, 0, v26
  v_cndmask_b32 v5, v4, v26, s[60:61]
  v_add_u32 v5, 64512, v5
  v_add_u32 v6, 0, v27
  v_cndmask_b32 v7, v6, v27, s[60:61]
  v_add_u32 v7, 64512, v7
  s_cmp_eq_u32 s70, 3
  s_cselect_b32 s8, 2, 1
  ds_read_b64_tr_b16 v[228:229], v6 offset:0
  ds_read_b64_tr_b16 v[230:231], v6 offset:5376
  ds_read_b64_tr_b16 v[232:233], v6 offset:21504
  ds_read_b64_tr_b16 v[234:235], v6 offset:26880
  ds_read_b64_tr_b16 v[236:237], v6 offset:43008
  ds_read_b64_tr_b16 v[238:239], v6 offset:48384
  ds_read_b64_tr_b16 v[240:241], v7 offset:0
  ds_read_b64_tr_b16 v[242:243], v7 offset:5376
  ds_read_b64_tr_b16 v[244:245], v6 offset:640
  ds_read_b64_tr_b16 v[246:247], v6 offset:6016
L_chunk_99:
  s_waitcnt lgkmcnt(8)
  v_mfma_f32_32x32x16_bf16 v[196:211], v[228:231], v[28:31], 0
  ds_read_b64_tr_b16 v[248:249], v6 offset:22144
  ds_read_b64_tr_b16 v[250:251], v6 offset:27520
  s_cmp_eq_u32 s53, 1
  s_cbranch_scc0 L_gi_100
  s_and_b32 s51, s48, 2047
  s_mul_i32 s51, s51, 1280
  s_add_u32 m0, s50, 2688
  s_add_u32 s48, s48, s49
  s_mov_b32 exec_hi, 0xff
  buffer_load_dwordx4 v17, s[20:23], s51 offen lds
  buffer_load_dwordx4 v17, s[20:23], s51 offen offset:640 lds
  s_mov_b32 exec_hi, -1
L_gi_100:
  s_waitcnt lgkmcnt(8)
  v_mfma_f32_32x32x16_bf16 v[196:211], v[232:235], v[32:35], v[196:211]
  ds_read_b64_tr_b16 v[228:229], v6 offset:43648
  ds_read_b64_tr_b16 v[230:231], v6 offset:49024
  s_cmp_eq_u32 s53, 1
  s_cbranch_scc0 L_gi_101
  s_and_b32 s51, s48, 2047
  s_mul_i32 s51, s51, 1280
  s_add_u32 m0, s50, 4032
  s_add_u32 s48, s48, s49
  s_mov_b32 exec_hi, 0xff
  buffer_load_dwordx4 v17, s[20:23], s51 offen lds
  buffer_load_dwordx4 v17, s[20:23], s51 offen offset:640 lds
  s_mov_b32 exec_hi, -1
L_gi_101:
  s_waitcnt lgkmcnt(8)
  v_mfma_f32_32x32x16_bf16 v[196:211], v[236:239], v[36:39], v[196:211]
  ds_read_b64_tr_b16 v[232:233], v7 offset:640
  ds_read_b64_tr_b16 v[234:235], v7 offset:6016
  s_cmp_eq_u32 s53, 1
  s_cbranch_scc0 L_gi_102
  s_and_b32 s51, s48, 2047
  s_mul_i32 s51, s51, 1280
  s_add_u32 m0, s50, 5376
  s_add_u32 s48, s48, s49
  s_mov_b32 exec_hi, 0xff
  buffer_load_dwordx4 v17, s[20:23], s51 offen lds
  buffer_load_dwordx4 v17, s[20:23], s51 offen offset:640 lds
  s_mov_b32 exec_hi, -1
L_gi_102:
  s_waitcnt lgkmcnt(8)
  v_mfma_f32_32x32x16_bf16 v[196:211], v[240:243], v[40:43], v[196:211]
  ds_read_b64_tr_b16 v[236:237], v4 offset:640
  ds_read_b64_tr_b16 v[238:239], v4 offset:6016
  s_waitcnt lgkmcnt(8)
  v_mfma_f32_32x32x16_bf16 v[212:227], v[244:247], v[28:31], 0
  ds_read_b64_tr_b16 v[240:241], v4 offset:22144
  ds_read_b64_tr_b16 v[242:243], v4 offset:27520
  s_cmp_eq_u32 s53, 1
  s_cbranch_scc0 L_gi_103
  s_and_b32 s51, s48, 2047
  s_mul_i32 s51, s51, 1280
  s_add_u32 m0, s50, 6720
  s_add_u32 s48, s48, s49
  s_mov_b32 exec_hi, 0xff
  buffer_load_dwordx4 v17, s[20:23], s51 offen lds
  buffer_load_dwordx4 v17, s[20:23], s51 offen offset:640 lds
  s_mov_b32 exec_hi, -1
L_gi_103:
  s_waitcnt lgkmcnt(8)
  v_mfma_f32_32x32x16_bf16 v[212:227], v[248:251], v[32:35], v[212:227]
  ds_read_b64_tr_b16 v[244:245], v4 offset:43648
  ds_read_b64_tr_b16 v[246:247], v4 offset:49024
  s_waitcnt lgkmcnt(8)
  v_mfma_f32_32x32x16_bf16 v[212:227], v[228:231], v[36:39], v[212:227]
  ds_read_b64_tr_b16 v[248:249], v5 offset:640
  ds_read_b64_tr_b16 v[250:251], v5 offset:6016
  v_mul_f32 v180, v24, v199
  v_mul_f32 v181, v24, v198
  v_mul_f32 v182, v24, v197
  v_mul_f32 v183, v24, v196
  v_mul_f32 v184, v24, v203
  v_mul_f32 v185, v24, v202
  v_mul_f32 v186, v24, v201
  v_mul_f32 v187, v24, v200
  s_waitcnt lgkmcnt(8)
  v_mfma_f32_32x32x16_bf16 v[212:227], v[232:235], v[40:43], v[212:227]
  v_mul_f32 v188, v24, v207
  v_mul_f32 v189, v24, v206
  v_mul_f32 v190, v24, v205
  v_mul_f32 v191, v24, v204
  v_mul_f32 v192, v24, v211
  v_mul_f32 v193, v24, v210
  v_mul_f32 v194, v24, v209
  v_mul_f32 v195, v24, v208
  ds_read_b64_tr_b16 v[228:229], v4 offset:0
  ds_read_b64_tr_b16 v[230:231], v4 offset:5376
  s_waitcnt lgkmcnt(8)
  v_mfma_f32_32x32x16_bf16 v[180:195], v[236:239], v[28:31], v[180:195]
  ds_read_b64_tr_b16 v[232:233], v4 offset:21504
  ds_read_b64_tr_b16 v[234:235], v4 offset:26880
  s_cmp_eq_u32 s53, 1
  s_cbranch_scc0 L_gi_104
  s_and_b32 s51, s48, 2047
  s_mul_i32 s51, s51, 1280
  s_add_u32 m0, s50, 8064
  s_add_u32 s48, s48, s49
  s_mov_b32 exec_hi, 0xff
  buffer_load_dwordx4 v17, s[20:23], s51 offen lds
  buffer_load_dwordx4 v17, s[20:23], s51 offen offset:640 lds
  s_mov_b32 exec_hi, -1
L_gi_104:
  s_waitcnt lgkmcnt(8)
  v_mfma_f32_32x32x16_bf16 v[180:195], v[240:243], v[32:35], v[180:195]
  ds_read_b64_tr_b16 v[236:237], v4 offset:43008
  ds_read_b64_tr_b16 v[238:239], v4 offset:48384
  s_waitcnt lgkmcnt(8)
  v_mfma_f32_32x32x16_bf16 v[180:195], v[244:247], v[36:39], v[180:195]
  ds_read_b64_tr_b16 v[240:241], v5 offset:0
  ds_read_b64_tr_b16 v[242:243], v5 offset:5376
  v_mul_f32 v164, v24, v215
  v_mul_f32 v165, v24, v214
  v_mul_f32 v166, v24, v213
  v_mul_f32 v167, v24, v212
  v_mul_f32 v168, v24, v219
  v_mul_f32 v169, v24, v218
  v_mul_f32 v170, v24, v217
  v_mul_f32 v171, v24, v216
  s_waitcnt lgkmcnt(8)
  v_mfma_f32_32x32x16_bf16 v[180:195], v[248:251], v[40:43], v[180:195]
  v_mul_f32 v172, v24, v223
  v_mul_f32 v173, v24, v222
  v_mul_f32 v174, v24, v221
  v_mul_f32 v175, v24, v220
  v_mul_f32 v176, v24, v227
  v_mul_f32 v177, v24, v226
  v_mul_f32 v178, v24, v225
  v_mul_f32 v179, v24, v224
  s_nop 0
  s_waitcnt lgkmcnt(6)
  v_mfma_f32_32x32x16_bf16 v[164:179], v[228:231], v[28:31], v[164:179]
  s_cmp_eq_u32 s53, 1
  s_cbranch_scc0 L_gi_105
  s_and_b32 s51, s48, 2047
  s_mul_i32 s51, s51, 1280
  s_add_u32 m0, s50, 9408
  s_add_u32 s48, s48, s49
  s_mov_b32 exec_hi, 0xff
  buffer_load_dwordx4 v17, s[20:23], s51 offen lds
  buffer_load_dwordx4 v17, s[20:23], s51 offen offset:640 lds
  s_mov_b32 exec_hi, -1
L_gi_105:
  s_waitcnt lgkmcnt(4)
  v_mfma_f32_32x32x16_bf16 v[164:179], v[232:235], v[32:35], v[164:179]
  s_cmp_eq_u32 s53, 1
  s_cbranch_scc0 L_gi_106
  s_mov_b32 m0, s52
  s_mov_b64 exec, 0xffff
  buffer_load_dword v23, s[20:23], 0 offen lds
  s_mov_b64 exec, -1
L_gi_106:
  s_waitcnt lgkmcnt(2)
  v_mfma_f32_32x32x16_bf16 v[164:179], v[236:239], v[36:39], v[164:179]
  s_waitcnt lgkmcnt(0)
  v_mfma_f32_32x32x16_bf16 v[164:179], v[240:243], v[40:43], v[164:179]
  s_cmp_eq_u32 s8, 1
  s_cbranch_scc1 L_j0_108
  v_add_u32 v4, 64, v4
  v_add_u32 v5, 64, v5
  v_subrev_u32 v6, 64, v6
  v_subrev_u32 v7, 64, v7
  ds_read_b64_tr_b16 v[228:229], v6 offset:0
  ds_read_b64_tr_b16 v[230:231], v6 offset:5376
  ds_read_b64_tr_b16 v[232:233], v6 offset:21504
  ds_read_b64_tr_b16 v[234:235], v6 offset:26880
  ds_read_b64_tr_b16 v[236:237], v6 offset:43008
  ds_read_b64_tr_b16 v[238:239], v6 offset:48384
  ds_read_b64_tr_b16 v[240:241], v7 offset:0
  ds_read_b64_tr_b16 v[242:243], v7 offset:5376
  ds_read_b64_tr_b16 v[244:245], v6 offset:640
  ds_read_b64_tr_b16 v[246:247], v6 offset:6016
L_j0_108:
  s_nop 9
  v_add_f32 v196, v164, v180
  v_sub_f32 v212, v164, v180
  v_add_f32 v197, v165, v181
  v_sub_f32 v213, v165, v181
  v_add_f32 v198, v166, v182
  v_sub_f32 v214, v166, v182
  v_add_f32 v199, v167, v183
  v_sub_f32 v215, v167, v183
  v_add_f32 v200, v168, v184
  v_sub_f32 v216, v168, v184
  v_add_f32 v201, v169, v185
  v_sub_f32 v217, v169, v185
  v_add_f32 v202, v170, v186
  v_sub_f32 v218, v170, v186
  v_add_f32 v203, v171, v187
  v_sub_f32 v219, v171, v187
  v_add_f32 v204, v172, v188
  v_sub_f32 v220, v172, v188
  v_add_f32 v205, v173, v189
  v_sub_f32 v221, v173, v189
  v_add_f32 v206, v174, v190
  v_sub_f32 v222, v174, v190
  v_add_f32 v207, v175, v191
  v_sub_f32 v223, v175, v191
  v_add_f32 v208, v176, v192
  v_sub_f32 v224, v176, v192
  v_add_f32 v209, v177, v193
  v_sub_f32 v225, v177, v193
  v_add_f32 v210, v178, v194
  v_sub_f32 v226, v178, v194
  v_add_f32 v211, v179, v195
  v_sub_f32 v227, v179, v195
  s_cmp_eq_u32 s8, 1
  s_cbranch_scc1 L_jd_107
  s_mov_b32 s8, 1
  s_mov_b32 s53, 0
  v_cvt_pk_bf16_f32 v144, v196, v197
  v_cvt_pk_bf16_f32 v145, v198, v199
  v_cvt_pk_bf16_f32 v146, v200, v201
  v_cvt_pk_bf16_f32 v147, v202, v203
  v_cvt_pk_bf16_f32 v148, v204, v205
  v_cvt_pk_bf16_f32 v149, v206, v207
  v_cvt_pk_bf16_f32 v150, v208, v209
  v_cvt_pk_bf16_f32 v151, v210, v211
  v_cvt_pk_bf16_f32 v152, v212, v213
  v_cvt_pk_bf16_f32 v153, v214, v215
  v_cvt_pk_bf16_f32 v154, v216, v217
  v_cvt_pk_bf16_f32 v155, v218, v219
  v_cvt_pk_bf16_f32 v156, v220, v221
  v_cvt_pk_bf16_f32 v157, v222, v223
  v_cvt_pk_bf16_f32 v158, v224, v225
  v_cvt_pk_bf16_f32 v159, v226, v227
  s_branch L_chunk_99
L_jd_107:
  v_cvt_pk_bf16_f32 v196, v196, v197
  v_cvt_pk_bf16_f32 v197, v198, v199
  v_cvt_pk_bf16_f32 v198, v200, v201
  v_cvt_pk_bf16_f32 v199, v202, v203
  v_cvt_pk_bf16_f32 v200, v204, v205
  v_cvt_pk_bf16_f32 v201, v206, v207
  v_cvt_pk_bf16_f32 v202, v208, v209
  v_cvt_pk_bf16_f32 v203, v210, v211
  v_cvt_pk_bf16_f32 v204, v212, v213
  v_cvt_pk_bf16_f32 v205, v214, v215
  v_cvt_pk_bf16_f32 v206, v216, v217
  v_cvt_pk_bf16_f32 v207, v218, v219
  v_cvt_pk_bf16_f32 v208, v220, v221
  v_cvt_pk_bf16_f32 v209, v222, v223
  v_cvt_pk_bf16_f32 v210, v224, v225
  v_cvt_pk_bf16_f32 v211, v226, v227
  s_barrier
  s_cmp_eq_u32 s19, 2
  s_cbranch_scc0 L_gi_111
  s_and_b32 s51, s48, 2047
  s_mul_i32 s51, s51, 1280
  s_add_u32 m0, s50, 0
  s_add_u32 s48, s48, s49
  s_mov_b32 exec_hi, 0xff
  buffer_load_dwordx4 v17, s[20:23], s51 offen lds
  buffer_load_dwordx4 v17, s[20:23], s51 offen offset:640 lds
  s_mov_b32 exec_hi, -1
  s_and_b32 s51, s48, 2047
  s_mul_i32 s51, s51, 1280
  s_add_u32 m0, s50, 1344
  s_add_u32 s48, s48, s49
  s_mov_b32 exec_hi, 0xff
  buffer_load_dwordx4 v17, s[20:23], s51 offen lds
  buffer_load_dwordx4 v17, s[20:23], s51 offen offset:640 lds
  s_mov_b32 exec_hi, -1
  s_and_b32 s51, s48, 2047
  s_mul_i32 s51, s51, 1280
  s_add_u32 m0, s50, 2688
  s_add_u32 s48, s48, s49
  s_mov_b32 exec_hi, 0xff
  buffer_load_dwordx4 v17, s[20:23], s51 offen lds
  buffer_load_dwordx4 v17, s[20:23], s51 offen offset:640 lds
  s_mov_b32 exec_hi, -1
  s_and_b32 s51, s48, 2047
  s_mul_i32 s51, s51, 1280
  s_add_u32 m0, s50, 4032
  s_add_u32 s48, s48, s49
  s_mov_b32 exec_hi, 0xff
  buffer_load_dwordx4 v17, s[20:23], s51 offen lds
  buffer_load_dwordx4 v17, s[20:23], s51 offen offset:640 lds
  s_mov_b32 exec_hi, -1
  s_and_b32 s51, s48, 2047
  s_mul_i32 s51, s51, 1280
  s_add_u32 m0, s50, 5376
  s_add_u32 s48, s48, s49
  s_mov_b32 exec_hi, 0xff
  buffer_load_dwordx4 v17, s[20:23], s51 offen lds
  buffer_load_dwordx4 v17, s[20:23], s51 offen offset:640 lds
  s_mov_b32 exec_hi, -1
  s_and_b32 s51, s48, 2047
  s_mul_i32 s51, s51, 1280
  s_add_u32 m0, s50, 6720
  s_add_u32 s48, s48, s49
  s_mov_b32 exec_hi, 0xff
  buffer_load_dwordx4 v17, s[20:23], s51 offen lds
  buffer_load_dwordx4 v17, s[20:23], s51 offen offset:640 lds
  s_mov_b32 exec_hi, -1
  s_and_b32 s51, s48, 2047
  s_mul_i32 s51, s51, 1280
  s_add_u32 m0, s50, 8064
  s_add_u32 s48, s48, s49
  s_mov_b32 exec_hi, 0xff
  buffer_load_dwordx4 v17, s[20:23], s51 offen lds
  buffer_load_dwordx4 v17, s[20:23], s51 offen offset:640 lds
  s_mov_b32 exec_hi, -1
  s_and_b32 s51, s48, 2047
  s_mul_i32 s51, s51, 1280
  s_add_u32 m0, s50, 9408
  s_add_u32 s48, s48, s49
  s_mov_b32 exec_hi, 0xff
  buffer_load_dwordx4 v17, s[20:23], s51 offen lds
  buffer_load_dwordx4 v17, s[20:23], s51 offen offset:640 lds
  s_mov_b32 exec_hi, -1
  s_mov_b32 m0, s52
  s_mov_b64 exec, 0xffff
  buffer_load_dword v23, s[20:23], 0 offen lds
  s_mov_b64 exec, -1
L_gi_111:
  s_cmp_eq_u32 s70, 3
  s_cbranch_scc1 L_j1_112
  ds_write_b128 v10, v[196:199] offset:0
  ds_write_b128 v10, v[200:203] offset:1024
  ds_write_b128 v10, v[204:207] offset:10240
  ds_write_b128 v10, v[208:211] offset:11264
  s_branch L_j2_113
L_j1_112:
  ds_write_b128 v10, v[144:147] offset:0
  ds_write_b128 v10, v[196:199] offset:2048
  ds_write_b128 v10, v[148:151] offset:1024
  ds_write_b128 v10, v[200:203] offset:3072
  ds_write_b128 v10, v[152:155] offset:10240
  ds_write_b128 v10, v[204:207] offset:12288
  ds_write_b128 v10, v[156:159] offset:11264
  ds_write_b128 v10, v[208:211] offset:13312
L_j2_113:
  s_setprio 0
  s_cmp_eq_u32 s3, 2
  s_cbranch_scc0 L_pr_114
  s_setprio 1
L_pr_114:
  s_waitcnt lgkmcnt(0)
  s_barrier
  s_lshl_b32 s9, s14, 7
  s_add_u32 s9, s9, 162304
  v_lshl_add_u32 v9, v2, 2, s9
  ds_read_b32 v9, v9
  ds_read_b128 v[164:167], v11 offset:0
  ds_read_b128 v[168:171], v11 offset:1024
  ds_read_b128 v[172:175], v11 offset:2048
  ds_read_b128 v[176:179], v11 offset:3072
  ds_read_b128 v[180:183], v11 offset:4096
  ds_read_b128 v[184:187], v11 offset:5120
  ds_read_b128 v[188:191], v11 offset:6144
  ds_read_b128 v[192:195], v11 offset:7168
  ds_read_b128 v[196:199], v11 offset:8192
  ds_read_b128 v[200:203], v11 offset:9216
  s_cmp_eq_u32 s15, 0
  s_cselect_b32 s16, -1, 0
  s_waitcnt lgkmcnt(10)
  v_and_b32 v9, s16, v9
  v_mov_b32 v204, v9
  v_mov_b32 v205, v9
  v_mov_b32 v206, v9
  v_mov_b32 v207, v9
  v_mov_b32 v208, v9
  v_mov_b32 v209, v9
  v_mov_b32 v210, v9
  v_mov_b32 v211, v9
  v_mov_b32 v212, v9
  v_mov_b32 v213, v9
  v_mov_b32 v214, v9
  v_mov_b32 v215, v9
  v_mov_b32 v216, v9
  v_mov_b32 v217, v9
  v_mov_b32 v218, v9
  v_mov_b32 v219, v9
  s_nop 0
  s_waitcnt lgkmcnt(9)
  v_mfma_f32_32x32x16_bf16 v[204:219], v[44:47], v[164:167], v[204:219]
  v_mov_b32 v220, v9
  v_mov_b32 v221, v9
  v_mov_b32 v222, v9
  v_mov_b32 v223, v9
  v_mov_b32 v224, v9
  v_mov_b32 v225, v9
  v_mov_b32 v226, v9
  v_mov_b32 v227, v9
  s_waitcnt lgkmcnt(8)
  v_mfma_f32_32x32x16_bf16 v[204:219], v[48:51], v[168:171], v[204:219]
  v_mov_b32 v228, v9
  v_mov_b32 v229, v9
  v_mov_b32 v230, v9
  v_mov_b32 v231, v9
  v_mov_b32 v232, v9
  v_mov_b32 v233, v9
  v_mov_b32 v234, v9
  v_mov_b32 v235, v9
  s_waitcnt lgkmcnt(7)
  v_mfma_f32_32x32x16_bf16 v[204:219], v[52:55], v[172:175], v[204:219]
  v_mov_b32 v236, v9
  v_mov_b32 v237, v9
  v_mov_b32 v238, v9
  v_mov_b32 v239, v9
  v_mov_b32 v240, v9
  v_mov_b32 v241, v9
  v_mov_b32 v242, v9
  v_mov_b32 v243, v9
  s_waitcnt lgkmcnt(6)
  v_mfma_f32_32x32x16_bf16 v[204:219], v[56:59], v[176:179], v[204:219]
  v_mov_b32 v244, v9
  v_mov_b32 v245, v9
  v_mov_b32 v246, v9
  v_mov_b32 v247, v9
  v_mov_b32 v248, v9
  v_mov_b32 v249, v9
  v_mov_b32 v250, v9
  v_mov_b32 v251, v9
  s_waitcnt lgkmcnt(5)
  v_mfma_f32_32x32x16_bf16 v[204:219], v[60:63], v[180:183], v[204:219]
  s_or_b32 s4, s63, s69
  s_sub_u32 s4, 17, s4
  s_and_b32 s5, s63, s69
  s_sub_u32 s6, s5, 16
  v_cmp_gt_u32 s[66:67], s4, v2
  s_cmp_eq_u32 s69, 1
  s_cselect_b32 s10, 0x3e800000, 0
  s_cselect_b32 s11, 0x3f000000, 0x3e800000
  s_waitcnt lgkmcnt(4)
  v_mfma_f32_32x32x16_bf16 v[204:219], v[64:67], v[184:187], v[204:219]
  s_cselect_b32 s12, 0xbf800000, 0x3f800000
  s_cselect_b32 s68, 0x80008000, 0
  s_cmp_eq_u32 s63, 1
  s_cselect_b32 s11, s10, s11
  s_cselect_b32 s68, 0, s68
  s_cselect_b32 s7, 32, s62
  v_add_u32 v4, s69, v2
  v_add_u32 v5, s6, v2
  s_waitcnt lgkmcnt(3)
  v_mfma_f32_32x32x16_bf16 v[204:219], v[68:71], v[188:191], v[204:219]
  v_cndmask_b32 v4, v5, v4, s[66:67]
  v_mov_b32 v5, s11
  v_mov_b32 v6, s10
  v_cndmask_b32 v5, v5, v6, s[66:67]
  v_mov_b32 v6, s7
  v_mov_b32 v7, s62
  v_cmp_eq_u32 vcc, 16, v4
  v_cndmask_b32 v6, v6, v7, s[66:67]
  s_waitcnt lgkmcnt(2)
  v_mfma_f32_32x32x16_bf16 v[204:219], v[72:75], v[192:195], v[204:219]
  v_cvt_f32_u32 v4, v4
  v_cndmask_b32 v5, v5, 0, vcc
  v_cndmask_b32 v6, v6, 0, vcc
  v_lshl_add_u32 v6, v3, 9, v6
  v_cvt_f32_u32 v6, v6
  v_mul_f32 v7, 0x3a000000, v4
  v_mul_f32 v4, 0x3d000000, v4
  v_fma_f32 v7, v7, v6, -v5
  s_waitcnt lgkmcnt(1)
  v_mfma_f32_32x32x16_bf16 v[204:219], v[76:79], v[196:199], v[204:219]
  s_cmp_eq_u32 s63, 1
  s_cselect_b64 s[10:11], s[66:67], -1
  s_cselect_b64 s[66:67], s[66:67], 0
  v_cndmask_b32 v254, 0, -1, s[10:11]
  v_cndmask_b32 v255, -1, 0, s[66:67]
  s_mul_i32 s5, s5, 15
  s_cmp_eq_u32 s5, 0
  s_cselect_b32 s5, 99, s5
  s_waitcnt lgkmcnt(0)
  v_mfma_f32_32x32x16_bf16 v[204:219], v[80:83], v[200:203], v[204:219]
  v_cmp_eq_u32 vcc, s5, v2
  v_mov_b32 v24, s12
  v_fmamk_f32 v28, v4, 0x0, v7
  v_fmamk_f32 v29, v4, 0x3f800000, v7
  v_fmamk_f32 v30, v4, 0x40000000, v7
  v_fmamk_f32 v31, v4, 0x40400000, v7
  v_fmamk_f32 v32, v4, 0x40800000, v7
  v_fmamk_f32 v33, v4, 0x40a00000, v7
  v_mfma_f32_32x32x16_bf16 v[220:235], v[84:87], v[164:167], v[220:235]
  v_fmamk_f32 v34, v4, 0x40c00000, v7
  v_fmamk_f32 v35, v4, 0x40e00000, v7
  v_fmamk_f32 v36, v4, 0x41800000, v7
  v_fmamk_f32 v37, v4, 0x41880000, v7
  v_fmamk_f32 v38, v4, 0x41900000, v7
  v_fmamk_f32 v39, v4, 0x41980000, v7
  v_fmamk_f32 v40, v4, 0x41a00000, v7
  v_fmamk_f32 v41, v4, 0x41a80000, v7
  v_mfma_f32_32x32x16_bf16 v[220:235], v[88:91], v[168:171], v[220:235]
  v_fmamk_f32 v42, v4, 0x41b00000, v7
  v_fmamk_f32 v43, v4, 0x41b80000, v7
  v_cndmask_b32 v24, v24, 1.0, vcc
  v_cos_f32 v28, v28
  v_cos_f32 v29, v29
  v_cos_f32 v30, v30
  v_cos_f32 v31, v31
  v_cos_f32 v32, v32
  v_mfma_f32_32x32x16_bf16 v[220:235], v[92:95], v[172:175], v[220:235]
  v_cos_f32 v33, v33
  v_cos_f32 v34, v34
  v_cos_f32 v35, v35
  v_cos_f32 v36, v36
  v_cos_f32 v37, v37
  v_cos_f32 v38, v38
  v_cos_f32 v39, v39
  v_cos_f32 v40, v40
  v_mfma_f32_32x32x16_bf16 v[220:235], v[96:99], v[176:179], v[220:235]
  v_cos_f32 v41, v41
  v_cos_f32 v42, v42
  v_cos_f32 v43, v43
  s_nop 0
  v_cvt_pk_bf16_f32 v28, v28, v29
  v_cvt_pk_bf16_f32 v29, v30, v31
  v_cvt_pk_bf16_f32 v30, v32, v33
  v_cvt_pk_bf16_f32 v31, v34, v35
  v_mfma_f32_32x32x16_bf16 v[220:235], v[100:103], v[180:183], v[220:235]
  v_cvt_pk_bf16_f32 v32, v36, v37
  v_cvt_pk_bf16_f32 v33, v38, v39
  v_cvt_pk_bf16_f32 v34, v40, v41
  v_cvt_pk_bf16_f32 v35, v42, v43
  v_xor_b32 v36, s68, v28
  v_and_b32 v36, v255, v36
  v_and_b32 v28, v254, v28
  v_xor_b32 v37, s68, v29
  v_mfma_f32_32x32x16_bf16 v[220:235], v[104:107], v[184:187], v[220:235]
  v_and_b32 v37, v255, v37
  v_and_b32 v29, v254, v29
  v_xor_b32 v38, s68, v30
  v_and_b32 v38, v255, v38
  v_and_b32 v30, v254, v30
  v_xor_b32 v39, s68, v31
  v_and_b32 v39, v255, v39
  v_and_b32 v31, v254, v31
  v_mfma_f32_32x32x16_bf16 v[220:235], v[108:111], v[188:191], v[220:235]
  v_xor_b32 v40, s68, v32
  v_and_b32 v40, v255, v40
  v_and_b32 v32, v254, v32
  v_xor_b32 v41, s68, v33
  v_and_b32 v41, v255, v41
  v_and_b32 v33, v254, v33
  v_xor_b32 v42, s68, v34
  v_and_b32 v42, v255, v42
  v_mfma_f32_32x32x16_bf16 v[220:235], v[112:115], v[192:195], v[220:235]
  v_and_b32 v34, v254, v34
  v_xor_b32 v43, s68, v35
  v_and_b32 v43, v255, v43
  v_and_b32 v35, v254, v35
  v_mfma_f32_32x32x16_bf16 v[220:235], v[116:119], v[196:199], v[220:235]
  v_mfma_f32_32x32x16_bf16 v[220:235], v[120:123], v[200:203], v[220:235]
  s_cmp_eq_u32 s19, 1
  s_cselect_b32 s4, 86016, 0
  v_add_u32 v18, s4, v18
  v_add_u32 v19, s4, v19
  v_add_u32 v20, s4, v20
  v_add_u32 v21, s4, v21
  v_add_u32 v22, s4, v22
  s_cmp_eq_u32 s17, 0
  s_cbranch_scc1 L_t1_117
  s_waitcnt vmcnt(0)
  ds_read_b128 v[132:135], v18
  ds_read_b32 v136, v18 offset:16
  ds_read_b128 v[138:141], v19
  ds_read_b32 v142, v19 offset:16
  ds_read_b128 v[144:147], v20
  ds_read_b32 v148, v20 offset:16
  ds_read_b128 v[150:153], v21
  ds_read_b32 v154, v21 offset:16
  ds_read_b128 v[156:159], v22
  ds_read_b32 v160, v22 offset:16
  s_cmp_eq_u32 s17, 1
  s_cbranch_scc1 L_t2_118
  v_cvt_pk_bf16_f32 v204, v204, v205
  v_cvt_pk_bf16_f32 v205, v206, v207
  v_cvt_pk_bf16_f32 v206, v208, v209
  v_cvt_pk_bf16_f32 v207, v210, v211
  v_cvt_pk_bf16_f32 v208, v212, v213
  v_cvt_pk_bf16_f32 v209, v214, v215
  v_cvt_pk_bf16_f32 v210, v216, v217
  v_cvt_pk_bf16_f32 v211, v218, v219
  v_cvt_pk_bf16_f32 v220, v220, v221
  v_cvt_pk_bf16_f32 v221, v222, v223
  v_cvt_pk_bf16_f32 v222, v224, v225
  v_cvt_pk_bf16_f32 v223, v226, v227
  v_cvt_pk_bf16_f32 v224, v228, v229
  v_cvt_pk_bf16_f32 v225, v230, v231
  v_cvt_pk_bf16_f32 v226, v232, v233
  v_cvt_pk_bf16_f32 v227, v234, v235
  v_xor_b32 v4, 16, v12
  v_xor_b32 v5, 64, v12
  v_xor_b32 v6, 80, v12
  ds_write_b128 v12, v[204:207]
  ds_write_b128 v4, v[208:211]
  ds_write_b128 v5, v[220:223]
  ds_write_b128 v6, v[224:227]
  ds_read_b128 v[212:215], v13 offset:0
  ds_read_b128 v[216:219], v13 offset:1024
  ds_read_b128 v[228:231], v13 offset:2048
  ds_read_b128 v[232:235], v13 offset:3072
  s_waitcnt lgkmcnt(8)
  v_alignbit_b32 v132, v133, v132, 16
  v_alignbit_b32 v133, v134, v133, 16
  v_alignbit_b32 v134, v135, v134, 16
  v_alignbit_b32 v135, v136, v135, 16
  ds_write_b128 v18, v[132:135]
  v_alignbit_b32 v138, v139, v138, 16
  v_alignbit_b32 v139, v140, v139, 16
  v_alignbit_b32 v140, v141, v140, 16
  v_alignbit_b32 v141, v142, v141, 16
  ds_write_b128 v19, v[138:141]
  v_alignbit_b32 v144, v145, v144, 16
  v_alignbit_b32 v145, v146, v145, 16
  v_alignbit_b32 v146, v147, v146, 16
  v_alignbit_b32 v147, v148, v147, 16
  ds_write_b128 v20, v[144:147]
  v_alignbit_b32 v150, v151, v150, 16
  v_alignbit_b32 v151, v152, v151, 16
  v_alignbit_b32 v152, v153, v152, 16
  v_alignbit_b32 v153, v154, v153, 16
  ds_write_b128 v21, v[150:153]
  v_alignbit_b32 v156, v157, v156, 16
  v_alignbit_b32 v157, v158, v157, 16
  v_alignbit_b32 v158, v159, v158, 16
  v_alignbit_b32 v159, v160, v159, 16
  ds_write_b128 v22, v[156:159]
  s_branch L_t3_119
L_t1_117:
  v_mfma_f32_32x32x16_bf16 v[236:251], v[124:127], v[164:167], v[236:251]
  v_mfma_f32_32x32x16_bf16 v[236:251], v[128:131], v[168:171], v[236:251]
  v_cvt_pk_bf16_f32 v204, v204, v205
  v_cvt_pk_bf16_f32 v205, v206, v207
  v_cvt_pk_bf16_f32 v206, v208, v209
  v_cvt_pk_bf16_f32 v207, v210, v211
  v_mfma_f32_32x32x16_bf16 v[236:251], v[132:135], v[172:175], v[236:251]
  v_cvt_pk_bf16_f32 v208, v212, v213
  v_cvt_pk_bf16_f32 v209, v214, v215
  v_cvt_pk_bf16_f32 v210, v216, v217
  v_cvt_pk_bf16_f32 v211, v218, v219
  v_mfma_f32_32x32x16_bf16 v[236:251], v[136:139], v[176:179], v[236:251]
  v_cvt_pk_bf16_f32 v220, v220, v221
  v_cvt_pk_bf16_f32 v221, v222, v223
  v_cvt_pk_bf16_f32 v222, v224, v225
  v_cvt_pk_bf16_f32 v223, v226, v227
  v_mfma_f32_32x32x16_bf16 v[236:251], v[140:143], v[180:183], v[236:251]
  v_cvt_pk_bf16_f32 v224, v228, v229
  v_cvt_pk_bf16_f32 v225, v230, v231
  v_cvt_pk_bf16_f32 v226, v232, v233
  v_cvt_pk_bf16_f32 v227, v234, v235
  v_mfma_f32_32x32x16_bf16 v[236:251], v[144:147], v[184:187], v[236:251]
  v_xor_b32 v4, 16, v12
  v_xor_b32 v5, 64, v12
  v_xor_b32 v6, 80, v12
  ds_write_b128 v12, v[204:207]
  v_mfma_f32_32x32x16_bf16 v[236:251], v[148:151], v[188:191], v[236:251]
  ds_write_b128 v4, v[208:211]
  ds_write_b128 v5, v[220:223]
  ds_write_b128 v6, v[224:227]
  ds_read_b128 v[212:215], v13 offset:0
  v_mfma_f32_32x32x16_bf16 v[236:251], v[152:155], v[192:195], v[236:251]
  ds_read_b128 v[216:219], v13 offset:1024
  ds_read_b128 v[228:231], v13 offset:2048
  ds_read_b128 v[232:235], v13 offset:3072
  v_mfma_f32_32x32x16_bf16 v[236:251], v[156:159], v[196:199], v[236:251]
  v_mfma_f32_32x32x16_bf16 v[236:251], v[160:163], v[200:203], v[236:251]
  s_branch L_t3_119
L_t2_118:
  v_mfma_f32_32x32x16_bf16 v[236:251], v[124:127], v[164:167], v[236:251]
  v_mfma_f32_32x32x16_bf16 v[236:251], v[124:127], v[168:171], v[236:251]
  v_cvt_pk_bf16_f32 v204, v204, v205
  v_cvt_pk_bf16_f32 v205, v206, v207
  v_cvt_pk_bf16_f32 v206, v208, v209
  v_cvt_pk_bf16_f32 v207, v210, v211
  v_mfma_f32_32x32x16_bf16 v[236:251], v[124:127], v[172:175], v[236:251]
  v_cvt_pk_bf16_f32 v208, v212, v213
  v_cvt_pk_bf16_f32 v209, v214, v215
  v_cvt_pk_bf16_f32 v210, v216, v217
  v_cvt_pk_bf16_f32 v211, v218, v219
  v_mfma_f32_32x32x16_bf16 v[236:251], v[124:127], v[176:179], v[236:251]
  v_cvt_pk_bf16_f32 v220, v220, v221
  v_cvt_pk_bf16_f32 v221, v222, v223
  v_cvt_pk_bf16_f32 v222, v224, v225
  v_cvt_pk_bf16_f32 v223, v226, v227
  v_mfma_f32_32x32x16_bf16 v[236:251], v[124:127], v[180:183], v[236:251]
  v_cvt_pk_bf16_f32 v224, v228, v229
  v_cvt_pk_bf16_f32 v225, v230, v231
  v_cvt_pk_bf16_f32 v226, v232, v233
  v_cvt_pk_bf16_f32 v227, v234, v235
  v_xor_b32 v4, 16, v12
  v_xor_b32 v5, 64, v12
  v_xor_b32 v6, 80, v12
  v_mfma_f32_32x32x16_bf16 v[236:251], v[124:127], v[184:187], v[236:251]
  ds_write_b128 v12, v[204:207]
  ds_write_b128 v4, v[208:211]
  ds_write_b128 v5, v[220:223]
  ds_write_b128 v6, v[224:227]
  ds_read_b128 v[212:215], v13 offset:0
  ds_read_b128 v[216:219], v13 offset:1024
  ds_read_b128 v[228:231], v13 offset:2048
  v_mfma_f32_32x32x16_bf16 v[236:251], v[124:127], v[188:191], v[236:251]
  ds_read_b128 v[232:235], v13 offset:3072
  s_waitcnt lgkmcnt(8)
  v_alignbit_b32 v132, v133, v132, 16
  v_alignbit_b32 v133, v134, v133, 16
  v_alignbit_b32 v134, v135, v134, 16
  v_alignbit_b32 v135, v136, v135, 16
  ds_write_b128 v18, v[132:135]
  v_mfma_f32_32x32x16_bf16 v[236:251], v[124:127], v[192:195], v[236:251]
  v_alignbit_b32 v138, v139, v138, 16
  v_alignbit_b32 v139, v140, v139, 16
  v_alignbit_b32 v140, v141, v140, 16
  v_alignbit_b32 v141, v142, v141, 16
  ds_write_b128 v19, v[138:141]
  v_alignbit_b32 v144, v145, v144, 16
  v_alignbit_b32 v145, v146, v145, 16
  v_mfma_f32_32x32x16_bf16 v[236:251], v[124:127], v[196:199], v[236:251]
  v_alignbit_b32 v146, v147, v146, 16
  v_alignbit_b32 v147, v148, v147, 16
  ds_write_b128 v20, v[144:147]
  v_alignbit_b32 v150, v151, v150, 16
  v_alignbit_b32 v151, v152, v151, 16
  v_alignbit_b32 v152, v153, v152, 16
  v_alignbit_b32 v153, v154, v153, 16
  v_mfma_f32_32x32x16_bf16 v[236:251], v[128:131], v[200:203], v[236:251]
  ds_write_b128 v21, v[150:153]
  v_alignbit_b32 v156, v157, v156, 16
  v_alignbit_b32 v157, v158, v157, 16
  v_alignbit_b32 v158, v159, v158, 16
  v_alignbit_b32 v159, v160, v159, 16
  ds_write_b128 v22, v[156:159]
L_t3_119:
  s_cmp_eq_u32 s17, 3
  s_cbranch_scc1 L_s2e_116
  s_nop 9
  v_cvt_pk_bf16_f32 v236, v236, v237
  v_cvt_pk_bf16_f32 v237, v238, v239
  v_cvt_pk_bf16_f32 v238, v240, v241
  v_cvt_pk_bf16_f32 v239, v242, v243
  v_cvt_pk_bf16_f32 v240, v244, v245
  v_cvt_pk_bf16_f32 v241, v246, v247
  v_cvt_pk_bf16_f32 v242, v248, v249
  v_cvt_pk_bf16_f32 v243, v250, v251
  ds_write_b128 v12, v[236:239]
  ds_write_b128 v4, v[240:243]
  ds_read_b128 v[236:239], v13 offset:0
  ds_read_b128 v[240:243], v13 offset:1024
  ds_read_b128 v[244:247], v13 offset:2048
  ds_read_b128 v[248:251], v13 offset:3072
L_s2e_116:
  s_waitcnt vmcnt(0) lgkmcnt(0)
  s_cmp_eq_u32 s3, 1
  s_cbranch_scc1 L_sh_120
  ds_read_b128 v[164:167], v18
  ds_read_b32 v168, v18 offset:16
  ds_read_b128 v[172:175], v19
  ds_read_b32 v176, v19 offset:16
  ds_read_b128 v[180:183], v20
  ds_read_b32 v184, v20 offset:16
  ds_read_b128 v[188:191], v21
  ds_read_b32 v192, v21 offset:16
  ds_read_b128 v[196:199], v22
  ds_read_b32 v200, v22 offset:16
  s_waitcnt lgkmcnt(8)
  v_alignbit_b32 v164, v165, v164, 16
  v_alignbit_b32 v165, v166, v165, 16
  v_alignbit_b32 v166, v167, v166, 16
  v_alignbit_b32 v167, v168, v167, 16
  ds_write_b128 v18, v[164:167]
  s_waitcnt lgkmcnt(7)
  v_alignbit_b32 v172, v173, v172, 16
  v_alignbit_b32 v173, v174, v173, 16
  v_alignbit_b32 v174, v175, v174, 16
  v_alignbit_b32 v175, v176, v175, 16
  ds_write_b128 v19, v[172:175]
  s_waitcnt lgkmcnt(6)
  v_alignbit_b32 v180, v181, v180, 16
  v_alignbit_b32 v181, v182, v181, 16
  v_alignbit_b32 v182, v183, v182, 16
  v_alignbit_b32 v183, v184, v183, 16
  ds_write_b128 v20, v[180:183]
  s_waitcnt lgkmcnt(5)
  v_alignbit_b32 v188, v189, v188, 16
  v_alignbit_b32 v189, v190, v189, 16
  v_alignbit_b32 v190, v191, v190, 16
  v_alignbit_b32 v191, v192, v191, 16
  ds_write_b128 v21, v[188:191]
  s_waitcnt lgkmcnt(4)
  v_alignbit_b32 v196, v197, v196, 16
  v_alignbit_b32 v197, v198, v197, 16
  v_alignbit_b32 v198, v199, v198, 16
  v_alignbit_b32 v199, v200, v199, 16
  ds_write_b128 v22, v[196:199]
L_sh_120:
  s_add_u32 s16, s18, 0
  buffer_store_dwordx4 v[212:215], v14, s[36:39], s16 offen sc1
  buffer_store_dwordx4 v[216:219], v15, s[36:39], s16 offen sc1
  buffer_store_dwordx4 v[228:231], v16, s[36:39], s16 offen sc1
  buffer_store_dwordx4 v[232:235], v8, s[36:39], s16 offen sc1
  s_cmp_eq_u32 s17, 3
  s_cbranch_scc1 L_n3_121
  s_sub_u32 s18, s18, s64
  s_add_u32 s16, s18, 0
  s_mov_b32 exec_lo, 0x0f0f0f0f
  s_mov_b32 exec_hi, 0x0f0f0f0f
  buffer_store_dwordx4 v[236:239], v14, s[36:39], s16 offen sc1
  buffer_store_dwordx4 v[240:243], v15, s[36:39], s16 offen sc1
  buffer_store_dwordx4 v[244:247], v16, s[36:39], s16 offen sc1
  buffer_store_dwordx4 v[248:251], v8, s[36:39], s16 offen sc1
  s_mov_b64 exec, -1
  s_add_u32 s18, s18, s64
L_n3_121:
  v_add_u32 v14, 768, v14
  v_add_u32 v15, 768, v15
  v_add_u32 v16, 768, v16
  v_add_u32 v8, 768, v8
  s_cmp_eq_u32 s46, 7
  s_cselect_b32 s4, 82688, 0
  v_add_u32 v12, s4, v12
  v_add_u32 v13, s4, v13
  s_cmp_eq_u32 s63, 0
  s_cbranch_scc1 L_n4_122
  s_or_b32 s4, s63, s15
  s_sub_u32 s4, 17, s4
  s_lshl_b32 s5, s15, 6
  s_add_u32 s5, s5, s62
  s_and_b32 s6, s63, s15
  s_sub_u32 s7, s6, 16
  s_mul_i32 s6, s6, 15
  s_cmp_eq_u32 s6, 0
  s_cselect_b32 s6, 99, s6
  v_and_b32 v254, 7, v1
  v_lshlrev_b32 v254, 4, v254
  v_mov_b32 v255, 2147483632
  v_lshrrev_b32 v4, 3, v1
  v_add_u32 v4, 0, v4
  v_cmp_gt_u32 vcc, s4, v4
  v_add_u32 v5, s15, v4
  v_add_u32 v6, s7, v4
  v_cndmask_b32 v5, v6, v5, vcc
  v_cndmask_b32 v6, 32, 0, vcc
  v_cmp_eq_u32 vcc, s6, v4
  v_lshl_add_u32 v5, v5, 7, v6
  v_add_u32 v5, s5, v5
  v_mul_u32_u24 v5, 768, v5
  v_add_u32 v5, v5, v254
  v_cndmask_b32 v14, v5, v255, vcc
  v_lshrrev_b32 v4, 3, v1
  v_add_u32 v4, 8, v4
  v_cmp_gt_u32 vcc, s4, v4
  v_add_u32 v5, s15, v4
  v_add_u32 v6, s7, v4
  v_cndmask_b32 v5, v6, v5, vcc
  v_cndmask_b32 v6, 32, 0, vcc
  v_cmp_eq_u32 vcc, s6, v4
  v_lshl_add_u32 v5, v5, 7, v6
  v_add_u32 v5, s5, v5
  v_mul_u32_u24 v5, 768, v5
  v_add_u32 v5, v5, v254
  v_cndmask_b32 v15, v5, v255, vcc
  v_lshrrev_b32 v4, 3, v1
  v_add_u32 v4, 16, v4
  v_cmp_gt_u32 vcc, s4, v4
  v_add_u32 v5, s15, v4
  v_add_u32 v6, s7, v4
  v_cndmask_b32 v5, v6, v5, vcc
  v_cndmask_b32 v6, 32, 0, vcc
  v_cmp_eq_u32 vcc, s6, v4
  v_lshl_add_u32 v5, v5, 7, v6
  v_add_u32 v5, s5, v5
  v_mul_u32_u24 v5, 768, v5
  v_add_u32 v5, v5, v254
  v_cndmask_b32 v16, v5, v255, vcc
  v_lshrrev_b32 v4, 3, v1
  v_add_u32 v4, 24, v4
  v_cmp_gt_u32 vcc, s4, v4
  v_add_u32 v5, s15, v4
  v_add_u32 v6, s7, v4
  v_cndmask_b32 v5, v6, v5, vcc
  v_cndmask_b32 v6, 32, 0, vcc
  v_cmp_eq_u32 vcc, s6, v4
  v_lshl_add_u32 v5, v5, 7, v6
  v_add_u32 v5, s5, v5
  v_mul_u32_u24 v5, 768, v5
  v_add_u32 v5, v5, v254
  v_cndmask_b32 v8, v5, v255, vcc
L_n4_122:
  s_mov_b64 exec, 1
  v_mov_b32 v4, 0
  buffer_load_dwordx2 v[254:255], v4, s[40:43], 0 offen sc1
  s_mov_b64 exec, -1
  s_setprio 0
  s_cmp_eq_u32 s70, 3
  s_cbranch_scc0 L_pr_123
  s_setprio 1
L_pr_123:
  s_waitcnt lgkmcnt(0)
  s_barrier
  s_cmp_lt_u32 s46, 2
  s_cbranch_scc0 L_nx_124
  ds_read_b64_tr_b16 v[180:181], v252 offset:512
  ds_read_b64_tr_b16 v[182:183], v252 offset:544
  ds_read_b64_tr_b16 v[184:185], v252 offset:640
  ds_read_b64_tr_b16 v[186:187], v252 offset:672
  ds_read_b64_tr_b16 v[188:189], v252 offset:768
  ds_read_b64_tr_b16 v[190:191], v252 offset:800
  ds_read_b64_tr_b16 v[192:193], v252 offset:896
  ds_read_b64_tr_b16 v[194:195], v252 offset:928
  s_waitcnt lgkmcnt(0)
  v_mfma_f32_32x32x16_bf16 v[164:179], v[180:183], v[28:31], 0
  v_mfma_f32_32x32x16_bf16 v[164:179], v[184:187], v[32:35], v[164:179]
  v_mfma_f32_32x32x16_bf16 v[164:179], v[188:191], v[36:39], v[164:179]
  v_mfma_f32_32x32x16_bf16 v[164:179], v[192:195], v[40:43], v[164:179]
  s_lshl_b32 s4, s46, 8
  s_add_u32 s4, s4, 162304
  v_lshl_add_u32 v4, v2, 2, s4
  s_nop 9
  v_add_f32 v5, v164, v166
  v_sub_f32 v6, v164, v166
  s_mov_b32 exec_hi, 0
  ds_write_b32 v4, v5
  ds_write_b32 v4, v6 offset:128
  s_mov_b32 exec_hi, -1
L_nx_124:
  v_add_u32 v4, 86016, v26
  v_cndmask_b32 v5, v4, v26, s[60:61]
  v_add_u32 v5, 64512, v5
  v_add_u32 v6, 86016, v27
  v_cndmask_b32 v7, v6, v27, s[60:61]
  v_add_u32 v7, 64512, v7
  s_cmp_eq_u32 s70, 3
  s_cselect_b32 s8, 2, 1
  ds_read_b64_tr_b16 v[228:229], v6 offset:0
  ds_read_b64_tr_b16 v[230:231], v6 offset:5376
  ds_read_b64_tr_b16 v[232:233], v6 offset:21504
  ds_read_b64_tr_b16 v[234:235], v6 offset:26880
  ds_read_b64_tr_b16 v[236:237], v6 offset:43008
  ds_read_b64_tr_b16 v[238:239], v6 offset:48384
  ds_read_b64_tr_b16 v[240:241], v7 offset:0
  ds_read_b64_tr_b16 v[242:243], v7 offset:5376
  ds_read_b64_tr_b16 v[244:245], v6 offset:640
  ds_read_b64_tr_b16 v[246:247], v6 offset:6016
L_chunk_125:
  s_waitcnt lgkmcnt(8)
  v_mfma_f32_32x32x16_bf16 v[196:211], v[228:231], v[28:31], 0
  ds_read_b64_tr_b16 v[248:249], v6 offset:22144
  ds_read_b64_tr_b16 v[250:251], v6 offset:27520
  s_waitcnt lgkmcnt(8)
  v_mfma_f32_32x32x16_bf16 v[196:211], v[232:235], v[32:35], v[196:211]
  ds_read_b64_tr_b16 v[228:229], v6 offset:43648
  ds_read_b64_tr_b16 v[230:231], v6 offset:49024
  s_waitcnt lgkmcnt(8)
  v_mfma_f32_32x32x16_bf16 v[196:211], v[236:239], v[36:39], v[196:211]
  ds_read_b64_tr_b16 v[232:233], v7 offset:640
  ds_read_b64_tr_b16 v[234:235], v7 offset:6016
  s_waitcnt lgkmcnt(8)
  v_mfma_f32_32x32x16_bf16 v[196:211], v[240:243], v[40:43], v[196:211]
  ds_read_b64_tr_b16 v[236:237], v4 offset:640
  ds_read_b64_tr_b16 v[238:239], v4 offset:6016
  s_waitcnt lgkmcnt(8)
  v_mfma_f32_32x32x16_bf16 v[212:227], v[244:247], v[28:31], 0
  ds_read_b64_tr_b16 v[240:241], v4 offset:22144
  ds_read_b64_tr_b16 v[242:243], v4 offset:27520
  s_waitcnt lgkmcnt(8)
  v_mfma_f32_32x32x16_bf16 v[212:227], v[248:251], v[32:35], v[212:227]
  ds_read_b64_tr_b16 v[244:245], v4 offset:43648
  ds_read_b64_tr_b16 v[246:247], v4 offset:49024
  s_waitcnt lgkmcnt(8)
  v_mfma_f32_32x32x16_bf16 v[212:227], v[228:231], v[36:39], v[212:227]
  ds_read_b64_tr_b16 v[248:249], v5 offset:640
  ds_read_b64_tr_b16 v[250:251], v5 offset:6016
  v_mul_f32 v180, v24, v199
  v_mul_f32 v181, v24, v198
  v_mul_f32 v182, v24, v197
  v_mul_f32 v183, v24, v196
  v_mul_f32 v184, v24, v203
  v_mul_f32 v185, v24, v202
  v_mul_f32 v186, v24, v201
  v_mul_f32 v187, v24, v200
  s_waitcnt lgkmcnt(8)
  v_mfma_f32_32x32x16_bf16 v[212:227], v[232:235], v[40:43], v[212:227]
  v_mul_f32 v188, v24, v207
  v_mul_f32 v189, v24, v206
  v_mul_f32 v190, v24, v205
  v_mul_f32 v191, v24, v204
  v_mul_f32 v192, v24, v211
  v_mul_f32 v193, v24, v210
  v_mul_f32 v194, v24, v209
  v_mul_f32 v195, v24, v208
  ds_read_b64_tr_b16 v[228:229], v4 offset:0
  ds_read_b64_tr_b16 v[230:231], v4 offset:5376
  s_waitcnt lgkmcnt(8)
  v_mfma_f32_32x32x16_bf16 v[180:195], v[236:239], v[28:31], v[180:195]
  ds_read_b64_tr_b16 v[232:233], v4 offset:21504
  ds_read_b64_tr_b16 v[234:235], v4 offset:26880
  s_waitcnt lgkmcnt(8)
  v_mfma_f32_32x32x16_bf16 v[180:195], v[240:243], v[32:35], v[180:195]
  ds_read_b64_tr_b16 v[236:237], v4 offset:43008
  ds_read_b64_tr_b16 v[238:239], v4 offset:48384
  s_waitcnt lgkmcnt(8)
  v_mfma_f32_32x32x16_bf16 v[180:195], v[244:247], v[36:39], v[180:195]
  ds_read_b64_tr_b16 v[240:241], v5 offset:0
  ds_read_b64_tr_b16 v[242:243], v5 offset:5376
  v_mul_f32 v164, v24, v215
  v_mul_f32 v165, v24, v214
  v_mul_f32 v166, v24, v213
  v_mul_f32 v167, v24, v212
  v_mul_f32 v168, v24, v219
  v_mul_f32 v169, v24, v218
  v_mul_f32 v170, v24, v217
  v_mul_f32 v171, v24, v216
  s_waitcnt lgkmcnt(8)
  v_mfma_f32_32x32x16_bf16 v[180:195], v[248:251], v[40:43], v[180:195]
  v_mul_f32 v172, v24, v223
  v_mul_f32 v173, v24, v222
  v_mul_f32 v174, v24, v221
  v_mul_f32 v175, v24, v220
  v_mul_f32 v176, v24, v227
  v_mul_f32 v177, v24, v226
  v_mul_f32 v178, v24, v225
  v_mul_f32 v179, v24, v224
  s_nop 0
  s_waitcnt lgkmcnt(6)
  v_mfma_f32_32x32x16_bf16 v[164:179], v[228:231], v[28:31], v[164:179]
  s_waitcnt lgkmcnt(4)
  v_mfma_f32_32x32x16_bf16 v[164:179], v[232:235], v[32:35], v[164:179]
  s_waitcnt lgkmcnt(2)
  v_mfma_f32_32x32x16_bf16 v[164:179], v[236:239], v[36:39], v[164:179]
  s_waitcnt lgkmcnt(0)
  v_mfma_f32_32x32x16_bf16 v[164:179], v[240:243], v[40:43], v[164:179]
  s_cmp_eq_u32 s8, 1
  s_cbranch_scc1 L_j0_127
  v_add_u32 v4, 64, v4
  v_add_u32 v5, 64, v5
  v_subrev_u32 v6, 64, v6
  v_subrev_u32 v7, 64, v7
  ds_read_b64_tr_b16 v[228:229], v6 offset:0
  ds_read_b64_tr_b16 v[230:231], v6 offset:5376
  ds_read_b64_tr_b16 v[232:233], v6 offset:21504
  ds_read_b64_tr_b16 v[234:235], v6 offset:26880
  ds_read_b64_tr_b16 v[236:237], v6 offset:43008
  ds_read_b64_tr_b16 v[238:239], v6 offset:48384
  ds_read_b64_tr_b16 v[240:241], v7 offset:0
  ds_read_b64_tr_b16 v[242:243], v7 offset:5376
  ds_read_b64_tr_b16 v[244:245], v6 offset:640
  ds_read_b64_tr_b16 v[246:247], v6 offset:6016
L_j0_127:
  s_nop 9
  v_add_f32 v196, v164, v180
  v_sub_f32 v212, v164, v180
  v_add_f32 v197, v165, v181
  v_sub_f32 v213, v165, v181
  v_add_f32 v198, v166, v182
  v_sub_f32 v214, v166, v182
  v_add_f32 v199, v167, v183
  v_sub_f32 v215, v167, v183
  v_add_f32 v200, v168, v184
  v_sub_f32 v216, v168, v184
  v_add_f32 v201, v169, v185
  v_sub_f32 v217, v169, v185
  v_add_f32 v202, v170, v186
  v_sub_f32 v218, v170, v186
  v_add_f32 v203, v171, v187
  v_sub_f32 v219, v171, v187
  v_add_f32 v204, v172, v188
  v_sub_f32 v220, v172, v188
  v_add_f32 v205, v173, v189
  v_sub_f32 v221, v173, v189
  v_add_f32 v206, v174, v190
  v_sub_f32 v222, v174, v190
  v_add_f32 v207, v175, v191
  v_sub_f32 v223, v175, v191
  v_add_f32 v208, v176, v192
  v_sub_f32 v224, v176, v192
  v_add_f32 v209, v177, v193
  v_sub_f32 v225, v177, v193
  v_add_f32 v210, v178, v194
  v_sub_f32 v226, v178, v194
  v_add_f32 v211, v179, v195
  v_sub_f32 v227, v179, v195
  s_cmp_eq_u32 s8, 1
  s_cbranch_scc1 L_jd_126
  s_mov_b32 s8, 1
  s_mov_b32 s53, 0
  v_cvt_pk_bf16_f32 v144, v196, v197
  v_cvt_pk_bf16_f32 v145, v198, v199
  v_cvt_pk_bf16_f32 v146, v200, v201
  v_cvt_pk_bf16_f32 v147, v202, v203
  v_cvt_pk_bf16_f32 v148, v204, v205
  v_cvt_pk_bf16_f32 v149, v206, v207
  v_cvt_pk_bf16_f32 v150, v208, v209
  v_cvt_pk_bf16_f32 v151, v210, v211
  v_cvt_pk_bf16_f32 v152, v212, v213
  v_cvt_pk_bf16_f32 v153, v214, v215
  v_cvt_pk_bf16_f32 v154, v216, v217
  v_cvt_pk_bf16_f32 v155, v218, v219
  v_cvt_pk_bf16_f32 v156, v220, v221
  v_cvt_pk_bf16_f32 v157, v222, v223
  v_cvt_pk_bf16_f32 v158, v224, v225
  v_cvt_pk_bf16_f32 v159, v226, v227
  s_waitcnt lgkmcnt(0)
  s_waitcnt vmcnt(0)
  v_readfirstlane_b32 s58, v254
  v_readfirstlane_b32 s59, v255
  s_nop 1
  s_cmp_lg_u32 s58, 0
  s_cbranch_scc1 L_xn_128
  v_mov_b32 v254, v4
  v_mov_b32 v255, v6
  v_mov_b32 v253, v7
  s_mov_b64 exec, 1
  v_mov_b32 v4, 0
L_nf_129:
  buffer_load_dwordx2 v[6:7], v4, s[40:43], 0 offen sc1
  s_waitcnt vmcnt(0)
  v_cmp_eq_u32 vcc, 0, v6
  s_cbranch_vccnz L_nf_129
L_nff_130:
  v_readfirstlane_b32 s58, v6
  v_readfirstlane_b32 s59, v7
  s_mov_b64 exec, -1
  v_mov_b32 v4, v254
  v_mov_b32 v6, v255
  v_mov_b32 v7, v253
L_xn_128:
  v_mov_b32 v254, 162820
  v_mov_b32 v255, 1
  s_mov_b64 exec, 1
  ds_add_u32 v254, v255
  s_mov_b64 exec, -1
  ds_write_b128 v10, v[144:147] offset:0
  ds_write_b128 v10, v[148:151] offset:1024
  ds_write_b128 v10, v[152:155] offset:10240
  ds_write_b128 v10, v[156:159] offset:11264
  s_branch L_chunk_125
L_jd_126:
  v_cvt_pk_bf16_f32 v196, v196, v197
  v_cvt_pk_bf16_f32 v197, v198, v199
  v_cvt_pk_bf16_f32 v198, v200, v201
  v_cvt_pk_bf16_f32 v199, v202, v203
  v_cvt_pk_bf16_f32 v200, v204, v205
  v_cvt_pk_bf16_f32 v201, v206, v207
  v_cvt_pk_bf16_f32 v202, v208, v209
  v_cvt_pk_bf16_f32 v203, v210, v211
  v_cvt_pk_bf16_f32 v204, v212, v213
  v_cvt_pk_bf16_f32 v205, v214, v215
  v_cvt_pk_bf16_f32 v206, v216, v217
  v_cvt_pk_bf16_f32 v207, v218, v219
  v_cvt_pk_bf16_f32 v208, v220, v221
  v_cvt_pk_bf16_f32 v209, v222, v223
  v_cvt_pk_bf16_f32 v210, v224, v225
  v_cvt_pk_bf16_f32 v211, v226, v227
  s_cmp_eq_u32 s70, 3
  s_cbranch_scc1 L_j1_131
  ds_write_b128 v10, v[196:199] offset:0
  ds_write_b128 v10, v[200:203] offset:1024
  ds_write_b128 v10, v[204:207] offset:10240
  ds_write_b128 v10, v[208:211] offset:11264
  s_waitcnt vmcnt(0)
  v_readfirstlane_b32 s58, v254
  v_readfirstlane_b32 s59, v255
  s_nop 1
  s_cmp_lg_u32 s58, 0
  s_cbranch_scc1 L_xn_133
  v_mov_b32 v254, v4
  v_mov_b32 v255, v6
  v_mov_b32 v253, v7
  s_mov_b64 exec, 1
  v_mov_b32 v4, 0
L_nf_134:
  buffer_load_dwordx2 v[6:7], v4, s[40:43], 0 offen sc1
  s_waitcnt vmcnt(0)
  v_cmp_eq_u32 vcc, 0, v6
  s_cbranch_vccnz L_nf_134
L_nff_135:
  v_readfirstlane_b32 s58, v6
  v_readfirstlane_b32 s59, v7
  s_mov_b64 exec, -1
  v_mov_b32 v4, v254
  v_mov_b32 v6, v255
  v_mov_b32 v7, v253
L_xn_133:
  v_mov_b32 v254, 162820
  v_mov_b32 v255, 1
  s_mov_b64 exec, 1
  ds_add_u32 v254, v255
  s_mov_b64 exec, -1
  s_cmp_eq_u32 s46, 5
  s_cbranch_scc0 L_j2_132
L_xa_136:
  ds_read_b32 v255, v254
  s_waitcnt lgkmcnt(0)
  v_cmp_gt_u32 vcc, 8, v255
  s_cbranch_vccnz L_xa_136
L_xa_136f:
  s_add_u32 s4, s74, 4096
  v_mov_b32 v4, s58
  v_mov_b32 v5, s59
  v_mov_b32 v6, s58
  v_mov_b32 v7, s59
  s_mov_b64 exec, 0xff
  buffer_store_dwordx4 v[4:7], v17, s[36:39], s4 offen sc1
  s_mov_b64 exec, -1
  s_branch L_j2_132
L_j1_131:
  ds_write_b128 v10, v[196:199] offset:2048
  ds_write_b128 v10, v[200:203] offset:3072
  ds_write_b128 v10, v[204:207] offset:12288
  ds_write_b128 v10, v[208:211] offset:13312
L_j2_132:
  s_setprio 0
  s_cmp_eq_u32 s3, 2
  s_cbranch_scc0 L_pr_137
  s_setprio 1
L_pr_137:
  s_waitcnt lgkmcnt(0)
  s_barrier
  s_lshl_b32 s9, s14, 7
  s_add_u32 s9, s9, 162304
  v_lshl_add_u32 v9, v2, 2, s9
  ds_read_b32 v9, v9
  ds_read_b128 v[164:167], v11 offset:0
  ds_read_b128 v[168:171], v11 offset:1024
  ds_read_b128 v[172:175], v11 offset:2048
  ds_read_b128 v[176:179], v11 offset:3072
  ds_read_b128 v[180:183], v11 offset:4096
  ds_read_b128 v[184:187], v11 offset:5120
  ds_read_b128 v[188:191], v11 offset:6144
  ds_read_b128 v[192:195], v11 offset:7168
  ds_read_b128 v[196:199], v11 offset:8192
  ds_read_b128 v[200:203], v11 offset:9216
  s_cmp_eq_u32 s15, 0
  s_cselect_b32 s16, -1, 0
  s_waitcnt lgkmcnt(10)
  v_and_b32 v9, s16, v9
  v_mov_b32 v204, v9
  v_mov_b32 v205, v9
  v_mov_b32 v206, v9
  v_mov_b32 v207, v9
  v_mov_b32 v208, v9
  v_mov_b32 v209, v9
  v_mov_b32 v210, v9
  v_mov_b32 v211, v9
  v_mov_b32 v212, v9
  v_mov_b32 v213, v9
  v_mov_b32 v214, v9
  v_mov_b32 v215, v9
  v_mov_b32 v216, v9
  v_mov_b32 v217, v9
  v_mov_b32 v218, v9
  v_mov_b32 v219, v9
  s_nop 0
  s_waitcnt lgkmcnt(9)
  v_mfma_f32_32x32x16_bf16 v[204:219], v[44:47], v[164:167], v[204:219]
  v_mov_b32 v220, v9
  v_mov_b32 v221, v9
  v_mov_b32 v222, v9
  v_mov_b32 v223, v9
  v_mov_b32 v224, v9
  v_mov_b32 v225, v9
  v_mov_b32 v226, v9
  v_mov_b32 v227, v9
  s_waitcnt lgkmcnt(8)
  v_mfma_f32_32x32x16_bf16 v[204:219], v[48:51], v[168:171], v[204:219]
  v_mov_b32 v228, v9
  v_mov_b32 v229, v9
  v_mov_b32 v230, v9
  v_mov_b32 v231, v9
  v_mov_b32 v232, v9
  v_mov_b32 v233, v9
  v_mov_b32 v234, v9
  v_mov_b32 v235, v9
  s_waitcnt lgkmcnt(7)
  v_mfma_f32_32x32x16_bf16 v[204:219], v[52:55], v[172:175], v[204:219]
  v_mov_b32 v236, v9
  v_mov_b32 v237, v9
  v_mov_b32 v238, v9
  v_mov_b32 v239, v9
  v_mov_b32 v240, v9
  v_mov_b32 v241, v9
  v_mov_b32 v242, v9
  v_mov_b32 v243, v9
  s_waitcnt lgkmcnt(6)
  v_mfma_f32_32x32x16_bf16 v[204:219], v[56:59], v[176:179], v[204:219]
  v_mov_b32 v244, v9
  v_mov_b32 v245, v9
  v_mov_b32 v246, v9
  v_mov_b32 v247, v9
  v_mov_b32 v248, v9
  v_mov_b32 v249, v9
  v_mov_b32 v250, v9
  v_mov_b32 v251, v9
  s_waitcnt lgkmcnt(5)
  v_mfma_f32_32x32x16_bf16 v[204:219], v[60:63], v[180:183], v[204:219]
  s_waitcnt lgkmcnt(4)
  v_mfma_f32_32x32x16_bf16 v[204:219], v[64:67], v[184:187], v[204:219]
  s_waitcnt lgkmcnt(3)
  v_mfma_f32_32x32x16_bf16 v[204:219], v[68:71], v[188:191], v[204:219]
  s_waitcnt lgkmcnt(2)
  v_mfma_f32_32x32x16_bf16 v[204:219], v[72:75], v[192:195], v[204:219]
  s_waitcnt lgkmcnt(1)
  v_mfma_f32_32x32x16_bf16 v[204:219], v[76:79], v[196:199], v[204:219]
  s_waitcnt lgkmcnt(0)
  v_mfma_f32_32x32x16_bf16 v[204:219], v[80:83], v[200:203], v[204:219]
  v_mfma_f32_32x32x16_bf16 v[220:235], v[84:87], v[164:167], v[220:235]
  v_mfma_f32_32x32x16_bf16 v[220:235], v[88:91], v[168:171], v[220:235]
  v_mfma_f32_32x32x16_bf16 v[220:235], v[92:95], v[172:175], v[220:235]
  v_mfma_f32_32x32x16_bf16 v[220:235], v[96:99], v[176:179], v[220:235]
  v_mfma_f32_32x32x16_bf16 v[220:235], v[100:103], v[180:183], v[220:235]
  v_mfma_f32_32x32x16_bf16 v[220:235], v[104:107], v[184:187], v[220:235]
  v_mfma_f32_32x32x16_bf16 v[220:235], v[108:111], v[188:191], v[220:235]
  v_mfma_f32_32x32x16_bf16 v[220:235], v[112:115], v[192:195], v[220:235]
  v_mfma_f32_32x32x16_bf16 v[220:235], v[116:119], v[196:199], v[220:235]
  v_mfma_f32_32x32x16_bf16 v[220:235], v[120:123], v[200:203], v[220:235]
  s_cmp_eq_u32 s17, 0
  s_cbranch_scc1 L_t1_140
  s_cmp_eq_u32 s17, 1
  s_cbranch_scc1 L_t2_141
  v_cvt_pk_bf16_f32 v204, v204, v205
  v_cvt_pk_bf16_f32 v205, v206, v207
  v_cvt_pk_bf16_f32 v206, v208, v209
  v_cvt_pk_bf16_f32 v207, v210, v211
  v_cvt_pk_bf16_f32 v208, v212, v213
  v_cvt_pk_bf16_f32 v209, v214, v215
  v_cvt_pk_bf16_f32 v210, v216, v217
  v_cvt_pk_bf16_f32 v211, v218, v219
  v_cvt_pk_bf16_f32 v220, v220, v221
  v_cvt_pk_bf16_f32 v221, v222, v223
  v_cvt_pk_bf16_f32 v222, v224, v225
  v_cvt_pk_bf16_f32 v223, v226, v227
  v_cvt_pk_bf16_f32 v224, v228, v229
  v_cvt_pk_bf16_f32 v225, v230, v231
  v_cvt_pk_bf16_f32 v226, v232, v233
  v_cvt_pk_bf16_f32 v227, v234, v235
  v_xor_b32 v4, 16, v12
  v_xor_b32 v5, 64, v12
  v_xor_b32 v6, 80, v12
  ds_write_b128 v12, v[204:207]
  ds_write_b128 v4, v[208:211]
  ds_write_b128 v5, v[220:223]
  ds_write_b128 v6, v[224:227]
  ds_read_b128 v[212:215], v13 offset:0
  ds_read_b128 v[216:219], v13 offset:1024
  ds_read_b128 v[228:231], v13 offset:2048
  ds_read_b128 v[232:235], v13 offset:3072
  s_branch L_t3_142
L_t1_140:
  v_mfma_f32_32x32x16_bf16 v[236:251], v[124:127], v[164:167], v[236:251]
  v_mfma_f32_32x32x16_bf16 v[236:251], v[128:131], v[168:171], v[236:251]
  v_cvt_pk_bf16_f32 v204, v204, v205
  v_cvt_pk_bf16_f32 v205, v206, v207
  v_cvt_pk_bf16_f32 v206, v208, v209
  v_cvt_pk_bf16_f32 v207, v210, v211
  v_mfma_f32_32x32x16_bf16 v[236:251], v[132:135], v[172:175], v[236:251]
  v_cvt_pk_bf16_f32 v208, v212, v213
  v_cvt_pk_bf16_f32 v209, v214, v215
  v_cvt_pk_bf16_f32 v210, v216, v217
  v_cvt_pk_bf16_f32 v211, v218, v219
  v_mfma_f32_32x32x16_bf16 v[236:251], v[136:139], v[176:179], v[236:251]
  v_cvt_pk_bf16_f32 v220, v220, v221
  v_cvt_pk_bf16_f32 v221, v222, v223
  v_cvt_pk_bf16_f32 v222, v224, v225
  v_cvt_pk_bf16_f32 v223, v226, v227
  v_mfma_f32_32x32x16_bf16 v[236:251], v[140:143], v[180:183], v[236:251]
  v_cvt_pk_bf16_f32 v224, v228, v229
  v_cvt_pk_bf16_f32 v225, v230, v231
  v_cvt_pk_bf16_f32 v226, v232, v233
  v_cvt_pk_bf16_f32 v227, v234, v235
  v_mfma_f32_32x32x16_bf16 v[236:251], v[144:147], v[184:187], v[236:251]
  v_xor_b32 v4, 16, v12
  v_xor_b32 v5, 64, v12
  v_xor_b32 v6, 80, v12
  ds_write_b128 v12, v[204:207]
  v_mfma_f32_32x32x16_bf16 v[236:251], v[148:151], v[188:191], v[236:251]
  ds_write_b128 v4, v[208:211]
  ds_write_b128 v5, v[220:223]
  ds_write_b128 v6, v[224:227]
  ds_read_b128 v[212:215], v13 offset:0
  v_mfma_f32_32x32x16_bf16 v[236:251], v[152:155], v[192:195], v[236:251]
  ds_read_b128 v[216:219], v13 offset:1024
  ds_read_b128 v[228:231], v13 offset:2048
  ds_read_b128 v[232:235], v13 offset:3072
  v_mfma_f32_32x32x16_bf16 v[236:251], v[156:159], v[196:199], v[236:251]
  v_mfma_f32_32x32x16_bf16 v[236:251], v[160:163], v[200:203], v[236:251]
  s_branch L_t3_142
L_t2_141:
  v_mfma_f32_32x32x16_bf16 v[236:251], v[124:127], v[164:167], v[236:251]
  v_mfma_f32_32x32x16_bf16 v[236:251], v[124:127], v[168:171], v[236:251]
  v_cvt_pk_bf16_f32 v204, v204, v205
  v_cvt_pk_bf16_f32 v205, v206, v207
  v_cvt_pk_bf16_f32 v206, v208, v209
  v_cvt_pk_bf16_f32 v207, v210, v211
  v_mfma_f32_32x32x16_bf16 v[236:251], v[124:127], v[172:175], v[236:251]
  v_cvt_pk_bf16_f32 v208, v212, v213
  v_cvt_pk_bf16_f32 v209, v214, v215
  v_cvt_pk_bf16_f32 v210, v216, v217
  v_cvt_pk_bf16_f32 v211, v218, v219
  v_mfma_f32_32x32x16_bf16 v[236:251], v[124:127], v[176:179], v[236:251]
  v_cvt_pk_bf16_f32 v220, v220, v221
  v_cvt_pk_bf16_f32 v221, v222, v223
  v_cvt_pk_bf16_f32 v222, v224, v225
  v_cvt_pk_bf16_f32 v223, v226, v227
  v_mfma_f32_32x32x16_bf16 v[236:251], v[124:127], v[180:183], v[236:251]
  v_cvt_pk_bf16_f32 v224, v228, v229
  v_cvt_pk_bf16_f32 v225, v230, v231
  v_cvt_pk_bf16_f32 v226, v232, v233
  v_cvt_pk_bf16_f32 v227, v234, v235
  v_xor_b32 v4, 16, v12
  v_xor_b32 v5, 64, v12
  v_xor_b32 v6, 80, v12
  v_mfma_f32_32x32x16_bf16 v[236:251], v[124:127], v[184:187], v[236:251]
  ds_write_b128 v12, v[204:207]
  ds_write_b128 v4, v[208:211]
  ds_write_b128 v5, v[220:223]
  ds_write_b128 v6, v[224:227]
  ds_read_b128 v[212:215], v13 offset:0
  ds_read_b128 v[216:219], v13 offset:1024
  ds_read_b128 v[228:231], v13 offset:2048
  v_mfma_f32_32x32x16_bf16 v[236:251], v[124:127], v[188:191], v[236:251]
  ds_read_b128 v[232:235], v13 offset:3072
  v_mfma_f32_32x32x16_bf16 v[236:251], v[124:127], v[192:195], v[236:251]
  v_mfma_f32_32x32x16_bf16 v[236:251], v[124:127], v[196:199], v[236:251]
  v_mfma_f32_32x32x16_bf16 v[236:251], v[128:131], v[200:203], v[236:251]
L_t3_142:
  s_waitcnt lgkmcnt(0)
  s_add_u32 s16, s18, 0
  buffer_store_dwordx4 v[212:215], v14, s[36:39], s16 offen sc1
  buffer_store_dwordx4 v[216:219], v15, s[36:39], s16 offen sc1
  buffer_store_dwordx4 v[228:231], v16, s[36:39], s16 offen sc1
  buffer_store_dwordx4 v[232:235], v8, s[36:39], s16 offen sc1
  s_cmp_eq_u32 s17, 3
  s_cbranch_scc1 L_s2e_139
  s_nop 9
  v_cvt_pk_bf16_f32 v236, v236, v237
  v_cvt_pk_bf16_f32 v237, v238, v239
  v_cvt_pk_bf16_f32 v238, v240, v241
  v_cvt_pk_bf16_f32 v239, v242, v243
  v_cvt_pk_bf16_f32 v240, v244, v245
  v_cvt_pk_bf16_f32 v241, v246, v247
  v_cvt_pk_bf16_f32 v242, v248, v249
  v_cvt_pk_bf16_f32 v243, v250, v251
  ds_write_b128 v12, v[236:239]
  ds_write_b128 v4, v[240:243]
  ds_read_b128 v[236:239], v13 offset:0
  ds_read_b128 v[240:243], v13 offset:1024
  ds_read_b128 v[244:247], v13 offset:2048
  ds_read_b128 v[248:251], v13 offset:3072
L_s2e_139:
  s_waitcnt lgkmcnt(0)
  s_cmp_eq_u32 s17, 3
  s_cbranch_scc1 L_n3_143
  s_sub_u32 s18, s18, s64
  s_add_u32 s16, s18, 0
  s_mov_b32 exec_lo, 0x0f0f0f0f
  s_mov_b32 exec_hi, 0x0f0f0f0f
  buffer_store_dwordx4 v[236:239], v14, s[36:39], s16 offen sc1
  buffer_store_dwordx4 v[240:243], v15, s[36:39], s16 offen sc1
  buffer_store_dwordx4 v[244:247], v16, s[36:39], s16 offen sc1
  buffer_store_dwordx4 v[248:251], v8, s[36:39], s16 offen sc1
  s_mov_b64 exec, -1
  s_add_u32 s18, s18, s64
L_n3_143:
  s_cmp_eq_u32 s63, 0
  s_cbranch_scc1 L_xe_145
  s_cmp_eq_u32 s15, 0
  s_cbranch_scc1 L_xs_146
  v_mov_b32 v4, 70368
  v_mov_b32 v6, 1065369472
  v_mov_b32 v7, v6
  ds_write_b64 v4, v[6:7] offset:8
  ds_write_b64 v4, v[6:7]
  s_waitcnt lgkmcnt(0)
  s_waitcnt vmcnt(0)
  v_mov_b32 v4, 162816
  v_mov_b32 v5, 1
  s_mov_b64 exec, 1
  ds_add_u32 v4, v5
  s_mov_b64 exec, -1
L_cw_148:
  ds_read_b32 v5, v4
  s_waitcnt lgkmcnt(0)
  v_cmp_gt_u32 vcc, 8, v5
  s_cbranch_vccnz L_cw_148
L_cw_148f:
  s_cmp_eq_u32 s46, 2
  s_cbranch_scc0 L_xw_147
  v_mov_b32 v4, s58
  v_mov_b32 v5, s59
  v_mov_b32 v6, s58
  v_mov_b32 v7, s59
  s_mov_b64 exec, 0xff
  buffer_store_dwordx4 v[4:7], v17, s[36:39], s74 offen sc1
  s_mov_b64 exec, -1
L_xw_147:
  s_and_b32 s46, s46, 3
  s_mov_b32 s3, 0
  s_setprio 0
  s_bitcmp1_b32 0x0f000000, s45
  s_cselect_b32 s54, 1, 0
  s_cmp_ge_u32 s45, 28
  s_cselect_b32 s5, 4, 0
  s_sub_u32 s5, s45, s5
  s_mul_i32 s56, s5, 37
  s_lshr_b32 s56, s56, 8
  s_mul_i32 s4, s56, 7
  s_sub_u32 s100, s5, s4
  s_lshr_b32 s4, s44, 1
  s_mul_i32 s55, s4, 7
  s_add_u32 s55, s55, s100
  s_add_u32 s55, s55, 4
  s_and_b32 s5, s45, 3
  s_lshl_b32 s6, s5, 1
  s_add_u32 s6, s6, 1
  s_cmp_eq_u32 s54, 1
  s_cselect_b32 s55, s5, s55
  s_cselect_b32 s56, s4, s56
  s_cselect_b32 s100, s6, s100
  s_and_b32 s4, s44, 1
  s_lshl_b32 s4, s4, 2
  s_add_u32 s56, s56, s4
  s_branch L_btail
L_xs_146:
  s_add_u32 s9, s9, 256
  v_lshl_add_u32 v9, v2, 2, s9
  ds_read_b32 v9, v9
  ds_read_b128 v[164:167], v11 offset:20480
  ds_read_b128 v[168:171], v11 offset:21504
  ds_read_b128 v[172:175], v11 offset:22528
  ds_read_b128 v[176:179], v11 offset:23552
  ds_read_b128 v[180:183], v11 offset:24576
  ds_read_b128 v[184:187], v11 offset:25600
  ds_read_b128 v[188:191], v11 offset:26624
  ds_read_b128 v[192:195], v11 offset:27648
  ds_read_b128 v[196:199], v11 offset:28672
  ds_read_b128 v[200:203], v11 offset:29696
  s_waitcnt lgkmcnt(10)
  v_mov_b32 v204, v9
  v_mov_b32 v205, v9
  v_mov_b32 v206, v9
  v_mov_b32 v207, v9
  v_mov_b32 v208, v9
  v_mov_b32 v209, v9
  v_mov_b32 v210, v9
  v_mov_b32 v211, v9
  v_mov_b32 v212, v9
  v_mov_b32 v213, v9
  v_mov_b32 v214, v9
  v_mov_b32 v215, v9
  v_mov_b32 v216, v9
  v_mov_b32 v217, v9
  v_mov_b32 v218, v9
  v_mov_b32 v219, v9
  s_nop 0
  s_waitcnt lgkmcnt(9)
  v_mfma_f32_32x32x16_bf16 v[204:219], v[44:47], v[164:167], v[204:219]
  v_mov_b32 v220, v9
  v_mov_b32 v221, v9
  v_mov_b32 v222, v9
  v_mov_b32 v223, v9
  v_mov_b32 v224, v9
  v_mov_b32 v225, v9
  s_waitcnt lgkmcnt(8)
  v_mfma_f32_32x32x16_bf16 v[204:219], v[48:51], v[168:171], v[204:219]
  v_mov_b32 v226, v9
  v_mov_b32 v227, v9
  v_mov_b32 v228, v9
  v_mov_b32 v229, v9
  v_mov_b32 v230, v9
  v_mov_b32 v231, v9
  s_waitcnt lgkmcnt(7)
  v_mfma_f32_32x32x16_bf16 v[204:219], v[52:55], v[172:175], v[204:219]
  v_mov_b32 v232, v9
  v_mov_b32 v233, v9
  v_mov_b32 v234, v9
  v_mov_b32 v235, v9
  v_mov_b32 v236, v9
  v_mov_b32 v237, v9
  s_waitcnt lgkmcnt(6)
  v_mfma_f32_32x32x16_bf16 v[204:219], v[56:59], v[176:179], v[204:219]
  v_mov_b32 v238, v9
  v_mov_b32 v239, v9
  v_mov_b32 v240, v9
  v_mov_b32 v241, v9
  v_mov_b32 v242, v9
  v_mov_b32 v243, v9
  s_waitcnt lgkmcnt(5)
  v_mfma_f32_32x32x16_bf16 v[204:219], v[60:63], v[180:183], v[204:219]
  v_mov_b32 v244, v9
  v_mov_b32 v245, v9
  v_mov_b32 v246, v9
  v_mov_b32 v247, v9
  v_mov_b32 v248, v9
  v_mov_b32 v249, v9
  s_waitcnt lgkmcnt(4)
  v_mfma_f32_32x32x16_bf16 v[204:219], v[64:67], v[184:187], v[204:219]
  v_mov_b32 v250, v9
  v_mov_b32 v251, v9
  v_lshlrev_b32 v6, 5, v3
  v_add_u32 v6, 1572864, v6
  s_waitcnt lgkmcnt(3)
  v_mfma_f32_32x32x16_bf16 v[204:219], v[68:71], v[188:191], v[204:219]
  s_waitcnt lgkmcnt(2)
  v_mfma_f32_32x32x16_bf16 v[204:219], v[72:75], v[192:195], v[204:219]
  s_waitcnt lgkmcnt(1)
  v_mfma_f32_32x32x16_bf16 v[204:219], v[76:79], v[196:199], v[204:219]
  s_waitcnt lgkmcnt(0)
  v_mfma_f32_32x32x16_bf16 v[204:219], v[80:83], v[200:203], v[204:219]
  v_mfma_f32_32x32x16_bf16 v[220:235], v[84:87], v[164:167], v[220:235]
  v_mfma_f32_32x32x16_bf16 v[220:235], v[88:91], v[168:171], v[220:235]
  v_mfma_f32_32x32x16_bf16 v[220:235], v[92:95], v[172:175], v[220:235]
  v_mfma_f32_32x32x16_bf16 v[220:235], v[96:99], v[176:179], v[220:235]
  v_mfma_f32_32x32x16_bf16 v[220:235], v[100:103], v[180:183], v[220:235]
  v_mfma_f32_32x32x16_bf16 v[220:235], v[104:107], v[184:187], v[220:235]
  v_mfma_f32_32x32x16_bf16 v[220:235], v[108:111], v[188:191], v[220:235]
  v_mfma_f32_32x32x16_bf16 v[220:235], v[112:115], v[192:195], v[220:235]
  v_mfma_f32_32x32x16_bf16 v[220:235], v[116:119], v[196:199], v[220:235]
  v_mfma_f32_32x32x16_bf16 v[220:235], v[120:123], v[200:203], v[220:235]
  s_waitcnt vmcnt(0)
  v_mov_b32 v4, 162816
  v_mov_b32 v5, 1
  s_mov_b64 exec, 1
  ds_add_u32 v4, v5
  s_mov_b64 exec, -1
  s_cmp_eq_u32 s17, 0
  s_cbranch_scc1 L_y_149
  s_cmp_eq_u32 s17, 3
  s_cbranch_scc1 L_y_150
  v_mfma_f32_32x32x16_bf16 v[236:251], v[124:127], v[164:167], v[236:251]
  v_mfma_f32_32x32x16_bf16 v[236:251], v[124:127], v[168:171], v[236:251]
  v_mfma_f32_32x32x16_bf16 v[236:251], v[124:127], v[172:175], v[236:251]
  v_mfma_f32_32x32x16_bf16 v[236:251], v[124:127], v[176:179], v[236:251]
  v_mfma_f32_32x32x16_bf16 v[236:251], v[124:127], v[180:183], v[236:251]
  v_mfma_f32_32x32x16_bf16 v[236:251], v[124:127], v[184:187], v[236:251]
  v_mfma_f32_32x32x16_bf16 v[236:251], v[124:127], v[188:191], v[236:251]
  v_mfma_f32_32x32x16_bf16 v[236:251], v[124:127], v[192:195], v[236:251]
  v_mfma_f32_32x32x16_bf16 v[236:251], v[124:127], v[196:199], v[236:251]
  v_mfma_f32_32x32x16_bf16 v[236:251], v[128:131], v[200:203], v[236:251]
  s_branch L_y_150
L_y_149:
  v_mfma_f32_32x32x16_bf16 v[236:251], v[124:127], v[164:167], v[236:251]
  v_mfma_f32_32x32x16_bf16 v[236:251], v[128:131], v[168:171], v[236:251]
  v_mfma_f32_32x32x16_bf16 v[236:251], v[132:135], v[172:175], v[236:251]
  v_mfma_f32_32x32x16_bf16 v[236:251], v[136:139], v[176:179], v[236:251]
  v_mfma_f32_32x32x16_bf16 v[236:251], v[140:143], v[180:183], v[236:251]
  v_mfma_f32_32x32x16_bf16 v[236:251], v[144:147], v[184:187], v[236:251]
  v_mfma_f32_32x32x16_bf16 v[236:251], v[148:151], v[188:191], v[236:251]
  v_mfma_f32_32x32x16_bf16 v[236:251], v[152:155], v[192:195], v[236:251]
  v_mfma_f32_32x32x16_bf16 v[236:251], v[156:159], v[196:199], v[236:251]
  v_mfma_f32_32x32x16_bf16 v[236:251], v[160:163], v[200:203], v[236:251]
L_y_150:
  s_nop 3
  v_cvt_pk_bf16_f32 v204, v204, v205
  v_cvt_pk_bf16_f32 v205, v206, v207
  v_cvt_pk_bf16_f32 v206, v208, v209
  v_cvt_pk_bf16_f32 v207, v210, v211
  v_cvt_pk_bf16_f32 v208, v212, v213
  v_cvt_pk_bf16_f32 v209, v214, v215
  v_cvt_pk_bf16_f32 v210, v216, v217
  v_cvt_pk_bf16_f32 v211, v218, v219
  s_add_u32 s16, s18, 0
  s_mov_b32 exec_lo, 0x8000
  s_mov_b32 exec_hi, 0x8000
  buffer_store_dwordx4 v[204:207], v6, s[36:39], s16 offen sc1
  buffer_store_dwordx4 v[208:211], v6, s[36:39], s16 offen offset:16 sc1
  s_mov_b64 exec, -1
  v_cvt_pk_bf16_f32 v220, v220, v221
  v_cvt_pk_bf16_f32 v221, v222, v223
  v_cvt_pk_bf16_f32 v222, v224, v225
  v_cvt_pk_bf16_f32 v223, v226, v227
  v_cvt_pk_bf16_f32 v224, v228, v229
  v_cvt_pk_bf16_f32 v225, v230, v231
  v_cvt_pk_bf16_f32 v226, v232, v233
  v_cvt_pk_bf16_f32 v227, v234, v235
  s_add_u32 s16, s18, 64
  s_mov_b32 exec_lo, 0x8000
  s_mov_b32 exec_hi, 0x8000
  buffer_store_dwordx4 v[220:223], v6, s[36:39], s16 offen sc1
  buffer_store_dwordx4 v[224:227], v6, s[36:39], s16 offen offset:16 sc1
  s_mov_b64 exec, -1
  s_cmp_eq_u32 s17, 3
  s_cbranch_scc1 L_y_150x
  v_cvt_pk_bf16_f32 v236, v236, v237
  v_cvt_pk_bf16_f32 v237, v238, v239
  v_cvt_pk_bf16_f32 v238, v240, v241
  v_cvt_pk_bf16_f32 v239, v242, v243
  v_cvt_pk_bf16_f32 v240, v244, v245
  v_cvt_pk_bf16_f32 v241, v246, v247
  v_cvt_pk_bf16_f32 v242, v248, v249
  v_cvt_pk_bf16_f32 v243, v250, v251
  s_sub_u32 s16, s18, s64
  s_mov_b32 exec_lo, 0x8000
  s_mov_b32 exec_hi, 0x8000
  buffer_store_dwordx4 v[236:239], v6, s[36:39], s16 offen sc1
  buffer_store_dwordx4 v[240:243], v6, s[36:39], s16 offen offset:16 sc1
  s_mov_b64 exec, -1
L_y_150x:
  s_waitcnt vmcnt(0)
  v_mov_b32 v4, 162824
  v_mov_b32 v5, 1
  s_mov_b64 exec, 1
  ds_add_u32 v4, v5
  s_mov_b64 exec, -1
  s_mov_b32 s3, 1
  s_setprio 0
  s_cmp_eq_u32 s46, 0
  s_cbranch_scc0 L_late
L_cw_151:
  ds_read_b32 v5, v4
  s_waitcnt lgkmcnt(0)
  v_cmp_gt_u32 vcc, 4, v5
  s_cbranch_vccnz L_cw_151
L_cw_151f:
  s_add_u32 s74, s74, 128
  v_mov_b32 v4, s58
  v_mov_b32 v5, s59
  v_mov_b32 v6, s58
  v_mov_b32 v7, s59
  s_mov_b64 exec, 0xff
  buffer_store_dwordx4 v[4:7], v17, s[36:39], s74 offen sc1
  s_mov_b64 exec, -1
  s_branch L_late
L_xe_145:
  s_setprio 0
  s_bitcmp1_b32 0x0f000000, s45
  s_cselect_b32 s54, 1, 0
  s_cmp_ge_u32 s45, 28
  s_cselect_b32 s5, 4, 0
  s_sub_u32 s5, s45, s5
  s_mul_i32 s56, s5, 37
  s_lshr_b32 s56, s56, 8
  s_mul_i32 s4, s56, 7
  s_sub_u32 s100, s5, s4
  s_lshr_b32 s4, s44, 1
  s_mul_i32 s55, s4, 7
  s_add_u32 s55, s55, s100
  s_add_u32 s55, s55, 4
  s_and_b32 s5, s45, 3
  s_lshl_b32 s6, s5, 1
  s_add_u32 s6, s6, 1
  s_cmp_eq_u32 s54, 1
  s_cselect_b32 s55, s5, s55
  s_cselect_b32 s56, s4, s56
  s_cselect_b32 s100, s6, s100
  s_and_b32 s4, s44, 1
  s_lshl_b32 s4, s4, 2
  s_add_u32 s56, s56, s4
  s_waitcnt vmcnt(0)
  s_cmp_eq_u32 s46, 7
  s_cbranch_scc0 L_bn_153c
  v_mov_b32 v4, 70368
  v_mov_b32 v6, 1065369472
  v_mov_b32 v7, v6
  ds_write_b64 v4, v[6:7] offset:8
  ds_write_b64 v4, v[6:7]
  s_waitcnt lgkmcnt(0)
L_bn_153c:
  s_barrier
  s_cmp_eq_u32 s46, 0
  s_cbranch_scc0 L_bf_152
  v_mov_b32 v4, s58
  v_mov_b32 v5, s59
  v_mov_b32 v6, s58
  v_mov_b32 v7, s59
  s_mov_b64 exec, 0xff
  buffer_store_dwordx4 v[4:7], v17, s[36:39], s74 offen sc1
  s_mov_b64 exec, -1
L_bf_152:
  s_cmp_eq_u32 s3, 1
  s_cbranch_scc1 L_late
L_btail:
  s_and_b32 s4, s46, 3
  s_lshl_b32 s4, s4, 6
  v_add_u32 v4, s4, v1
  v_mul_u32_u24 v5, 205, v4
  v_lshrrev_b32 v5, 11, v5
  v_mul_u32_u24 v6, 10, v5
  v_sub_u32 v4, v4, v6
  v_bfe_u32 v6, v5, 2, 1
  v_bfe_u32 v7, v5, 3, 1
  v_xor_b32 v7, v6, v7
  v_mul_u32_u24 v7, 12, v7
  v_xor_b32 v5, v5, v7
  s_mul_i32 s4, s56, 160
  v_lshl_add_u32 v4, v4, 4, s4
  v_lshrrev_b32 v6, 4, v5
  v_lshl_add_u32 v6, v6, 2, v5
  v_mul_u32_u24 v6, 1280, v6
  v_add_u32 v18, v6, v4
  v_lshrrev_b32 v6, 2, v5
  v_mul_u32_u24 v6, 20, v6
  v_and_b32 v7, 3, v5
  v_add3_u32 v6, v6, v7, 16
  v_mul_u32_u24 v6, 1280, v6
  v_add_u32 v20, v6, v4
  s_and_b32 s4, s46, 3
  s_lshl_b32 s4, s4, 6
  v_add_u32 v4, 256, v1
  v_mul_u32_u24 v5, 205, v4
  v_lshrrev_b32 v5, 11, v5
  v_mul_u32_u24 v6, 10, v5
  v_sub_u32 v4, v4, v6
  v_bfe_u32 v6, v5, 2, 1
  v_bfe_u32 v7, v5, 3, 1
  v_xor_b32 v7, v6, v7
  v_mul_u32_u24 v7, 12, v7
  v_xor_b32 v5, v5, v7
  s_mul_i32 s4, s56, 160
  v_lshl_add_u32 v4, v4, 4, s4
  v_lshrrev_b32 v6, 4, v5
  v_lshl_add_u32 v6, v6, 2, v5
  v_mul_u32_u24 v6, 1280, v6
  v_add_u32 v19, v6, v4
  v_lshrrev_b32 v6, 2, v5
  v_mul_u32_u24 v6, 20, v6
  v_and_b32 v7, 3, v5
  v_add3_u32 v6, v6, v7, 16
  v_mul_u32_u24 v6, 1280, v6
  v_add_u32 v21, v6, v4
  s_mov_b32 s10, s100
  s_and_b32 s12, s46, 3
  s_lshl_b32 s12, s12, 10
  s_cmp_eq_u32 s3, 0
  s_cselect_b32 s13, 8, 0
L_bwf:
  s_cmp_eq_u32 s13, 0
  s_cbranch_scc1 L_bn2_154
  s_mul_i32 s4, s10, 10240
  s_mul_i32 s5, s10, 102400
  s_add_u32 s4, s4, 70400
  s_add_u32 m0, s4, s12
  s_sub_u32 s13, s13, 1
  buffer_load_dwordx4 v18, s[28:31], s5 offen lds
  s_add_u32 m0, m0, 5120
  s_add_u32 s6, s5, 51200
  buffer_load_dwordx4 v18, s[28:31], s6 offen lds
  s_lshr_b32 s7, s12, 11
  s_xor_b32 s7, s7, s10
  s_add_u32 s10, s10, 1
  s_and_b32 s10, s10, 7
  s_bitcmp1_b32 s7, 0
  s_cbranch_scc1 L_wp_155
  s_bitcmp1_b32 s46, 0
  s_cselect_b32 s5, s6, s5
  s_cselect_b32 s6, 5120, 0
  s_add_u32 s4, s4, 4096
  s_add_u32 m0, s4, s6
  s_nop 0
  buffer_load_dwordx4 v19, s[28:31], s5 offen lds
L_wp_155:
  s_branch L_bwf
L_bn2_154:
  v_and_b32 v4, 15, v1
  v_lshrrev_b32 v5, 4, v1
  s_lshl_b32 s4, s55, 6
  s_and_b32 s5, s46, 3
  s_lshl_b32 s5, s5, 4
  s_add_u32 s4, s4, s5
  v_add_u32 v6, s4, v4
  v_lshlrev_b32 v7, 15, v5
  v_lshl_add_u32 v56, v6, 4, v7
  v_add_u32 v56, 8388608, v56
  v_lshl_add_u32 v57, v6, 3, v7
  v_add_u32 v57, 10485760, v57
  v_lshlrev_b32 v6, 4, v3
  v_bfe_u32 v7, v1, 4, 1
  v_lshl_add_u32 v6, v7, 2, v6
  v_bfe_u32 v8, v1, 2, 2
  v_add_u32 v6, v6, v8
  v_mul_u32_u24 v6, 160, v6
  v_and_b32 v8, 3, v1
  v_lshl_add_u32 v60, v8, 3, v6
  s_cmp_eq_u32 s54, 1
  s_cselect_b64 vcc, -1, 0
  v_cndmask_b32 v7, v60, v17, vcc
  s_and_b32 s5, s56, 3
  s_mul_i32 s6, s5, 20480
  s_add_u32 s6, s6, 70400
  v_add_u32 v58, s6, v7
  s_add_u32 s5, s5, 1
  s_and_b32 s5, s5, 3
  s_mul_i32 s6, s5, 20480
  s_add_u32 s6, s6, 70400
  v_add_u32 v59, s6, v7
  s_add_u32 s5, s5, 1
  s_and_b32 s5, s5, 3
  s_mul_i32 s6, s5, 20480
  s_add_u32 s6, s6, 70400
  v_add_u32 v68, s6, v7
  s_add_u32 s5, s5, 1
  s_and_b32 s5, s5, 3
  s_mul_i32 s6, s5, 20480
  s_add_u32 s6, s6, 70400
  v_add_u32 v69, s6, v7
  s_mul_i32 s5, s46, 2816
  s_add_u32 s5, s5, 45056
  v_mul_u32_u24 v6, 176, v4
  v_lshl_add_u32 v6, v5, 3, v6
  v_add_u32 v61, s5, v6
  s_mul_i32 s6, s56, 160
  s_mul_i32 s7, s4, 2560
  s_add_u32 s6, s6, s7
  s_lshr_b32 s7, s55, 1
  s_lshl_b32 s7, s7, 11
  s_add_u32 s7, s7, 13697024
  v_lshl_add_u32 v71, v4, 7, s7
  s_lshr_b32 s7, s55, 1
  s_max_u32 s7, s7, 1
  s_sub_u32 s7, 15, s7
  s_lshl_b32 s7, s7, 11
  s_add_u32 s7, s7, 13729792
  v_and_b32 v6, 1, v4
  v_lshlrev_b32 v6, 10, v6
  v_lshrrev_b32 v7, 1, v4
  v_lshl_add_u32 v6, v7, 7, v6
  v_add_u32 v70, s7, v6
  s_lshl_b32 s7, s4, 4
  s_add_u32 s7, s7, 8421616
  v_lshl_add_u32 v93, v2, 16, s7
  v_add_u32 v4, 0, v1
  v_mul_u32_u24 v5, 205, v4
  v_lshrrev_b32 v5, 11, v5
  v_mul_u32_u24 v6, 10, v5
  v_sub_u32 v4, v4, v6
  v_lshlrev_b32 v4, 4, v4
  v_mul_u32_u24 v6, 176, v5
  v_add3_u32 v62, v6, v4, s5
  v_mul_u32_u24 v6, 2560, v5
  v_add3_u32 v65, v6, v4, s6
  v_add_u32 v4, 64, v1
  v_mul_u32_u24 v5, 205, v4
  v_lshrrev_b32 v5, 11, v5
  v_mul_u32_u24 v6, 10, v5
  v_sub_u32 v4, v4, v6
  v_lshlrev_b32 v4, 4, v4
  v_mul_u32_u24 v6, 176, v5
  v_add3_u32 v63, v6, v4, s5
  v_mul_u32_u24 v6, 2560, v5
  v_add3_u32 v66, v6, v4, s6
  v_add_u32 v4, 128, v1
  v_mul_u32_u24 v5, 205, v4
  v_lshrrev_b32 v5, 11, v5
  v_mul_u32_u24 v6, 10, v5
  v_sub_u32 v4, v4, v6
  v_lshlrev_b32 v4, 4, v4
  v_mul_u32_u24 v6, 176, v5
  v_add3_u32 v64, v6, v4, s5
  v_mul_u32_u24 v6, 2560, v5
  v_add3_u32 v67, v6, v4, s6
  v_add_u32 v4, 0, v1
  v_mul_u32_u24 v5, 205, v4
  v_lshrrev_b32 v5, 11, v5
  v_mul_u32_u24 v6, 10, v5
  v_sub_u32 v4, v4, v6
  v_bfe_u32 v6, v5, 2, 1
  v_bfe_u32 v7, v5, 3, 1
  v_xor_b32 v7, v6, v7
  v_mul_u32_u24 v7, 12, v7
  v_xor_b32 v5, v5, v7
  s_mul_i32 s4, s56, 160
  s_add_u32 s4, s4, 20480
  v_lshl_add_u32 v4, v4, 4, s4
  v_lshrrev_b32 v6, 2, v5
  v_mul_u32_u24 v6, 20, v6
  v_and_b32 v7, 3, v5
  v_add_u32 v6, v6, v7
  v_mul_u32_u24 v6, 1280, v6
  v_add_u32 v88, v6, v4
  v_add_u32 v4, 64, v1
  v_mul_u32_u24 v5, 205, v4
  v_lshrrev_b32 v5, 11, v5
  v_mul_u32_u24 v6, 10, v5
  v_sub_u32 v4, v4, v6
  v_bfe_u32 v6, v5, 2, 1
  v_bfe_u32 v7, v5, 3, 1
  v_xor_b32 v7, v6, v7
  v_mul_u32_u24 v7, 12, v7
  v_xor_b32 v5, v5, v7
  s_mul_i32 s4, s56, 160
  s_add_u32 s4, s4, 19456
  v_lshl_add_u32 v4, v4, 4, s4
  v_lshrrev_b32 v6, 2, v5
  v_mul_u32_u24 v6, 20, v6
  v_and_b32 v7, 3, v5
  v_add_u32 v6, v6, v7
  v_mul_u32_u24 v6, 1280, v6
  v_add_u32 v89, v6, v4
  v_add_u32 v4, 128, v1
  v_mul_u32_u24 v5, 205, v4
  v_lshrrev_b32 v5, 11, v5
  v_mul_u32_u24 v6, 10, v5
  v_sub_u32 v4, v4, v6
  v_bfe_u32 v6, v5, 2, 1
  v_bfe_u32 v7, v5, 3, 1
  v_xor_b32 v7, v6, v7
  v_mul_u32_u24 v7, 12, v7
  v_xor_b32 v5, v5, v7
  s_mul_i32 s4, s56, 160
  s_add_u32 s4, s4, 18432
  v_lshl_add_u32 v4, v4, 4, s4
  v_lshrrev_b32 v6, 2, v5
  v_mul_u32_u24 v6, 20, v6
  v_and_b32 v7, 3, v5
  v_add_u32 v6, v6, v7
  v_mul_u32_u24 v6, 1280, v6
  v_add_u32 v90, v6, v4
  v_add_u32 v4, 192, v1
  v_mul_u32_u24 v5, 205, v4
  v_lshrrev_b32 v5, 11, v5
  v_mul_u32_u24 v6, 10, v5
  v_sub_u32 v4, v4, v6
  v_bfe_u32 v6, v5, 2, 1
  v_bfe_u32 v7, v5, 3, 1
  v_xor_b32 v7, v6, v7
  v_mul_u32_u24 v7, 12, v7
  v_xor_b32 v5, v5, v7
  s_mul_i32 s4, s56, 160
  s_add_u32 s4, s4, 17408
  v_lshl_add_u32 v4, v4, 4, s4
  v_lshrrev_b32 v6, 2, v5
  v_mul_u32_u24 v6, 20, v6
  v_and_b32 v7, 3, v5
  v_add_u32 v6, v6, v7
  v_mul_u32_u24 v6, 1280, v6
  v_add_u32 v91, v6, v4
  v_add_u32 v4, 256, v1
  v_mul_u32_u24 v5, 205, v4
  v_lshrrev_b32 v5, 11, v5
  v_mul_u32_u24 v6, 10, v5
  v_sub_u32 v4, v4, v6
  v_bfe_u32 v6, v5, 2, 1
  v_bfe_u32 v7, v5, 3, 1
  v_xor_b32 v7, v6, v7
  v_mul_u32_u24 v7, 12, v7
  v_xor_b32 v5, v5, v7
  s_mul_i32 s4, s56, 160
  s_add_u32 s4, s4, 20480
  v_lshl_add_u32 v4, v4, 4, s4
  v_lshrrev_b32 v6, 2, v5
  v_mul_u32_u24 v6, 20, v6
  v_and_b32 v7, 3, v5
  v_add_u32 v6, v6, v7
  v_mul_u32_u24 v6, 1280, v6
  v_add_u32 v92, v6, v4
  v_mov_b32 v6, 2147483632
  v_cndmask_b32 v67, v67, v6, s[60:61]
  v_cndmask_b32 v64, v64, v62, s[60:61]
  v_mov_b32 v8, 0
  v_mov_b32 v9, 0
  s_waitcnt vmcnt(0)
  v_mov_b32 v4, 70380
  v_mov_b32 v5, 1
  s_mov_b64 exec, 1
  ds_add_u32 v4, v5
  s_mov_b64 exec, -1
  v_mov_b32 v4, 70380
L_lw_156:
  ds_read_b32 v5, v4
  s_waitcnt lgkmcnt(0)
  v_cmp_gt_u32 vcc, 1065369476, v5
  s_cbranch_vccz L_lwf_157
  s_sleep 1
  s_branch L_lw_156
L_lwf_157:
  s_branch L_late
L_codeend:
  s_endpgm
.section .rodata,"a"
.p2align 6
.amdhsa_kernel concat_heads__sliding_block__spectral_fnet__prompt_kernel
  .amdhsa_next_free_vgpr 256
  .amdhsa_next_free_sgpr 102
  .amdhsa_accum_offset 256
  .amdhsa_group_segment_fixed_size 0
  .amdhsa_kernarg_size 88
  .amdhsa_user_sgpr_count 2
  .amdhsa_user_sgpr_kernarg_segment_ptr 1
  .amdhsa_system_sgpr_workgroup_id_x 1
  .amdhsa_float_denorm_mode_32 3
.end_amdhsa_kernel
```
